```python
import torch

def _softmax(x, axis=-1):
    return torch.softmax(x, dim=axis)
def _gelu(x):
    return torch.nn.functional.gelu(x, approximate="tanh")
def _silu(x):
    return torch.nn.functional.silu(x)
def _sigmoid(x):
    return torch.sigmoid(x)
def _layernorm(x, axis=-1, eps=1e-5):
    m = x.mean(dim=axis, keepdim=True)
    v = x.var(dim=axis, keepdim=True, unbiased=False)
    return (x - m) / torch.sqrt(v + eps)
def _scatter_add(tgt, idx, src, axis=0):
    return tgt.clone().index_add_(axis, idx, src)
def _segment_sum(src, seg, n):
    out = torch.zeros((n,) + src.shape[1:], dtype=src.dtype)
    return out.index_add_(0, seg, src)
def _pad(x, pw):
    flat = tuple(v for pair in reversed(pw) for v in pair)
    return torch.nn.functional.pad(x, flat)

kernel_name = 'interleave_layers__sliding_local_dilated__glu_gated_glu__prompt'

def setup_inputs():

    _w = (lambda a: (lambda t: t.to(torch.bfloat16) if t.is_floating_point() else t)(torch.as_tensor(a)))
    def _A_setup():
        B, S, D = 1, 2048, 512
        return {
            "x": _w((lambda *s: torch.randn(*s, dtype=torch.bfloat16) * 0.05)(B, S, D)),
            "wqkv": _w((lambda *s: torch.randn(*s, dtype=torch.bfloat16) * 0.05)(D, 3 * D)),
            "wo": _w((lambda *s: torch.randn(*s, dtype=torch.bfloat16) * 0.05)(D, D)),
        }
    _A_in = _A_setup()

    def _B_setup():
        B, S, D, F = 1, 2048, 512, 1792
        return {
            "x": _w((lambda *s: torch.randn(*s, dtype=torch.bfloat16) * 0.05)(B, S, D)),
            "w_gate": _w((lambda *s: torch.randn(*s, dtype=torch.bfloat16) * 0.05)(D, F)),
            "w_up": _w((lambda *s: torch.randn(*s, dtype=torch.bfloat16) * 0.05)(D, F)),
            "w_down": _w((lambda *s: torch.randn(*s, dtype=torch.bfloat16) * 0.05)(F, D)),
        }
    _B_in = _B_setup()

    return {
        "A_x": _A_in["x"],
        "A_wqkv": _A_in["wqkv"],
        "A_wo": _A_in["wo"],
        "B_x": _B_in["x"],
        "B_w_gate": _B_in["w_gate"],
        "B_w_up": _B_in["w_up"],
        "B_w_down": _B_in["w_down"],
    }

def reference(A_x, A_wqkv, A_wo, B_x, B_w_gate, B_w_up, B_w_down):
    def _A_ref(x, wqkv, wo):
        B, S, D = x.shape
        H = 32; Dh = D // H
        W, dil = 8, 2
        qkv = (lambda x, *d: x.permute(*d))((x @ wqkv).reshape(B, S, 3, H, Dh), 2, 0, 3, 1, 4)
        q, k, v = qkv[0], qkv[1], qkv[2]
        scale = Dh ** -0.5
        pos = torch.arange(S)
        off = torch.arange(W) * dil
        idx = pos[:, None] - off[None, :]
        mask = idx >= 0
        idx_c = torch.where(mask, idx, 0).reshape(-1)
        kg = k[:, :, idx_c, :].reshape(B, H, S, W, Dh)
        vg = v[:, :, idx_c, :].reshape(B, H, S, W, Dh)
        logits = torch.einsum("bhsd,bhswd->bhsw", q, kg) * scale
        logits = torch.where(mask[None, None, :, :], logits, -1e9)
        attn = _softmax(logits, axis=-1)
        o = torch.einsum("bhsw,bhswd->bhsd", attn, vg)
        return (lambda x, *d: x.permute(*d))(o, 0, 2, 1, 3).reshape(B, S, D) @ wo

    def _B_ref(x, w_gate, w_up, w_down):
        g = torch.einsum("bsd,df->bsf", x, w_gate)
        u = torch.einsum("bsd,df->bsf", x, w_up)
        h = _sigmoid(g) * u
        return torch.einsum("bsf,fd->bsd", h, w_down)

    x = A_x
    x = x + _A_ref(_layernorm(x, axis=-1), A_wqkv, A_wo)
    x = x + _B_ref(_layernorm(x, axis=-1), B_w_gate, B_w_up, B_w_down)
    x = x + _A_ref(_layernorm(x, axis=-1), A_wqkv, A_wo)
    x = x + _B_ref(_layernorm(x, axis=-1), B_w_gate, B_w_up, B_w_down)
    return x
```

```asm
; @launch grid=(256,1,1) block=(256,1,1) lds=163840
.amdgcn_target "amdgcn-amd-amdhsa--gfx950"
.text
.globl interleave_layers__sliding_local_dilated__glu_gated_glu__prompt_kernel
.p2align 8
.type interleave_layers__sliding_local_dilated__glu_gated_glu__prompt_kernel,@function
interleave_layers__sliding_local_dilated__glu_gated_glu__prompt_kernel:
  s_cmp_ge_u32 s2, 256
  s_cbranch_scc1 L_end
  s_load_dwordx16 s[72:87], s[0:1], 0
  s_load_dwordx4 s[88:91], s[0:1], 64
  s_getreg_b32 s68, hwreg(HW_REG_XCC_ID, 0, 4)
  v_lshrrev_b32 v1, 6, v0
  v_and_b32 v0, 63, v0
  v_readfirstlane_b32 s39, v1
  s_getpc_b64 s[92:93]
L_pc_1:
  s_sub_u32 s92, s92, L_pc_1-interleave_layers__sliding_local_dilated__glu_gated_glu__prompt_kernel
  s_subb_u32 s93, s93, 0
  s_and_b32 s93, s93, 65535
  s_mov_b32 s94, L_codeend-interleave_layers__sliding_local_dilated__glu_gated_glu__prompt_kernel
  s_mov_b32 s95, 131072
  s_lshr_b32 s65, s2, 3
  s_mul_i32 s65, s65, 2048
  s_mul_i32 s67, s39, 512
  s_add_u32 s65, s65, s67
  v_lshlrev_b32 v14, 7, v0
  v_mov_b32 v13, 2147483648
  v_cmp_gt_u32 vcc, 4, v0
  s_nop 1
  v_cndmask_b32 v14, v13, v14, vcc
  s_mov_b32 m0, 159744
  s_nop 0
  buffer_load_dword v14, s[92:95], s65 offen lds
  s_and_b32 s54, s2, 7
  s_lshr_b32 s55, s2, 3
  s_and_b32 s41, s55, 15
  s_lshr_b32 s55, s55, 4
  s_lshl_b32 s54, s54, 1
  s_add_u32 s40, s54, s55
  s_lshr_b32 s45, s40, 3
  s_and_b32 s44, s40, 7
  s_lshr_b32 s42, s41, 3
  s_and_b32 s43, s41, 7
  s_mov_b32 s38, 1
  s_lshr_b32 s54, s39, 1
  s_cmp_eq_u32 s54, 0
  s_cselect_b32 s46, -1, 0
  s_cselect_b32 s47, 0, -1
  s_lshl_b32 s54, s42, 1
  s_lshl_b32 s55, s39, 4
  s_add_u32 s54, s54, s55
  s_mov_b32 s48, 13107
  s_mov_b32 s49, 0
  s_lshl_b64 s[48:49], s[48:49], s54
  s_mov_b32 s52, 0
  s_mov_b32 s53, -1
  s_mul_i32 s50, s40, 8192
  s_mul_i32 s51, s40, 8192
  s_mul_i32 s67, s41, 32
  s_add_u32 s51, s51, s67
  s_mul_i32 s67, s39, 8
  s_add_u32 s51, s51, s67
  s_and_b32 s64, s41, 1
  s_and_b32 s65, s40, 1
  s_lshr_b32 s66, s41, 1
  s_and_b32 s63, s2, 7
  s_mul_i32 s58, s65, 4
  s_mul_i32 s67, s63, 1
  s_add_u32 s58, s58, s67
  v_lshrrev_b32 v13, 4, v0
  v_lshlrev_b32 v13, 4, v13
  v_lshrrev_b32 v1, 3, v0
  v_lshlrev_b32 v1, 11, v1
  v_bfe_u32 v15, v0, 0, 3
  v_lshl_add_u32 v1, v15, 4, v1
  v_xor_b32 v1, v1, v13
  v_xor_b32 v7, 64, v1
  s_mul_i32 s54, s44, 262144
  s_mul_i32 s67, s45, 1024
  s_add_u32 s54, s54, s67
  s_mul_i32 s67, s39, 65536
  s_add_u32 s54, s54, s67
  v_lshrrev_b32 v2, 2, v0
  v_mul_u32_u24 v2, 3072, v2
  v_bfe_u32 v15, v0, 0, 2
  v_lshl_add_u32 v2, v15, 4, v2
  s_mul_i32 s55, s41, 64
  s_mul_i32 s67, s39, 49152
  s_add_u32 s55, s55, s67
  s_mul_i32 s56, s39, 1024
  s_mul_i32 s57, s39, 10240
  s_add_u32 s57, s57, 98304
  s_mul_i32 s63, s39, 4096
  s_add_u32 s63, s63, 139264
  v_lshlrev_b32 v8, 4, v0
  v_lshlrev_b32 v40, 7, v0
  v_mov_b32 v13, 2147483648
  v_cmp_gt_u32 vcc, 12, v0
  v_cmp_gt_u32 s[96:97], 4, v0
  v_bfe_u32 v43, v0, 0, 2
  v_lshlrev_b32 v43, 7, v43
  v_bfe_u32 v15, v0, 2, 1
  v_lshl_add_u32 v43, v15, 12, v43
  v_bfe_u32 v15, v0, 3, 1
  v_mul_u32_u24 v15, 12800, v15
  v_add_u32 v43, v43, v15
  v_cndmask_b32 v41, v13, v40, vcc
  v_cndmask_b32 v42, v13, v40, s[96:97]
  v_cndmask_b32 v43, v13, v43, vcc
  s_mul_i32 s98, s2, 6144
  s_mul_i32 s67, s39, 1536
  s_add_u32 s98, s98, s67
  s_mul_i32 s99, s44, 262144
  s_mul_i32 s67, s45, 1024
  s_add_u32 s99, s99, s67
  s_mul_i32 s67, s41, 16384
  s_add_u32 s99, s99, s67
  s_mul_i32 s67, s39, 4096
  s_add_u32 s99, s99, s67
  s_and_b32 s64, s41, 1
  s_mul_i32 s100, s44, 262144
  s_mul_i32 s67, s45, 1024
  s_add_u32 s100, s100, s67
  s_mul_i32 s67, s64, 8192
  s_add_u32 s100, s100, s67
  s_mul_i32 s67, s39, 2048
  s_add_u32 s100, s100, s67
  s_add_u32 s100, s100, -16384
  s_cmp_eq_u32 s44, 0
  s_cselect_b32 s100, 2147483648, s100
  s_mul_i32 s101, s2, 2048
  s_mul_i32 s67, s39, 512
  s_add_u32 s101, s101, s67
  s_mul_i32 s65, s41, 4096
  s_add_u32 s65, s65, 131072
  v_lshlrev_b32 v44, 10, v0
  s_lshr_b32 s64, s2, 3
  v_cndmask_b32 v45, v13, v44, s[96:97]
  v_cndmask_b32 v44, v13, v44, vcc
  s_mul_i32 s96, s64, 49152
  s_mul_i32 s67, s39, 12288
  s_add_u32 s96, s96, s67
  s_add_u32 s96, s96, 384
  s_mul_i32 s97, s64, 16384
  s_mul_i32 s67, s39, 4096
  s_add_u32 s97, s97, s67
  s_add_u32 s97, s97, 384
  s_mul_i32 s66, s40, 16384
  s_add_u32 s66, s66, 286720
  s_mov_b32 m0, 159744
  s_mov_b32 s6, 2097152
  s_mov_b32 s7, 131072
  s_mov_b32 s10, 1572864
  s_mov_b32 s11, 131072
  s_mov_b32 s14, 524288
  s_mov_b32 s15, 131072
  s_mov_b32 s18, 1835008
  s_mov_b32 s19, 131072
  s_mov_b32 s22, 1835008
  s_mov_b32 s23, 131072
  s_mov_b32 s26, 1835008
  s_mov_b32 s27, 131072
  s_mov_b32 s30, 2097152
  s_mov_b32 s31, 131072
  s_mov_b32 s34, 268435456
  s_mov_b32 s35, 131072
  s_waitcnt lgkmcnt(0)
  s_mov_b64 s[4:5], s[72:73]
  s_mov_b64 s[8:9], s[74:75]
  s_mov_b64 s[12:13], s[76:77]
  s_mov_b64 s[16:17], s[80:81]
  s_mov_b64 s[20:21], s[82:83]
  s_mov_b64 s[24:25], s[84:85]
  s_mov_b64 s[28:29], s[86:87]
  s_mov_b64 s[32:33], s[90:91]
  buffer_load_dword v44, s[8:11], s96 offen lds
  buffer_load_dwordx4 v[16:19], v8, s[4:7], s99 offen
  buffer_load_dwordx4 v[20:23], v8, s[4:7], s99 offen offset:2048
  buffer_load_dwordx4 v[24:27], v8, s[4:7], s100 offen
  buffer_load_dword v42, s[12:15], s101 offen lds
  buffer_load_dword v45, s[12:15], s97 offen lds
  buffer_load_dword v43, s[32:35], s50 offen lds
  buffer_load_dword v42, s[32:35], s65 offen lds
  buffer_load_dword v42, s[32:35], s66 offen lds
  v_lshlrev_b32 v8, 4, v0
  v_lshlrev_b32 v222, 3, v0
  v_lshrrev_b32 v3, 5, v0
  v_lshlrev_b32 v3, 9, v3
  v_bfe_u32 v15, v0, 2, 2
  v_lshl_add_u32 v3, v15, 6, v3
  v_bfe_u32 v15, v0, 4, 1
  v_lshl_add_u32 v3, v15, 5, v3
  v_bfe_u32 v15, v0, 0, 1
  v_lshl_add_u32 v3, v15, 4, v3
  v_bfe_u32 v15, v0, 1, 1
  v_lshl_add_u32 v3, v15, 3, v3
  v_add_u32 v4, 65536, v3
  s_and_b32 s64, s39, 1
  s_lshr_b32 s65, s39, 1
  s_mul_i32 s66, s64, 32
  s_mul_i32 s67, s65, 32768
  s_add_u32 s66, s66, s67
  v_lshrrev_b32 v5, 4, v0
  v_lshlrev_b32 v5, 9, v5
  v_bfe_u32 v15, v0, 2, 2
  v_lshl_add_u32 v5, v15, 6, v5
  v_bfe_u32 v15, v0, 0, 2
  v_lshl_add_u32 v5, v15, 3, v5
  v_add_u32 v5, s66, v5
  s_and_b32 s64, s39, 1
  s_mul_i32 s65, s64, 32
  s_add_u32 s65, s65, 65536
  v_lshrrev_b32 v185, 4, v0
  v_lshlrev_b32 v185, 9, v185
  v_bfe_u32 v15, v0, 2, 2
  v_lshl_add_u32 v185, v15, 6, v185
  v_bfe_u32 v15, v0, 0, 2
  v_lshl_add_u32 v185, v15, 3, v185
  v_add_u32 v185, s65, v185
  v_bfe_u32 v13, v0, 1, 3
  v_lshlrev_b32 v13, 4, v13
  v_lshrrev_b32 v14, 5, v0
  v_lshlrev_b32 v14, 4, v14
  v_xor_b32 v13, v13, v14
  v_bfe_u32 v14, v0, 0, 5
  v_lshlrev_b32 v14, 7, v14
  s_add_u32 s64, s57, 4096
  v_xor_b32 v176, 0, v13
  v_add_u32 v176, v176, v14
  v_add_u32 v172, s63, v176
  v_add_u32 v176, s64, v176
  v_xor_b32 v177, 32, v13
  v_add_u32 v177, v177, v14
  v_add_u32 v173, s63, v177
  v_add_u32 v177, s64, v177
  v_xor_b32 v178, 64, v13
  v_add_u32 v178, v178, v14
  v_add_u32 v174, s63, v178
  v_add_u32 v178, s64, v178
  v_xor_b32 v179, 96, v13
  v_add_u32 v179, v179, v14
  v_add_u32 v175, s63, v179
  v_add_u32 v179, s64, v179
  v_bfe_u32 v6, v0, 1, 2
  v_mul_u32_u24 v6, 10240, v6
  v_bfe_u32 v15, v0, 0, 1
  v_lshl_add_u32 v6, v15, 10, v6
  v_lshrrev_b32 v15, 4, v0
  v_lshl_add_u32 v6, v15, 4, v6
  v_add_u32 v6, 106560, v6
  v_bfe_u32 v13, v0, 3, 1
  v_lshlrev_b32 v13, 6, v13
  v_sub_u32 v6, v6, v13
  v_bfe_u32 v14, v0, 4, 1
  v_add_u32 v14, s39, v14
  v_and_b32 v14, 3, v14
  v_lshlrev_b32 v14, 5, v14
  v_bfe_u32 v13, v0, 3, 1
  v_lshlrev_b32 v13, 6, v13
  v_xor_b32 v14, v14, v13
  v_lshrrev_b32 v217, 5, v0
  v_lshlrev_b32 v217, 9, v217
  v_bfe_u32 v15, v0, 2, 2
  v_lshl_add_u32 v217, v15, 7, v217
  v_bfe_u32 v15, v0, 0, 1
  v_lshl_add_u32 v217, v15, 4, v217
  v_bfe_u32 v15, v0, 1, 1
  v_lshl_add_u32 v217, v15, 3, v217
  v_add_u32 v217, v217, v14
  v_add_u32 v217, s57, v217
  v_xor_b32 v218, 64, v217
  v_bfe_u32 v14, v0, 4, 1
  v_lshlrev_b32 v14, 6, v14
  v_lshrrev_b32 v13, 3, v0
  v_lshlrev_b32 v13, 10, v13
  v_bfe_u32 v15, v0, 0, 3
  v_lshl_add_u32 v13, v15, 4, v13
  v_xor_b32 v216, v13, v14
  s_mul_i32 s60, s39, 131072
  s_mul_i32 s67, s43, 128
  s_add_u32 s60, s60, s67
  v_add_u32 v219, s57, v8
  s_mul_i32 s64, s39, 1024
  s_add_u32 s64, s64, 141312
  v_bfe_u32 v9, v0, 0, 5
  v_lshlrev_b32 v9, 5, v9
  v_lshrrev_b32 v15, 5, v0
  v_lshl_add_u32 v9, v15, 4, v9
  v_add_u32 v9, 512, v9
  v_add_u32 v9, s64, v9
  v_bfe_u32 v11, v0, 0, 4
  v_lshlrev_b32 v11, 5, v11
  v_lshrrev_b32 v15, 4, v0
  v_lshl_add_u32 v11, v15, 3, v11
  s_mul_i32 s65, s39, 4608
  s_add_u32 s65, s65, 141312
  v_add_u32 v10, s65, v11
  v_add_u32 v11, s64, v11
  v_lshlrev_b32 v12, 3, v0
  v_add_u32 v12, 9216, v12
  v_add_u32 v12, s64, v12
  v_and_b32 v13, 15, v0
  v_lshrrev_b32 v14, 4, v0
  v_lshlrev_b32 v14, 2, v14
  v_sub_u32 v13, v13, v14
  v_mov_b32 v64, 4286578688
  v_mov_b32 v65, 0
  s_add_u32 s66, s44, s39
  s_cmp_eq_u32 s66, 0
  s_cselect_b64 s[64:65], -1, 0
  v_subrev_u32 v14, 0, v13
  v_cmp_gt_u32 vcc, 8, v14
  v_cmp_gt_i32 s[66:67], -8, v14
  s_nop 0
  v_cndmask_b32 v116, v64, v65, vcc
  v_cndmask_b32 v120, v64, v65, s[66:67]
  v_cndmask_b32 v124, v120, v64, s[64:65]
  v_subrev_u32 v14, 1, v13
  v_cmp_gt_u32 vcc, 8, v14
  v_cmp_gt_i32 s[66:67], -8, v14
  s_nop 0
  v_cndmask_b32 v117, v64, v65, vcc
  v_cndmask_b32 v121, v64, v65, s[66:67]
  v_cndmask_b32 v125, v121, v64, s[64:65]
  v_subrev_u32 v14, 2, v13
  v_cmp_gt_u32 vcc, 8, v14
  v_cmp_gt_i32 s[66:67], -8, v14
  s_nop 0
  v_cndmask_b32 v118, v64, v65, vcc
  v_cndmask_b32 v122, v64, v65, s[66:67]
  v_cndmask_b32 v126, v122, v64, s[64:65]
  v_subrev_u32 v14, 3, v13
  v_cmp_gt_u32 vcc, 8, v14
  v_cmp_gt_i32 s[66:67], -8, v14
  s_nop 0
  v_cndmask_b32 v119, v64, v65, vcc
  v_cndmask_b32 v123, v64, v65, s[66:67]
  v_cndmask_b32 v127, v123, v64, s[64:65]
  v_subrev_u32 v14, 0, v13
  v_subrev_u32 v15, 1, v13
  v_ashrrev_i32 v14, 31, v14
  v_ashrrev_i32 v15, 31, v15
  v_and_b32 v14, 65535, v14
  v_lshl_or_b32 v130, v15, 16, v14
  v_not_b32 v128, v130
  v_subrev_u32 v14, 2, v13
  v_subrev_u32 v15, 3, v13
  v_ashrrev_i32 v14, 31, v14
  v_ashrrev_i32 v15, 31, v15
  v_and_b32 v14, 65535, v14
  v_lshl_or_b32 v131, v15, 16, v14
  v_not_b32 v129, v131
  v_mov_b32 v82, 0
  v_mov_b32 v83, 0
  v_mov_b32 v85, 0
  v_mov_b32 v86, 0
  v_mov_b32 v87, 0
  v_mov_b32 v77, 0
  v_mov_b32 v79, 0
  v_mov_b32 v81, 0
  v_mov_b32 v136, 1065369472
  v_mov_b32 v137, 1065369472
  v_mov_b32 v138, 1065369472
  v_mov_b32 v139, 1065369472
  s_load_dwordx2 s[36:37], s[32:33], 196608
  s_add_u32 s59, s58, 0
  s_and_b32 s59, s59, 7
  s_lshl_b32 s64, s59, 7
  s_add_u32 m0, s63, 0
  s_add_u32 s64, s64, s54
  buffer_load_dwordx4 v1, s[4:7], s64 offen lds
  s_add_u32 m0, s63, 1024
  s_add_u32 s64, s64, 16384
  buffer_load_dwordx4 v7, s[4:7], s64 offen lds
  s_add_u32 m0, s63, 2048
  s_add_u32 s64, s64, 16384
  buffer_load_dwordx4 v1, s[4:7], s64 offen lds
  s_add_u32 m0, s63, 3072
  s_add_u32 s64, s64, 16384
  buffer_load_dwordx4 v7, s[4:7], s64 offen lds
  s_add_u32 s59, s58, 0
  s_and_b32 s59, s59, 7
  s_mul_i32 s66, s59, 196608
  s_lshl_b32 s65, s59, 12
  s_add_u32 s65, s65, s56
  s_add_u32 m0, s65, 65536
  s_add_u32 s66, s66, s55
  buffer_load_dwordx4 v2, s[8:11], s66 offen lds
  s_add_u32 m0, s65, 0
  s_add_u32 s66, s66, 1024
  buffer_load_dwordx4 v2, s[8:11], s66 offen lds
  s_add_u32 m0, s65, 32768
  s_add_u32 s66, s66, 1024
  buffer_load_dwordx4 v2, s[8:11], s66 offen lds
  s_mul_i32 s64, s44, 262144
  s_mul_i32 s67, s45, 1024
  s_add_u32 s64, s64, s67
  s_mul_i32 s67, s39, 4096
  s_add_u32 s64, s64, s67
  s_add_u32 s64, s64, -16384
  s_cmp_eq_u32 s44, 0
  s_cselect_b32 s64, 2147483648, s64
  s_add_u32 m0, s57, 8192
  s_nop 0
  buffer_load_dwordx4 v8, s[4:7], s64 offen lds
  s_add_u32 m0, s57, 7168
  s_nop 0
  buffer_load_dwordx4 v8, s[4:7], s64 offen offset:2048 lds
  v_mov_b32 v32, 0
  v_mov_b32 v33, 0
  v_mov_b32 v34, 0
  v_mov_b32 v35, 0
  v_mov_b32 v36, 0
  v_mov_b32 v37, 0
  v_lshrrev_b32 v14, 4, v0
  v_lshlrev_b32 v14, 3, v14
  v_bfe_u32 v15, v0, 0, 2
  v_lshl_add_u32 v14, v15, 5, v14
  s_mul_i32 s64, s40, 8192
  s_mul_i32 s67, s41, 512
  s_add_u32 s64, s64, s67
  s_mul_i32 s67, s39, 128
  s_add_u32 s64, s64, s67
  s_add_u32 s64, s64, 3145728
  s_waitcnt vmcnt(16)
  v_dot2c_f32_bf16 v32, v16, v136
  v_dot2c_f32_bf16 v34, v16, v16
  s_waitcnt vmcnt(15)
  v_dot2c_f32_bf16 v33, v20, v136
  v_dot2c_f32_bf16 v35, v20, v20
  s_waitcnt vmcnt(14)
  v_dot2c_f32_bf16 v36, v24, v136
  v_dot2c_f32_bf16 v37, v24, v24
  v_dot2c_f32_bf16 v32, v17, v136
  v_dot2c_f32_bf16 v34, v17, v17
  v_dot2c_f32_bf16 v33, v21, v136
  v_dot2c_f32_bf16 v35, v21, v21
  v_dot2c_f32_bf16 v36, v25, v136
  v_dot2c_f32_bf16 v37, v25, v25
  v_dot2c_f32_bf16 v32, v18, v136
  v_dot2c_f32_bf16 v34, v18, v18
  v_dot2c_f32_bf16 v33, v22, v136
  v_dot2c_f32_bf16 v35, v22, v22
  v_dot2c_f32_bf16 v36, v26, v136
  v_dot2c_f32_bf16 v37, v26, v26
  v_dot2c_f32_bf16 v32, v19, v136
  v_dot2c_f32_bf16 v34, v19, v19
  v_dot2c_f32_bf16 v33, v23, v136
  v_dot2c_f32_bf16 v35, v23, v23
  v_dot2c_f32_bf16 v36, v27, v136
  v_dot2c_f32_bf16 v37, v27, v27
  v_permlane32_swap_b32 v32, v33
  v_permlane32_swap_b32 v34, v35
  s_nop 0
  v_permlane32_swap_b32 v36, v37
  v_add_f32 v32, v32, v33
  v_add_f32 v34, v34, v35
  v_add_f32 v36, v36, v37
  v_mov_b32 v37, v36
  v_permlane16_swap_b32 v32, v34
  s_nop 0
  v_permlane16_swap_b32 v36, v37
  v_add_f32 v32, v32, v34
  v_add_f32 v33, v36, v37
  s_nop 0
  v_add_f32_dpp v32, v32, v32 row_ror:8 row_mask:0xf bank_mask:0xf
  v_add_f32_dpp v33, v33, v33 row_ror:8 row_mask:0xf bank_mask:0xf
  s_nop 0
  v_add_f32_dpp v32, v32, v32 row_ror:4 row_mask:0xf bank_mask:0xf
  v_add_f32_dpp v33, v33, v33 row_ror:4 row_mask:0xf bank_mask:0xf
  s_nop 0
  v_add_f32_dpp v32, v32, v32 row_ror:2 row_mask:0xf bank_mask:0xf
  v_add_f32_dpp v33, v33, v33 row_ror:2 row_mask:0xf bank_mask:0xf
  s_nop 0
  v_add_f32_dpp v32, v32, v32 row_ror:1 row_mask:0xf bank_mask:0xf
  v_add_f32_dpp v33, v33, v33 row_ror:1 row_mask:0xf bank_mask:0xf
  buffer_store_dwordx2 v[32:33], v14, s[32:35], s64 offen sc1
  s_add_u32 s59, s58, 1
  s_and_b32 s59, s59, 7
  s_lshl_b32 s64, s59, 7
  s_add_u32 m0, s57, 4096
  s_add_u32 s64, s64, s54
  buffer_load_dwordx4 v1, s[4:7], s64 offen lds
  s_add_u32 m0, s57, 5120
  s_add_u32 s64, s64, 16384
  buffer_load_dwordx4 v7, s[4:7], s64 offen lds
  s_add_u32 m0, s57, 6144
  s_add_u32 s64, s64, 16384
  buffer_load_dwordx4 v1, s[4:7], s64 offen lds
  s_add_u32 m0, s57, 7168
  s_add_u32 s64, s64, 16384
  buffer_load_dwordx4 v7, s[4:7], s64 offen lds
  s_add_u32 s59, s58, 1
  s_and_b32 s59, s59, 7
  s_mul_i32 s66, s59, 196608
  s_lshl_b32 s65, s59, 12
  s_add_u32 s65, s65, s56
  s_add_u32 m0, s65, 65536
  s_add_u32 s66, s66, s55
  buffer_load_dwordx4 v2, s[8:11], s66 offen lds
  s_add_u32 m0, s65, 0
  s_add_u32 s66, s66, 1024
  buffer_load_dwordx4 v2, s[8:11], s66 offen lds
  s_add_u32 m0, s65, 32768
  s_add_u32 s66, s66, 1024
  buffer_load_dwordx4 v2, s[8:11], s66 offen lds
  s_add_u32 s62, s58, 0
  s_and_b32 s62, s62, 7
  s_lshl_b32 s61, s62, 12
  s_lshl_b32 s62, s62, 7
  v_add_u32 v180, s61, v3
  v_add_u32 v181, s61, v4
  v_add_u32 v182, s61, v5
  v_add_u32 v183, s61, v185
  v_add_u32 v184, s62, v6
  s_waitcnt vmcnt(13)
  ds_read_b128 v[140:143], v172
  ds_read_b128 v[144:147], v173
  ds_read_b128 v[148:151], v174
  ds_read_b128 v[152:155], v175
  s_waitcnt vmcnt(8) lgkmcnt(0)
  s_barrier
  ds_read_b128 v[188:191], v184
  ds_read_b64_tr_b16 v[92:93], v180 offset:0
  ds_read_b64_tr_b16 v[94:95], v180 offset:256
  ds_read_b64_tr_b16 v[96:97], v180 offset:32768
  ds_read_b64_tr_b16 v[98:99], v180 offset:33024
  ds_read_b64_tr_b16 v[100:101], v181 offset:0
  ds_read_b64_tr_b16 v[102:103], v181 offset:256
  s_waitcnt lgkmcnt(4)
  v_mfma_f32_32x32x16_bf16 v[16:31], v[92:95], v[140:143], 0
  ds_read_b64_tr_b16 v[104:105], v180 offset:1024
  ds_read_b64_tr_b16 v[106:107], v180 offset:1280
  ds_read_b64_tr_b16 v[108:109], v182 offset:0
  ds_read_b64_tr_b16 v[110:111], v182 offset:256
  ds_read_b64_tr_b16 v[112:113], v183 offset:0
  ds_read_b64_tr_b16 v[114:115], v183 offset:256
  s_waitcnt lgkmcnt(8)
  v_mfma_f32_32x32x16_bf16 v[32:47], v[96:99], v[140:143], 0
  ds_read_b64_tr_b16 v[92:93], v180 offset:33792
  ds_read_b64_tr_b16 v[94:95], v180 offset:34048
  s_waitcnt lgkmcnt(8)
  v_mfma_f32_32x32x16_bf16 v[48:63], v[100:103], v[140:143], 0
  ds_read_b64_tr_b16 v[96:97], v181 offset:1024
  ds_read_b64_tr_b16 v[98:99], v181 offset:1280
  s_add_u32 s59, s58, 2
  s_and_b32 s59, s59, 7
  s_lshl_b32 s64, s59, 7
  s_add_u32 m0, s63, 0
  s_waitcnt lgkmcnt(8)
  v_mfma_f32_32x32x16_bf16 v[16:31], v[104:107], v[144:147], v[16:31]
  ds_read_b64_tr_b16 v[100:101], v180 offset:2048
  ds_read_b64_tr_b16 v[102:103], v180 offset:2304
  s_add_u32 s64, s64, s54
  buffer_load_dwordx4 v1, s[4:7], s64 offen lds
  s_add_u32 m0, s63, 1024
  s_waitcnt lgkmcnt(4)
  v_mfma_f32_32x32x16_bf16 v[32:47], v[92:95], v[144:147], v[32:47]
  ds_read_b64_tr_b16 v[104:105], v180 offset:34816
  ds_read_b64_tr_b16 v[106:107], v180 offset:35072
  s_add_u32 s64, s64, 16384
  buffer_load_dwordx4 v7, s[4:7], s64 offen lds
  v_mfma_f32_16x16x32_bf16 v[72:75], v[108:111], v[136:139], 0
  v_mfma_f32_16x16x32_bf16 v[192:195], v[112:115], v[136:139], 0
  v_mfma_f32_16x16x32_bf16 v[64:67], v[108:111], v[188:191], 0
  s_add_u32 m0, s63, 2048
  s_add_u32 s64, s64, 16384
  s_waitcnt lgkmcnt(4)
  v_mfma_f32_32x32x16_bf16 v[48:63], v[96:99], v[144:147], v[48:63]
  ds_read_b64_tr_b16 v[92:93], v181 offset:2048
  ds_read_b64_tr_b16 v[94:95], v181 offset:2304
  ds_read_b64_tr_b16 v[108:109], v182 offset:2048
  ds_read_b64_tr_b16 v[110:111], v182 offset:2304
  ds_read_b64_tr_b16 v[112:113], v183 offset:2048
  ds_read_b64_tr_b16 v[114:115], v183 offset:2304
  s_waitcnt lgkmcnt(8)
  v_mfma_f32_32x32x16_bf16 v[16:31], v[100:103], v[148:151], v[16:31]
  ds_read_b64_tr_b16 v[96:97], v180 offset:3072
  ds_read_b64_tr_b16 v[98:99], v180 offset:3328
  buffer_load_dwordx4 v1, s[4:7], s64 offen lds
  s_add_u32 m0, s63, 3072
  s_add_u32 s64, s64, 16384
  s_waitcnt lgkmcnt(8)
  v_mfma_f32_32x32x16_bf16 v[32:47], v[104:107], v[148:151], v[32:47]
  ds_read_b64_tr_b16 v[100:101], v180 offset:35840
  ds_read_b64_tr_b16 v[102:103], v180 offset:36096
  buffer_load_dwordx4 v7, s[4:7], s64 offen lds
  s_add_u32 s59, s58, 2
  s_and_b32 s59, s59, 7
  s_waitcnt lgkmcnt(8)
  v_mfma_f32_32x32x16_bf16 v[48:63], v[92:95], v[148:151], v[48:63]
  ds_read_b64_tr_b16 v[104:105], v181 offset:3072
  ds_read_b64_tr_b16 v[106:107], v181 offset:3328
  s_mul_i32 s66, s59, 196608
  s_lshl_b32 s65, s59, 12
  s_add_u32 s65, s65, s56
  s_waitcnt lgkmcnt(8)
  v_mfma_f32_16x16x32_bf16 v[72:75], v[108:111], v[136:139], v[72:75]
  s_waitcnt lgkmcnt(6)
  v_mfma_f32_16x16x32_bf16 v[192:195], v[112:115], v[136:139], v[192:195]
  v_mfma_f32_16x16x32_bf16 v[68:71], v[108:111], v[188:191], 0
  s_waitcnt vmcnt(7)
  ds_read_b128 v[156:159], v176
  ds_read_b128 v[160:163], v177
  ds_read_b128 v[164:167], v178
  ds_read_b128 v[168:171], v179
  s_waitcnt lgkmcnt(8)
  v_mfma_f32_32x32x16_bf16 v[16:31], v[96:99], v[152:155], v[16:31]
  s_add_u32 s62, s58, 1
  s_and_b32 s62, s62, 7
  s_lshl_b32 s61, s62, 12
  s_lshl_b32 s62, s62, 7
  v_add_u32 v180, s61, v3
  v_add_u32 v181, s61, v4
  v_add_u32 v182, s61, v5
  v_add_u32 v183, s61, v185
  v_add_u32 v184, s62, v6
  s_waitcnt vmcnt(4)
  s_barrier
  ds_read_b64_tr_b16 v[92:93], v180 offset:0
  ds_read_b64_tr_b16 v[94:95], v180 offset:256
  s_add_u32 m0, s65, 65536
  s_add_u32 s66, s66, s55
  buffer_load_dwordx4 v2, s[8:11], s66 offen lds
  s_waitcnt lgkmcnt(8)
  v_mfma_f32_32x32x16_bf16 v[32:47], v[100:103], v[152:155], v[32:47]
  ds_read_b64_tr_b16 v[96:97], v180 offset:32768
  ds_read_b64_tr_b16 v[98:99], v180 offset:33024
  ds_read_b128 v[188:191], v184
  s_add_u32 m0, s65, 0
  s_add_u32 s66, s66, 1024
  buffer_load_dwordx4 v2, s[8:11], s66 offen lds
  s_waitcnt lgkmcnt(9)
  v_mfma_f32_32x32x16_bf16 v[48:63], v[104:107], v[152:155], v[48:63]
  ds_read_b64_tr_b16 v[100:101], v181 offset:0
  ds_read_b64_tr_b16 v[102:103], v181 offset:256
  s_add_u32 m0, s65, 32768
  s_add_u32 s66, s66, 1024
  buffer_load_dwordx4 v2, s[8:11], s66 offen lds
  s_lshr_b32 s64, s41, 1
  s_and_b32 s3, s64, 3
  s_cmp_lg_u32 s3, 0
  s_cbranch_scc1 L_skip_2
  v_lshrrev_b32 v14, 3, v0
  v_mul_u32_u24 v14, 3584, v14
  v_bfe_u32 v15, v0, 0, 3
  v_lshl_add_u32 v14, v15, 4, v14
  s_lshr_b32 s64, s39, 1
  s_and_b32 s65, s39, 1
  s_mul_i32 s66, s40, 114688
  s_mul_i32 s67, s64, 57344
  s_add_u32 s66, s66, s67
  s_mul_i32 s67, s41, 224
  s_add_u32 s66, s66, s67
  s_mul_i32 s67, s65, 128
  s_add_u32 s66, s66, s67
  s_add_u32 s65, s66, 28672
  buffer_load_dwordx4 v[196:199], v14, s[16:19], s66 offen
  buffer_load_dwordx4 v[200:203], v14, s[16:19], s65 offen
  buffer_load_dwordx4 v[204:207], v14, s[20:23], s66 offen
  buffer_load_dwordx4 v[208:211], v14, s[20:23], s65 offen
  v_mul_u32_u24 v14, 128, v0
  v_mov_b32 v13, 2147483648
  v_cmp_gt_u32 vcc, 14, v0
  s_mul_i32 s65, s2, 7168
  s_mul_i32 s67, s39, 1792
  s_add_u32 s65, s65, s67
  v_cndmask_b32 v14, v13, v14, vcc
  s_mov_b32 m0, 159744
  s_nop 0
  buffer_load_dword v14, s[24:27], s65 offen lds
L_skip_2:
  s_nop 1
  s_waitcnt lgkmcnt(5)
  v_mfma_f32_32x32x16_bf16 v[16:31], v[92:95], v[156:159], v[16:31]
  ds_read_b64_tr_b16 v[104:105], v180 offset:1024
  ds_read_b64_tr_b16 v[106:107], v180 offset:1280
  ds_read_b64_tr_b16 v[108:109], v182 offset:0
  ds_read_b64_tr_b16 v[110:111], v182 offset:256
  ds_read_b64_tr_b16 v[112:113], v183 offset:0
  ds_read_b64_tr_b16 v[114:115], v183 offset:256
  s_waitcnt lgkmcnt(9)
  v_mfma_f32_32x32x16_bf16 v[32:47], v[96:99], v[156:159], v[32:47]
  ds_read_b64_tr_b16 v[92:93], v180 offset:33792
  ds_read_b64_tr_b16 v[94:95], v180 offset:34048
  s_waitcnt lgkmcnt(8)
  v_mfma_f32_32x32x16_bf16 v[48:63], v[100:103], v[156:159], v[48:63]
  ds_read_b64_tr_b16 v[96:97], v181 offset:1024
  ds_read_b64_tr_b16 v[98:99], v181 offset:1280
  s_add_u32 s59, s58, 3
  s_and_b32 s59, s59, 7
  s_lshl_b32 s64, s59, 7
  s_add_u32 m0, s57, 4096
  s_waitcnt lgkmcnt(8)
  v_mfma_f32_32x32x16_bf16 v[16:31], v[104:107], v[160:163], v[16:31]
  ds_read_b64_tr_b16 v[100:101], v180 offset:2048
  ds_read_b64_tr_b16 v[102:103], v180 offset:2304
  s_add_u32 s64, s64, s54
  buffer_load_dwordx4 v1, s[4:7], s64 offen lds
  s_add_u32 m0, s57, 5120
  s_waitcnt lgkmcnt(4)
  v_mfma_f32_32x32x16_bf16 v[32:47], v[92:95], v[160:163], v[32:47]
  ds_read_b64_tr_b16 v[104:105], v180 offset:34816
  ds_read_b64_tr_b16 v[106:107], v180 offset:35072
  s_add_u32 s64, s64, 16384
  buffer_load_dwordx4 v7, s[4:7], s64 offen lds
  v_mfma_f32_16x16x32_bf16 v[72:75], v[108:111], v[136:139], v[72:75]
  v_mfma_f32_16x16x32_bf16 v[192:195], v[112:115], v[136:139], v[192:195]
  v_mfma_f32_16x16x32_bf16 v[64:67], v[108:111], v[188:191], v[64:67]
  s_add_u32 m0, s57, 6144
  s_add_u32 s64, s64, 16384
  s_waitcnt lgkmcnt(4)
  v_mfma_f32_32x32x16_bf16 v[48:63], v[96:99], v[160:163], v[48:63]
  ds_read_b64_tr_b16 v[92:93], v181 offset:2048
  ds_read_b64_tr_b16 v[94:95], v181 offset:2304
  ds_read_b64_tr_b16 v[108:109], v182 offset:2048
  ds_read_b64_tr_b16 v[110:111], v182 offset:2304
  ds_read_b64_tr_b16 v[112:113], v183 offset:2048
  ds_read_b64_tr_b16 v[114:115], v183 offset:2304
  s_waitcnt lgkmcnt(8)
  v_mfma_f32_32x32x16_bf16 v[16:31], v[100:103], v[164:167], v[16:31]
  ds_read_b64_tr_b16 v[96:97], v180 offset:3072
  ds_read_b64_tr_b16 v[98:99], v180 offset:3328
  buffer_load_dwordx4 v1, s[4:7], s64 offen lds
  s_add_u32 m0, s57, 7168
  s_add_u32 s64, s64, 16384
  s_waitcnt lgkmcnt(8)
  v_mfma_f32_32x32x16_bf16 v[32:47], v[104:107], v[164:167], v[32:47]
  ds_read_b64_tr_b16 v[100:101], v180 offset:35840
  ds_read_b64_tr_b16 v[102:103], v180 offset:36096
  buffer_load_dwordx4 v7, s[4:7], s64 offen lds
  s_add_u32 s59, s58, 3
  s_and_b32 s59, s59, 7
  s_waitcnt lgkmcnt(8)
  v_mfma_f32_32x32x16_bf16 v[48:63], v[92:95], v[164:167], v[48:63]
  ds_read_b64_tr_b16 v[104:105], v181 offset:3072
  ds_read_b64_tr_b16 v[106:107], v181 offset:3328
  s_mul_i32 s66, s59, 196608
  s_lshl_b32 s65, s59, 12
  s_add_u32 s65, s65, s56
  s_waitcnt lgkmcnt(8)
  v_mfma_f32_16x16x32_bf16 v[72:75], v[108:111], v[136:139], v[72:75]
  s_waitcnt lgkmcnt(6)
  v_mfma_f32_16x16x32_bf16 v[192:195], v[112:115], v[136:139], v[192:195]
  v_mfma_f32_16x16x32_bf16 v[68:71], v[108:111], v[188:191], v[68:71]
  s_waitcnt vmcnt(7)
  ds_read_b128 v[140:143], v172
  ds_read_b128 v[144:147], v173
  ds_read_b128 v[148:151], v174
  ds_read_b128 v[152:155], v175
  s_waitcnt lgkmcnt(8)
  v_mfma_f32_32x32x16_bf16 v[16:31], v[96:99], v[168:171], v[16:31]
  s_add_u32 s62, s58, 2
  s_and_b32 s62, s62, 7
  s_lshl_b32 s61, s62, 12
  s_lshl_b32 s62, s62, 7
  v_add_u32 v180, s61, v3
  v_add_u32 v181, s61, v4
  v_add_u32 v182, s61, v5
  v_add_u32 v183, s61, v185
  v_add_u32 v184, s62, v6
  s_waitcnt vmcnt(4)
  s_barrier
  ds_read_b64_tr_b16 v[92:93], v180 offset:0
  ds_read_b64_tr_b16 v[94:95], v180 offset:256
  s_add_u32 m0, s65, 65536
  s_add_u32 s66, s66, s55
  buffer_load_dwordx4 v2, s[8:11], s66 offen lds
  s_waitcnt lgkmcnt(8)
  v_mfma_f32_32x32x16_bf16 v[32:47], v[100:103], v[168:171], v[32:47]
  ds_read_b64_tr_b16 v[96:97], v180 offset:32768
  ds_read_b64_tr_b16 v[98:99], v180 offset:33024
  ds_read_b128 v[188:191], v184
  s_add_u32 m0, s65, 0
  s_add_u32 s66, s66, 1024
  buffer_load_dwordx4 v2, s[8:11], s66 offen lds
  s_waitcnt lgkmcnt(9)
  v_mfma_f32_32x32x16_bf16 v[48:63], v[104:107], v[168:171], v[48:63]
  ds_read_b64_tr_b16 v[100:101], v181 offset:0
  ds_read_b64_tr_b16 v[102:103], v181 offset:256
  s_add_u32 m0, s65, 32768
  s_add_u32 s66, s66, 1024
  buffer_load_dwordx4 v2, s[8:11], s66 offen lds
  s_add_u32 s36, s36, 2135587861
  s_addc_u32 s37, s37, 2654435769
  s_and_b32 s64, s37, -16
  s_or_b32 s64, s64, s68
  v_mov_b32 v220, s36
  v_mov_b32 v221, s64
  s_add_u32 s65, s51, 4096
  s_mov_b64 exec, 1
  buffer_store_dwordx2 v[220:221], off, s[32:35], s65 sc1
  s_mov_b64 exec, -1
  s_cmp_lg_u32 s3, 1
  s_cbranch_scc1 L_skip_3
  v_lshrrev_b32 v14, 3, v0
  v_mul_u32_u24 v14, 3584, v14
  v_bfe_u32 v15, v0, 0, 3
  v_lshl_add_u32 v14, v15, 4, v14
  s_lshr_b32 s64, s39, 1
  s_and_b32 s65, s39, 1
  s_mul_i32 s66, s40, 114688
  s_mul_i32 s67, s64, 57344
  s_add_u32 s66, s66, s67
  s_mul_i32 s67, s41, 224
  s_add_u32 s66, s66, s67
  s_mul_i32 s67, s65, 128
  s_add_u32 s66, s66, s67
  s_add_u32 s65, s66, 28672
  buffer_load_dwordx4 v[196:199], v14, s[16:19], s66 offen
  buffer_load_dwordx4 v[200:203], v14, s[16:19], s65 offen
  buffer_load_dwordx4 v[204:207], v14, s[20:23], s66 offen
  buffer_load_dwordx4 v[208:211], v14, s[20:23], s65 offen
  v_mul_u32_u24 v14, 128, v0
  v_mov_b32 v13, 2147483648
  v_cmp_gt_u32 vcc, 14, v0
  s_mul_i32 s65, s2, 7168
  s_mul_i32 s67, s39, 1792
  s_add_u32 s65, s65, s67
  v_cndmask_b32 v14, v13, v14, vcc
  s_mov_b32 m0, 159744
  s_nop 0
  buffer_load_dword v14, s[24:27], s65 offen lds
L_skip_3:
  s_nop 1
  s_waitcnt lgkmcnt(5)
  v_mfma_f32_32x32x16_bf16 v[16:31], v[92:95], v[140:143], v[16:31]
  ds_read_b64_tr_b16 v[104:105], v180 offset:1024
  ds_read_b64_tr_b16 v[106:107], v180 offset:1280
  ds_read_b64_tr_b16 v[108:109], v182 offset:0
  ds_read_b64_tr_b16 v[110:111], v182 offset:256
  ds_read_b64_tr_b16 v[112:113], v183 offset:0
  ds_read_b64_tr_b16 v[114:115], v183 offset:256
  s_waitcnt lgkmcnt(9)
  v_mfma_f32_32x32x16_bf16 v[32:47], v[96:99], v[140:143], v[32:47]
  ds_read_b64_tr_b16 v[92:93], v180 offset:33792
  ds_read_b64_tr_b16 v[94:95], v180 offset:34048
  s_waitcnt lgkmcnt(8)
  v_mfma_f32_32x32x16_bf16 v[48:63], v[100:103], v[140:143], v[48:63]
  ds_read_b64_tr_b16 v[96:97], v181 offset:1024
  ds_read_b64_tr_b16 v[98:99], v181 offset:1280
  s_add_u32 s59, s58, 4
  s_and_b32 s59, s59, 7
  s_lshl_b32 s64, s59, 7
  s_add_u32 m0, s63, 0
  s_waitcnt lgkmcnt(8)
  v_mfma_f32_32x32x16_bf16 v[16:31], v[104:107], v[144:147], v[16:31]
  ds_read_b64_tr_b16 v[100:101], v180 offset:2048
  ds_read_b64_tr_b16 v[102:103], v180 offset:2304
  s_add_u32 s64, s64, s54
  buffer_load_dwordx4 v1, s[4:7], s64 offen lds
  s_add_u32 m0, s63, 1024
  s_waitcnt lgkmcnt(4)
  v_mfma_f32_32x32x16_bf16 v[32:47], v[92:95], v[144:147], v[32:47]
  ds_read_b64_tr_b16 v[104:105], v180 offset:34816
  ds_read_b64_tr_b16 v[106:107], v180 offset:35072
  s_add_u32 s64, s64, 16384
  buffer_load_dwordx4 v7, s[4:7], s64 offen lds
  v_mfma_f32_16x16x32_bf16 v[72:75], v[108:111], v[136:139], v[72:75]
  v_mfma_f32_16x16x32_bf16 v[192:195], v[112:115], v[136:139], v[192:195]
  v_mfma_f32_16x16x32_bf16 v[64:67], v[108:111], v[188:191], v[64:67]
  s_add_u32 m0, s63, 2048
  s_add_u32 s64, s64, 16384
  s_waitcnt lgkmcnt(4)
  v_mfma_f32_32x32x16_bf16 v[48:63], v[96:99], v[144:147], v[48:63]
  ds_read_b64_tr_b16 v[92:93], v181 offset:2048
  ds_read_b64_tr_b16 v[94:95], v181 offset:2304
  ds_read_b64_tr_b16 v[108:109], v182 offset:2048
  ds_read_b64_tr_b16 v[110:111], v182 offset:2304
  ds_read_b64_tr_b16 v[112:113], v183 offset:2048
  ds_read_b64_tr_b16 v[114:115], v183 offset:2304
  s_waitcnt lgkmcnt(8)
  v_mfma_f32_32x32x16_bf16 v[16:31], v[100:103], v[148:151], v[16:31]
  ds_read_b64_tr_b16 v[96:97], v180 offset:3072
  ds_read_b64_tr_b16 v[98:99], v180 offset:3328
  buffer_load_dwordx4 v1, s[4:7], s64 offen lds
  s_add_u32 m0, s63, 3072
  s_add_u32 s64, s64, 16384
  s_waitcnt lgkmcnt(8)
  v_mfma_f32_32x32x16_bf16 v[32:47], v[104:107], v[148:151], v[32:47]
  ds_read_b64_tr_b16 v[100:101], v180 offset:35840
  ds_read_b64_tr_b16 v[102:103], v180 offset:36096
  buffer_load_dwordx4 v7, s[4:7], s64 offen lds
  s_add_u32 s59, s58, 4
  s_and_b32 s59, s59, 7
  s_waitcnt lgkmcnt(8)
  v_mfma_f32_32x32x16_bf16 v[48:63], v[92:95], v[148:151], v[48:63]
  ds_read_b64_tr_b16 v[104:105], v181 offset:3072
  ds_read_b64_tr_b16 v[106:107], v181 offset:3328
  s_mul_i32 s66, s59, 196608
  s_lshl_b32 s65, s59, 12
  s_add_u32 s65, s65, s56
  s_waitcnt lgkmcnt(8)
  v_mfma_f32_16x16x32_bf16 v[72:75], v[108:111], v[136:139], v[72:75]
  s_waitcnt lgkmcnt(6)
  v_mfma_f32_16x16x32_bf16 v[192:195], v[112:115], v[136:139], v[192:195]
  v_mfma_f32_16x16x32_bf16 v[68:71], v[108:111], v[188:191], v[68:71]
  s_waitcnt vmcnt(8)
  ds_read_b128 v[156:159], v176
  ds_read_b128 v[160:163], v177
  ds_read_b128 v[164:167], v178
  ds_read_b128 v[168:171], v179
  s_waitcnt lgkmcnt(8)
  v_mfma_f32_32x32x16_bf16 v[16:31], v[96:99], v[152:155], v[16:31]
  s_add_u32 s62, s58, 3
  s_and_b32 s62, s62, 7
  s_lshl_b32 s61, s62, 12
  s_lshl_b32 s62, s62, 7
  v_add_u32 v180, s61, v3
  v_add_u32 v181, s61, v4
  v_add_u32 v182, s61, v5
  v_add_u32 v183, s61, v185
  v_add_u32 v184, s62, v6
  s_waitcnt vmcnt(5)
  s_barrier
  ds_read_b64_tr_b16 v[92:93], v180 offset:0
  ds_read_b64_tr_b16 v[94:95], v180 offset:256
  s_add_u32 m0, s65, 65536
  s_add_u32 s66, s66, s55
  buffer_load_dwordx4 v2, s[8:11], s66 offen lds
  s_waitcnt lgkmcnt(8)
  v_mfma_f32_32x32x16_bf16 v[32:47], v[100:103], v[152:155], v[32:47]
  ds_read_b64_tr_b16 v[96:97], v180 offset:32768
  ds_read_b64_tr_b16 v[98:99], v180 offset:33024
  ds_read_b128 v[188:191], v184
  s_add_u32 m0, s65, 0
  s_add_u32 s66, s66, 1024
  buffer_load_dwordx4 v2, s[8:11], s66 offen lds
  s_waitcnt lgkmcnt(9)
  v_mfma_f32_32x32x16_bf16 v[48:63], v[104:107], v[152:155], v[48:63]
  ds_read_b64_tr_b16 v[100:101], v181 offset:0
  ds_read_b64_tr_b16 v[102:103], v181 offset:256
  s_add_u32 m0, s65, 32768
  s_add_u32 s66, s66, 1024
  buffer_load_dwordx4 v2, s[8:11], s66 offen lds
  s_cmp_lg_u32 s3, 2
  s_cbranch_scc1 L_skip_4
  v_lshrrev_b32 v14, 3, v0
  v_mul_u32_u24 v14, 3584, v14
  v_bfe_u32 v15, v0, 0, 3
  v_lshl_add_u32 v14, v15, 4, v14
  s_lshr_b32 s64, s39, 1
  s_and_b32 s65, s39, 1
  s_mul_i32 s66, s40, 114688
  s_mul_i32 s67, s64, 57344
  s_add_u32 s66, s66, s67
  s_mul_i32 s67, s41, 224
  s_add_u32 s66, s66, s67
  s_mul_i32 s67, s65, 128
  s_add_u32 s66, s66, s67
  s_add_u32 s65, s66, 28672
  buffer_load_dwordx4 v[196:199], v14, s[16:19], s66 offen
  buffer_load_dwordx4 v[200:203], v14, s[16:19], s65 offen
  buffer_load_dwordx4 v[204:207], v14, s[20:23], s66 offen
  buffer_load_dwordx4 v[208:211], v14, s[20:23], s65 offen
  v_mul_u32_u24 v14, 128, v0
  v_mov_b32 v13, 2147483648
  v_cmp_gt_u32 vcc, 14, v0
  s_mul_i32 s65, s2, 7168
  s_mul_i32 s67, s39, 1792
  s_add_u32 s65, s65, s67
  v_cndmask_b32 v14, v13, v14, vcc
  s_mov_b32 m0, 159744
  s_nop 0
  buffer_load_dword v14, s[24:27], s65 offen lds
L_skip_4:
  s_nop 1
  s_waitcnt lgkmcnt(5)
  v_mfma_f32_32x32x16_bf16 v[16:31], v[92:95], v[156:159], v[16:31]
  ds_read_b64_tr_b16 v[104:105], v180 offset:1024
  ds_read_b64_tr_b16 v[106:107], v180 offset:1280
  ds_read_b64_tr_b16 v[108:109], v182 offset:0
  ds_read_b64_tr_b16 v[110:111], v182 offset:256
  ds_read_b64_tr_b16 v[112:113], v183 offset:0
  ds_read_b64_tr_b16 v[114:115], v183 offset:256
  s_waitcnt lgkmcnt(9)
  v_mfma_f32_32x32x16_bf16 v[32:47], v[96:99], v[156:159], v[32:47]
  ds_read_b64_tr_b16 v[92:93], v180 offset:33792
  ds_read_b64_tr_b16 v[94:95], v180 offset:34048
  s_waitcnt lgkmcnt(8)
  v_mfma_f32_32x32x16_bf16 v[48:63], v[100:103], v[156:159], v[48:63]
  ds_read_b64_tr_b16 v[96:97], v181 offset:1024
  ds_read_b64_tr_b16 v[98:99], v181 offset:1280
  s_add_u32 s59, s58, 5
  s_and_b32 s59, s59, 7
  s_lshl_b32 s64, s59, 7
  s_add_u32 m0, s57, 4096
  s_waitcnt lgkmcnt(8)
  v_mfma_f32_32x32x16_bf16 v[16:31], v[104:107], v[160:163], v[16:31]
  ds_read_b64_tr_b16 v[100:101], v180 offset:2048
  ds_read_b64_tr_b16 v[102:103], v180 offset:2304
  s_add_u32 s64, s64, s54
  buffer_load_dwordx4 v1, s[4:7], s64 offen lds
  s_add_u32 m0, s57, 5120
  s_waitcnt lgkmcnt(4)
  v_mfma_f32_32x32x16_bf16 v[32:47], v[92:95], v[160:163], v[32:47]
  ds_read_b64_tr_b16 v[104:105], v180 offset:34816
  ds_read_b64_tr_b16 v[106:107], v180 offset:35072
  s_add_u32 s64, s64, 16384
  buffer_load_dwordx4 v7, s[4:7], s64 offen lds
  v_mfma_f32_16x16x32_bf16 v[72:75], v[108:111], v[136:139], v[72:75]
  v_mfma_f32_16x16x32_bf16 v[192:195], v[112:115], v[136:139], v[192:195]
  v_mfma_f32_16x16x32_bf16 v[64:67], v[108:111], v[188:191], v[64:67]
  s_add_u32 m0, s57, 6144
  s_add_u32 s64, s64, 16384
  s_waitcnt lgkmcnt(4)
  v_mfma_f32_32x32x16_bf16 v[48:63], v[96:99], v[160:163], v[48:63]
  ds_read_b64_tr_b16 v[92:93], v181 offset:2048
  ds_read_b64_tr_b16 v[94:95], v181 offset:2304
  ds_read_b64_tr_b16 v[108:109], v182 offset:2048
  ds_read_b64_tr_b16 v[110:111], v182 offset:2304
  ds_read_b64_tr_b16 v[112:113], v183 offset:2048
  ds_read_b64_tr_b16 v[114:115], v183 offset:2304
  s_waitcnt lgkmcnt(8)
  v_mfma_f32_32x32x16_bf16 v[16:31], v[100:103], v[164:167], v[16:31]
  ds_read_b64_tr_b16 v[96:97], v180 offset:3072
  ds_read_b64_tr_b16 v[98:99], v180 offset:3328
  buffer_load_dwordx4 v1, s[4:7], s64 offen lds
  s_add_u32 m0, s57, 7168
  s_add_u32 s64, s64, 16384
  s_waitcnt lgkmcnt(8)
  v_mfma_f32_32x32x16_bf16 v[32:47], v[104:107], v[164:167], v[32:47]
  ds_read_b64_tr_b16 v[100:101], v180 offset:35840
  ds_read_b64_tr_b16 v[102:103], v180 offset:36096
  buffer_load_dwordx4 v7, s[4:7], s64 offen lds
  s_add_u32 s59, s58, 5
  s_and_b32 s59, s59, 7
  s_waitcnt lgkmcnt(8)
  v_mfma_f32_32x32x16_bf16 v[48:63], v[92:95], v[164:167], v[48:63]
  ds_read_b64_tr_b16 v[104:105], v181 offset:3072
  ds_read_b64_tr_b16 v[106:107], v181 offset:3328
  s_mul_i32 s66, s59, 196608
  s_lshl_b32 s65, s59, 12
  s_add_u32 s65, s65, s56
  s_waitcnt lgkmcnt(8)
  v_mfma_f32_16x16x32_bf16 v[72:75], v[108:111], v[136:139], v[72:75]
  s_waitcnt lgkmcnt(6)
  v_mfma_f32_16x16x32_bf16 v[192:195], v[112:115], v[136:139], v[192:195]
  v_mfma_f32_16x16x32_bf16 v[68:71], v[108:111], v[188:191], v[68:71]
  s_waitcnt vmcnt(7)
  ds_read_b128 v[140:143], v172
  ds_read_b128 v[144:147], v173
  ds_read_b128 v[148:151], v174
  ds_read_b128 v[152:155], v175
  s_waitcnt lgkmcnt(8)
  v_mfma_f32_32x32x16_bf16 v[16:31], v[96:99], v[168:171], v[16:31]
  s_add_u32 s62, s58, 4
  s_and_b32 s62, s62, 7
  s_lshl_b32 s61, s62, 12
  s_lshl_b32 s62, s62, 7
  v_add_u32 v180, s61, v3
  v_add_u32 v181, s61, v4
  v_add_u32 v182, s61, v5
  v_add_u32 v183, s61, v185
  v_add_u32 v184, s62, v6
  s_waitcnt vmcnt(4)
  s_barrier
  ds_read_b64_tr_b16 v[92:93], v180 offset:0
  ds_read_b64_tr_b16 v[94:95], v180 offset:256
  s_add_u32 m0, s65, 65536
  s_add_u32 s66, s66, s55
  buffer_load_dwordx4 v2, s[8:11], s66 offen lds
  s_waitcnt lgkmcnt(8)
  v_mfma_f32_32x32x16_bf16 v[32:47], v[100:103], v[168:171], v[32:47]
  ds_read_b64_tr_b16 v[96:97], v180 offset:32768
  ds_read_b64_tr_b16 v[98:99], v180 offset:33024
  ds_read_b128 v[188:191], v184
  s_add_u32 m0, s65, 0
  s_add_u32 s66, s66, 1024
  buffer_load_dwordx4 v2, s[8:11], s66 offen lds
  s_waitcnt lgkmcnt(9)
  v_mfma_f32_32x32x16_bf16 v[48:63], v[104:107], v[168:171], v[48:63]
  ds_read_b64_tr_b16 v[100:101], v181 offset:0
  ds_read_b64_tr_b16 v[102:103], v181 offset:256
  s_add_u32 m0, s65, 32768
  s_add_u32 s66, s66, 1024
  buffer_load_dwordx4 v2, s[8:11], s66 offen lds
  s_cmp_lg_u32 s3, 3
  s_cbranch_scc1 L_skip_5
  v_lshrrev_b32 v14, 3, v0
  v_mul_u32_u24 v14, 3584, v14
  v_bfe_u32 v15, v0, 0, 3
  v_lshl_add_u32 v14, v15, 4, v14
  s_lshr_b32 s64, s39, 1
  s_and_b32 s65, s39, 1
  s_mul_i32 s66, s40, 114688
  s_mul_i32 s67, s64, 57344
  s_add_u32 s66, s66, s67
  s_mul_i32 s67, s41, 224
  s_add_u32 s66, s66, s67
  s_mul_i32 s67, s65, 128
  s_add_u32 s66, s66, s67
  s_add_u32 s65, s66, 28672
  buffer_load_dwordx4 v[196:199], v14, s[16:19], s66 offen
  buffer_load_dwordx4 v[200:203], v14, s[16:19], s65 offen
  buffer_load_dwordx4 v[204:207], v14, s[20:23], s66 offen
  buffer_load_dwordx4 v[208:211], v14, s[20:23], s65 offen
  v_mul_u32_u24 v14, 128, v0
  v_mov_b32 v13, 2147483648
  v_cmp_gt_u32 vcc, 14, v0
  s_mul_i32 s65, s2, 7168
  s_mul_i32 s67, s39, 1792
  s_add_u32 s65, s65, s67
  v_cndmask_b32 v14, v13, v14, vcc
  s_mov_b32 m0, 159744
  s_nop 0
  buffer_load_dword v14, s[24:27], s65 offen lds
L_skip_5:
  s_nop 1
  s_waitcnt lgkmcnt(5)
  v_mfma_f32_32x32x16_bf16 v[16:31], v[92:95], v[140:143], v[16:31]
  ds_read_b64_tr_b16 v[104:105], v180 offset:1024
  ds_read_b64_tr_b16 v[106:107], v180 offset:1280
  ds_read_b64_tr_b16 v[108:109], v182 offset:0
  ds_read_b64_tr_b16 v[110:111], v182 offset:256
  ds_read_b64_tr_b16 v[112:113], v183 offset:0
  ds_read_b64_tr_b16 v[114:115], v183 offset:256
  s_waitcnt lgkmcnt(9)
  v_mfma_f32_32x32x16_bf16 v[32:47], v[96:99], v[140:143], v[32:47]
  ds_read_b64_tr_b16 v[92:93], v180 offset:33792
  ds_read_b64_tr_b16 v[94:95], v180 offset:34048
  s_waitcnt lgkmcnt(8)
  v_mfma_f32_32x32x16_bf16 v[48:63], v[100:103], v[140:143], v[48:63]
  ds_read_b64_tr_b16 v[96:97], v181 offset:1024
  ds_read_b64_tr_b16 v[98:99], v181 offset:1280
  s_add_u32 s59, s58, 6
  s_and_b32 s59, s59, 7
  s_lshl_b32 s64, s59, 7
  s_add_u32 m0, s63, 0
  s_waitcnt lgkmcnt(8)
  v_mfma_f32_32x32x16_bf16 v[16:31], v[104:107], v[144:147], v[16:31]
  ds_read_b64_tr_b16 v[100:101], v180 offset:2048
  ds_read_b64_tr_b16 v[102:103], v180 offset:2304
  s_add_u32 s64, s64, s54
  buffer_load_dwordx4 v1, s[4:7], s64 offen lds
  s_add_u32 m0, s63, 1024
  s_waitcnt lgkmcnt(4)
  v_mfma_f32_32x32x16_bf16 v[32:47], v[92:95], v[144:147], v[32:47]
  ds_read_b64_tr_b16 v[104:105], v180 offset:34816
  ds_read_b64_tr_b16 v[106:107], v180 offset:35072
  s_add_u32 s64, s64, 16384
  buffer_load_dwordx4 v7, s[4:7], s64 offen lds
  v_mfma_f32_16x16x32_bf16 v[72:75], v[108:111], v[136:139], v[72:75]
  v_mfma_f32_16x16x32_bf16 v[192:195], v[112:115], v[136:139], v[192:195]
  v_mfma_f32_16x16x32_bf16 v[64:67], v[108:111], v[188:191], v[64:67]
  s_add_u32 m0, s63, 2048
  s_add_u32 s64, s64, 16384
  s_waitcnt lgkmcnt(4)
  v_mfma_f32_32x32x16_bf16 v[48:63], v[96:99], v[144:147], v[48:63]
  ds_read_b64_tr_b16 v[92:93], v181 offset:2048
  ds_read_b64_tr_b16 v[94:95], v181 offset:2304
  ds_read_b64_tr_b16 v[108:109], v182 offset:2048
  ds_read_b64_tr_b16 v[110:111], v182 offset:2304
  ds_read_b64_tr_b16 v[112:113], v183 offset:2048
  ds_read_b64_tr_b16 v[114:115], v183 offset:2304
  s_waitcnt lgkmcnt(8)
  v_mfma_f32_32x32x16_bf16 v[16:31], v[100:103], v[148:151], v[16:31]
  ds_read_b64_tr_b16 v[96:97], v180 offset:3072
  ds_read_b64_tr_b16 v[98:99], v180 offset:3328
  buffer_load_dwordx4 v1, s[4:7], s64 offen lds
  s_add_u32 m0, s63, 3072
  s_add_u32 s64, s64, 16384
  s_waitcnt lgkmcnt(8)
  v_mfma_f32_32x32x16_bf16 v[32:47], v[104:107], v[148:151], v[32:47]
  ds_read_b64_tr_b16 v[100:101], v180 offset:35840
  ds_read_b64_tr_b16 v[102:103], v180 offset:36096
  buffer_load_dwordx4 v7, s[4:7], s64 offen lds
  s_add_u32 s59, s58, 6
  s_and_b32 s59, s59, 7
  s_waitcnt lgkmcnt(8)
  v_mfma_f32_32x32x16_bf16 v[48:63], v[92:95], v[148:151], v[48:63]
  ds_read_b64_tr_b16 v[104:105], v181 offset:3072
  ds_read_b64_tr_b16 v[106:107], v181 offset:3328
  s_mul_i32 s66, s59, 196608
  s_lshl_b32 s65, s59, 12
  s_add_u32 s65, s65, s56
  s_waitcnt lgkmcnt(8)
  v_mfma_f32_16x16x32_bf16 v[72:75], v[108:111], v[136:139], v[72:75]
  s_waitcnt lgkmcnt(6)
  v_mfma_f32_16x16x32_bf16 v[192:195], v[112:115], v[136:139], v[192:195]
  v_mfma_f32_16x16x32_bf16 v[68:71], v[108:111], v[188:191], v[68:71]
  s_waitcnt vmcnt(7)
  ds_read_b128 v[156:159], v176
  ds_read_b128 v[160:163], v177
  ds_read_b128 v[164:167], v178
  ds_read_b128 v[168:171], v179
  s_waitcnt lgkmcnt(8)
  v_mfma_f32_32x32x16_bf16 v[16:31], v[96:99], v[152:155], v[16:31]
  s_add_u32 s62, s58, 5
  s_and_b32 s62, s62, 7
  s_lshl_b32 s61, s62, 12
  s_lshl_b32 s62, s62, 7
  v_add_u32 v180, s61, v3
  v_add_u32 v181, s61, v4
  v_add_u32 v182, s61, v5
  v_add_u32 v183, s61, v185
  v_add_u32 v184, s62, v6
  s_waitcnt vmcnt(4)
  s_barrier
  ds_read_b64_tr_b16 v[92:93], v180 offset:0
  ds_read_b64_tr_b16 v[94:95], v180 offset:256
  s_add_u32 m0, s65, 65536
  s_add_u32 s66, s66, s55
  buffer_load_dwordx4 v2, s[8:11], s66 offen lds
  s_waitcnt lgkmcnt(8)
  v_mfma_f32_32x32x16_bf16 v[32:47], v[100:103], v[152:155], v[32:47]
  ds_read_b64_tr_b16 v[96:97], v180 offset:32768
  ds_read_b64_tr_b16 v[98:99], v180 offset:33024
  ds_read_b128 v[188:191], v184
  s_add_u32 m0, s65, 0
  s_add_u32 s66, s66, 1024
  buffer_load_dwordx4 v2, s[8:11], s66 offen lds
  s_waitcnt lgkmcnt(9)
  v_mfma_f32_32x32x16_bf16 v[48:63], v[104:107], v[152:155], v[48:63]
  ds_read_b64_tr_b16 v[100:101], v181 offset:0
  ds_read_b64_tr_b16 v[102:103], v181 offset:256
  s_add_u32 m0, s65, 32768
  s_add_u32 s66, s66, 1024
  buffer_load_dwordx4 v2, s[8:11], s66 offen lds
  s_add_u32 s64, s50, 4096
  buffer_load_dwordx2 v[220:221], v222, s[32:35], s64 offen offset:0 sc1
  s_waitcnt lgkmcnt(5)
  v_mfma_f32_32x32x16_bf16 v[16:31], v[92:95], v[156:159], v[16:31]
  ds_read_b64_tr_b16 v[104:105], v180 offset:1024
  ds_read_b64_tr_b16 v[106:107], v180 offset:1280
  ds_read_b64_tr_b16 v[108:109], v182 offset:0
  ds_read_b64_tr_b16 v[110:111], v182 offset:256
  ds_read_b64_tr_b16 v[112:113], v183 offset:0
  ds_read_b64_tr_b16 v[114:115], v183 offset:256
  s_waitcnt lgkmcnt(9)
  v_mfma_f32_32x32x16_bf16 v[32:47], v[96:99], v[156:159], v[32:47]
  ds_read_b64_tr_b16 v[92:93], v180 offset:33792
  ds_read_b64_tr_b16 v[94:95], v180 offset:34048
  s_waitcnt lgkmcnt(8)
  v_mfma_f32_32x32x16_bf16 v[48:63], v[100:103], v[156:159], v[48:63]
  ds_read_b64_tr_b16 v[96:97], v181 offset:1024
  ds_read_b64_tr_b16 v[98:99], v181 offset:1280
  s_add_u32 s59, s58, 7
  s_and_b32 s59, s59, 7
  s_lshl_b32 s64, s59, 7
  s_add_u32 m0, s57, 4096
  s_waitcnt lgkmcnt(8)
  v_mfma_f32_32x32x16_bf16 v[16:31], v[104:107], v[160:163], v[16:31]
  ds_read_b64_tr_b16 v[100:101], v180 offset:2048
  ds_read_b64_tr_b16 v[102:103], v180 offset:2304
  s_add_u32 s64, s64, s54
  buffer_load_dwordx4 v1, s[4:7], s64 offen lds
  s_add_u32 m0, s57, 5120
  s_waitcnt lgkmcnt(4)
  v_mfma_f32_32x32x16_bf16 v[32:47], v[92:95], v[160:163], v[32:47]
  ds_read_b64_tr_b16 v[104:105], v180 offset:34816
  ds_read_b64_tr_b16 v[106:107], v180 offset:35072
  s_add_u32 s64, s64, 16384
  buffer_load_dwordx4 v7, s[4:7], s64 offen lds
  v_mfma_f32_16x16x32_bf16 v[72:75], v[108:111], v[136:139], v[72:75]
  v_mfma_f32_16x16x32_bf16 v[192:195], v[112:115], v[136:139], v[192:195]
  v_mfma_f32_16x16x32_bf16 v[64:67], v[108:111], v[188:191], v[64:67]
  s_add_u32 m0, s57, 6144
  s_add_u32 s64, s64, 16384
  s_waitcnt lgkmcnt(4)
  v_mfma_f32_32x32x16_bf16 v[48:63], v[96:99], v[160:163], v[48:63]
  ds_read_b64_tr_b16 v[92:93], v181 offset:2048
  ds_read_b64_tr_b16 v[94:95], v181 offset:2304
  ds_read_b64_tr_b16 v[108:109], v182 offset:2048
  ds_read_b64_tr_b16 v[110:111], v182 offset:2304
  ds_read_b64_tr_b16 v[112:113], v183 offset:2048
  ds_read_b64_tr_b16 v[114:115], v183 offset:2304
  s_waitcnt lgkmcnt(8)
  v_mfma_f32_32x32x16_bf16 v[16:31], v[100:103], v[164:167], v[16:31]
  ds_read_b64_tr_b16 v[96:97], v180 offset:3072
  ds_read_b64_tr_b16 v[98:99], v180 offset:3328
  buffer_load_dwordx4 v1, s[4:7], s64 offen lds
  s_add_u32 m0, s57, 7168
  s_add_u32 s64, s64, 16384
  s_waitcnt lgkmcnt(8)
  v_mfma_f32_32x32x16_bf16 v[32:47], v[104:107], v[164:167], v[32:47]
  ds_read_b64_tr_b16 v[100:101], v180 offset:35840
  ds_read_b64_tr_b16 v[102:103], v180 offset:36096
  buffer_load_dwordx4 v7, s[4:7], s64 offen lds
  s_add_u32 s59, s58, 7
  s_and_b32 s59, s59, 7
  s_waitcnt lgkmcnt(8)
  v_mfma_f32_32x32x16_bf16 v[48:63], v[92:95], v[164:167], v[48:63]
  ds_read_b64_tr_b16 v[104:105], v181 offset:3072
  ds_read_b64_tr_b16 v[106:107], v181 offset:3328
  s_mul_i32 s66, s59, 196608
  s_lshl_b32 s65, s59, 12
  s_add_u32 s65, s65, s56
  s_waitcnt lgkmcnt(8)
  v_mfma_f32_16x16x32_bf16 v[72:75], v[108:111], v[136:139], v[72:75]
  s_waitcnt lgkmcnt(6)
  v_mfma_f32_16x16x32_bf16 v[192:195], v[112:115], v[136:139], v[192:195]
  v_mfma_f32_16x16x32_bf16 v[68:71], v[108:111], v[188:191], v[68:71]
  s_waitcnt vmcnt(8)
  ds_read_b128 v[140:143], v172
  ds_read_b128 v[144:147], v173
  ds_read_b128 v[148:151], v174
  ds_read_b128 v[152:155], v175
  s_waitcnt lgkmcnt(8)
  v_mfma_f32_32x32x16_bf16 v[16:31], v[96:99], v[168:171], v[16:31]
  s_add_u32 s62, s58, 6
  s_and_b32 s62, s62, 7
  s_lshl_b32 s61, s62, 12
  s_lshl_b32 s62, s62, 7
  v_add_u32 v180, s61, v3
  v_add_u32 v181, s61, v4
  v_add_u32 v182, s61, v5
  v_add_u32 v183, s61, v185
  v_add_u32 v184, s62, v6
  s_waitcnt vmcnt(5)
  s_barrier
  ds_read_b64_tr_b16 v[92:93], v180 offset:0
  ds_read_b64_tr_b16 v[94:95], v180 offset:256
  s_add_u32 m0, s65, 65536
  s_add_u32 s66, s66, s55
  buffer_load_dwordx4 v2, s[8:11], s66 offen lds
  s_waitcnt lgkmcnt(8)
  v_mfma_f32_32x32x16_bf16 v[32:47], v[100:103], v[168:171], v[32:47]
  ds_read_b64_tr_b16 v[96:97], v180 offset:32768
  ds_read_b64_tr_b16 v[98:99], v180 offset:33024
  ds_read_b128 v[188:191], v184
  s_add_u32 m0, s65, 0
  s_add_u32 s66, s66, 1024
  buffer_load_dwordx4 v2, s[8:11], s66 offen lds
  s_waitcnt lgkmcnt(9)
  v_mfma_f32_32x32x16_bf16 v[48:63], v[104:107], v[168:171], v[48:63]
  ds_read_b64_tr_b16 v[100:101], v181 offset:0
  ds_read_b64_tr_b16 v[102:103], v181 offset:256
  s_add_u32 m0, s65, 32768
  s_add_u32 s66, s66, 1024
  buffer_load_dwordx4 v2, s[8:11], s66 offen lds
  s_add_u32 s64, s60, 0
  buffer_load_dwordx4 a[224:227], v216, s[12:15], s64 offen
  s_add_u32 s64, s60, 8192
  buffer_load_dwordx4 a[228:231], v216, s[12:15], s64 offen
  s_add_u32 s64, s60, 16384
  buffer_load_dwordx4 a[232:235], v216, s[12:15], s64 offen
  s_add_u32 s64, s60, 24576
  buffer_load_dwordx4 a[236:239], v216, s[12:15], s64 offen
  s_lshr_b32 s65, s43, 1
  s_mul_i32 s64, s40, 8192
  s_mul_i32 s67, s65, 2048
  s_add_u32 s64, s64, s67
  s_mul_i32 s67, s42, 1024
  s_add_u32 s64, s64, s67
  s_add_u32 s64, s64, 1048576
  buffer_store_dwordx4 v[136:139], v8, s[32:35], s64 offen sc1
  v_add_u32 v14, s57, v8
  ds_write_b128 v14, v[196:199] offset:0
  ds_write_b128 v14, v[200:203] offset:1024
  ds_write_b128 v14, v[204:207] offset:2048
  ds_write_b128 v14, v[208:211] offset:3072
  v_bfe_u32 v13, v0, 4, 1
  v_lshlrev_b32 v13, 11, v13
  v_lshrrev_b32 v15, 5, v0
  v_lshl_add_u32 v13, v15, 10, v13
  v_bfe_u32 v15, v0, 2, 2
  v_lshl_add_u32 v13, v15, 7, v13
  v_bfe_u32 v15, v0, 0, 1
  v_lshl_add_u32 v13, v15, 4, v13
  v_bfe_u32 v15, v0, 1, 1
  v_lshl_add_u32 v13, v15, 3, v13
  v_add_u32 v13, s57, v13
  v_lshlrev_b32 v14, 2, v0
  s_lshr_b32 s64, s39, 1
  s_and_b32 s65, s39, 1
  s_mul_i32 s66, s41, 262144
  s_mul_i32 s67, s65, 131072
  s_add_u32 s66, s66, s67
  s_mul_i32 s67, s40, 2048
  s_add_u32 s66, s66, s67
  s_mul_i32 s67, s64, 1024
  s_add_u32 s66, s66, s67
  s_add_u32 s66, s66, 16777216
  s_mul_i32 s64, s64, 1024
  s_mul_i32 s67, s41, 32768
  s_add_u32 s64, s64, s67
  s_mul_i32 s67, s40, 2048
  s_add_u32 s64, s64, s67
  s_mul_i32 s67, s65, 512
  s_add_u32 s64, s64, s67
  s_add_u32 s64, s64, 2621440
  v_mov_b32 v212, 0
  v_mov_b32 v213, 0
  v_mov_b32 v214, 0
  v_mov_b32 v215, 0
  s_waitcnt lgkmcnt(14)
  ds_read_b64_tr_b16 v[196:197], v13 offset:0
  s_waitcnt lgkmcnt(14)
  ds_read_b64_tr_b16 v[198:199], v13 offset:512
  s_waitcnt lgkmcnt(14)
  ds_read_b64_tr_b16 v[200:201], v13 offset:32
  s_waitcnt lgkmcnt(14)
  ds_read_b64_tr_b16 v[202:203], v13 offset:544
  s_waitcnt lgkmcnt(14)
  ds_read_b64_tr_b16 v[204:205], v13 offset:64
  s_waitcnt lgkmcnt(14)
  ds_read_b64_tr_b16 v[206:207], v13 offset:576
  s_waitcnt lgkmcnt(14)
  ds_read_b64_tr_b16 v[208:209], v13 offset:96
  s_waitcnt lgkmcnt(14)
  ds_read_b64_tr_b16 v[210:211], v13 offset:608
  s_waitcnt lgkmcnt(6)
  buffer_store_dwordx4 v[196:199], v8, s[32:35], s66 offen sc1
  s_add_u32 s66, s66, 32768
  s_waitcnt lgkmcnt(4)
  buffer_store_dwordx4 v[200:203], v8, s[32:35], s66 offen sc1
  s_add_u32 s66, s66, 32768
  s_waitcnt lgkmcnt(2)
  buffer_store_dwordx4 v[204:207], v8, s[32:35], s66 offen sc1
  s_add_u32 s66, s66, 32768
  s_waitcnt lgkmcnt(0)
  buffer_store_dwordx4 v[208:211], v8, s[32:35], s66 offen sc1
  v_dot2c_f32_bf16 v212, v196, v136
  v_dot2c_f32_bf16 v213, v200, v136
  v_dot2c_f32_bf16 v214, v204, v136
  v_dot2c_f32_bf16 v215, v208, v136
  v_dot2c_f32_bf16 v212, v197, v136
  v_dot2c_f32_bf16 v213, v201, v136
  v_dot2c_f32_bf16 v214, v205, v136
  v_dot2c_f32_bf16 v215, v209, v136
  v_dot2c_f32_bf16 v212, v198, v136
  v_dot2c_f32_bf16 v213, v202, v136
  v_dot2c_f32_bf16 v214, v206, v136
  v_dot2c_f32_bf16 v215, v210, v136
  v_dot2c_f32_bf16 v212, v199, v136
  v_dot2c_f32_bf16 v213, v203, v136
  v_dot2c_f32_bf16 v214, v207, v136
  v_dot2c_f32_bf16 v215, v211, v136
  s_nop 0
  v_permlane32_swap_b32 v212, v213
  s_nop 0
  v_permlane32_swap_b32 v214, v215
  v_add_f32 v212, v212, v213
  buffer_store_dword v212, v14, s[32:35], s64 offen offset:0 sc1
  v_add_f32 v214, v214, v215
  buffer_store_dword v214, v14, s[32:35], s64 offen offset:256 sc1
  s_add_u32 s66, s50, 4096
  s_mov_b32 s69, 0
  s_and_b32 s65, s37, -16
  s_mov_b32 s64, s36
  s_waitcnt vmcnt(18)
L_chk_7:
  v_mov_b32 v223, v221
  v_and_b32 v221, -16, v221
  v_cmp_ne_u64 vcc, s[64:65], v[220:221]
  s_nop 0
  s_and_b64 vcc, vcc, -1
  s_cbranch_scc1 L_poll_6
  v_and_b32 v223, 15, v223
  v_cmp_ne_u32 vcc, s68, v223
  s_nop 0
  s_and_b64 vcc, vcc, -1
  s_cselect_b32 s38, 1, 0
  v_bfe_u32 v13, v0, 1, 4
  v_lshlrev_b32 v13, 7, v13
  v_bfe_u32 v15, v0, 0, 1
  v_lshl_add_u32 v13, v15, 4, v13
  v_bfe_u32 v14, v0, 0, 3
  v_lshlrev_b32 v14, 7, v14
  s_mul_i32 s64, s40, 8192
  s_add_u32 s64, s64, 3145728
  s_mul_i32 s65, s40, 8192
  s_mul_i32 s67, s39, 2048
  s_add_u32 s65, s65, s67
  s_add_u32 s65, s65, 3145728
  buffer_load_dwordx4 v[220:223], v13, s[32:35], s65 offen sc1
  buffer_load_dword v90, v14, s[32:35], s64 offen offset:4 sc1
  buffer_load_dword v91, v14, s[32:35], s64 offen offset:20 sc1
  v_mfma_f32_32x32x16_bf16 v[16:31], v[92:95], v[140:143], v[16:31]
  ds_read_b64_tr_b16 v[104:105], v180 offset:1024
  ds_read_b64_tr_b16 v[106:107], v180 offset:1280
  ds_read_b64_tr_b16 v[108:109], v182 offset:0
  ds_read_b64_tr_b16 v[110:111], v182 offset:256
  ds_read_b64_tr_b16 v[112:113], v183 offset:0
  ds_read_b64_tr_b16 v[114:115], v183 offset:256
  v_mfma_f32_32x32x16_bf16 v[32:47], v[96:99], v[140:143], v[32:47]
  ds_read_b64_tr_b16 v[92:93], v180 offset:33792
  ds_read_b64_tr_b16 v[94:95], v180 offset:34048
  v_mfma_f32_32x32x16_bf16 v[48:63], v[100:103], v[140:143], v[48:63]
  ds_read_b64_tr_b16 v[96:97], v181 offset:1024
  ds_read_b64_tr_b16 v[98:99], v181 offset:1280
  s_add_u32 s64, s60, 32768
  buffer_load_dwordx4 a[240:243], v216, s[12:15], s64 offen
  s_add_u32 s64, s60, 40960
  s_waitcnt lgkmcnt(8)
  v_mfma_f32_32x32x16_bf16 v[16:31], v[104:107], v[144:147], v[16:31]
  ds_read_b64_tr_b16 v[100:101], v180 offset:2048
  ds_read_b64_tr_b16 v[102:103], v180 offset:2304
  buffer_load_dwordx4 a[244:247], v216, s[12:15], s64 offen
  s_add_u32 s64, s60, 49152
  s_waitcnt lgkmcnt(4)
  v_mfma_f32_32x32x16_bf16 v[32:47], v[92:95], v[144:147], v[32:47]
  ds_read_b64_tr_b16 v[104:105], v180 offset:34816
  ds_read_b64_tr_b16 v[106:107], v180 offset:35072
  buffer_load_dwordx4 a[248:251], v216, s[12:15], s64 offen
  s_add_u32 s64, s60, 57344
  v_mfma_f32_16x16x32_bf16 v[72:75], v[108:111], v[136:139], v[72:75]
  v_mfma_f32_16x16x32_bf16 v[192:195], v[112:115], v[136:139], v[192:195]
  v_mfma_f32_16x16x32_bf16 v[64:67], v[108:111], v[188:191], v[64:67]
  buffer_load_dwordx4 a[252:255], v216, s[12:15], s64 offen
  s_waitcnt lgkmcnt(4)
  v_mfma_f32_32x32x16_bf16 v[48:63], v[96:99], v[144:147], v[48:63]
  ds_read_b64_tr_b16 v[92:93], v181 offset:2048
  ds_read_b64_tr_b16 v[94:95], v181 offset:2304
  ds_read_b64_tr_b16 v[108:109], v182 offset:2048
  ds_read_b64_tr_b16 v[110:111], v182 offset:2304
  ds_read_b64_tr_b16 v[112:113], v183 offset:2048
  ds_read_b64_tr_b16 v[114:115], v183 offset:2304
  s_waitcnt lgkmcnt(8)
  v_mfma_f32_32x32x16_bf16 v[16:31], v[100:103], v[148:151], v[16:31]
  ds_read_b64_tr_b16 v[96:97], v180 offset:3072
  ds_read_b64_tr_b16 v[98:99], v180 offset:3328
  s_add_u32 s64, s60, 65536
  buffer_load_dwordx4 v[224:227], v216, s[12:15], s64 offen
  s_add_u32 s64, s60, 73728
  s_waitcnt vmcnt(18)
  ds_write_b128 v219, a[224:227] offset:0
  s_waitcnt lgkmcnt(9)
  v_mfma_f32_32x32x16_bf16 v[32:47], v[104:107], v[148:151], v[32:47]
  ds_read_b64_tr_b16 v[100:101], v180 offset:35840
  ds_read_b64_tr_b16 v[102:103], v180 offset:36096
  buffer_load_dwordx4 v[228:231], v216, s[12:15], s64 offen
  s_add_u32 s64, s60, 81920
  s_waitcnt vmcnt(18)
  ds_write_b128 v219, a[228:231] offset:1024
  s_waitcnt lgkmcnt(10)
  v_mfma_f32_32x32x16_bf16 v[48:63], v[92:95], v[148:151], v[48:63]
  ds_read_b64_tr_b16 v[104:105], v181 offset:3072
  ds_read_b64_tr_b16 v[106:107], v181 offset:3328
  buffer_load_dwordx4 v[232:235], v216, s[12:15], s64 offen
  s_add_u32 s64, s60, 90112
  s_waitcnt lgkmcnt(10)
  v_mfma_f32_16x16x32_bf16 v[72:75], v[108:111], v[136:139], v[72:75]
  s_waitcnt vmcnt(18)
  ds_write_b128 v219, a[232:235] offset:2048
  s_waitcnt vmcnt(17)
  ds_write_b128 v219, a[236:239] offset:3072
  s_waitcnt lgkmcnt(10)
  v_mfma_f32_16x16x32_bf16 v[192:195], v[112:115], v[136:139], v[192:195]
  ds_read_b64_tr_b16 a[224:225], v217 offset:0
  ds_read_b64_tr_b16 a[226:227], v217 offset:2048
  v_mfma_f32_16x16x32_bf16 v[68:71], v[108:111], v[188:191], v[68:71]
  ds_read_b128 v[156:159], v176
  ds_read_b128 v[160:163], v177
  ds_read_b128 v[164:167], v178
  s_waitcnt lgkmcnt(14)
  ds_read_b128 v[168:171], v179
  s_waitcnt lgkmcnt(14)
  ds_read_b64_tr_b16 a[228:229], v218 offset:0
  v_mfma_f32_32x32x16_bf16 v[16:31], v[96:99], v[152:155], v[16:31]
  s_add_u32 s62, s58, 7
  s_and_b32 s62, s62, 7
  s_lshl_b32 s61, s62, 12
  s_lshl_b32 s62, s62, 7
  v_add_u32 v180, s61, v3
  v_add_u32 v181, s61, v4
  v_add_u32 v182, s61, v5
  v_add_u32 v183, s61, v185
  v_add_u32 v184, s62, v6
  s_barrier
  s_waitcnt lgkmcnt(14)
  ds_read_b64_tr_b16 v[92:93], v180 offset:0
  s_waitcnt lgkmcnt(14)
  ds_read_b64_tr_b16 v[94:95], v180 offset:256
  buffer_load_dwordx4 v[236:239], v216, s[12:15], s64 offen
  s_waitcnt lgkmcnt(14)
  ds_read_b64_tr_b16 a[230:231], v218 offset:2048
  s_waitcnt lgkmcnt(14)
  ds_read_b64_tr_b16 a[232:233], v217 offset:1024
  v_mfma_f32_32x32x16_bf16 v[32:47], v[100:103], v[152:155], v[32:47]
  s_waitcnt lgkmcnt(14)
  ds_read_b64_tr_b16 v[96:97], v180 offset:32768
  s_waitcnt lgkmcnt(14)
  ds_read_b64_tr_b16 v[98:99], v180 offset:33024
  s_waitcnt lgkmcnt(14)
  ds_read_b128 v[188:191], v184
  s_waitcnt lgkmcnt(14)
  ds_read_b64_tr_b16 a[234:235], v217 offset:3072
  s_waitcnt lgkmcnt(14)
  ds_read_b64_tr_b16 a[236:237], v218 offset:1024
  s_waitcnt lgkmcnt(14)
  ds_read_b64_tr_b16 a[238:239], v218 offset:3072
  v_mfma_f32_32x32x16_bf16 v[48:63], v[104:107], v[152:155], v[48:63]
  s_waitcnt lgkmcnt(14)
  ds_read_b64_tr_b16 v[100:101], v181 offset:0
  s_waitcnt lgkmcnt(14)
  ds_read_b64_tr_b16 v[102:103], v181 offset:256
  v_bfe_u32 v14, v0, 0, 5
  v_lshlrev_b32 v14, 11, v14
  v_lshrrev_b32 v15, 5, v0
  v_lshl_add_u32 v14, v15, 4, v14
  s_mul_i32 s64, s44, 262144
  s_mul_i32 s67, s42, 131072
  s_add_u32 s64, s64, s67
  s_mul_i32 s67, s45, 1024
  s_add_u32 s64, s64, s67
  s_mul_i32 s67, s43, 128
  s_add_u32 s64, s64, s67
  s_mul_i32 s67, s39, 32
  s_add_u32 s64, s64, s67
  buffer_load_dwordx4 v[208:211], v14, s[4:7], s64 offen
  s_add_u32 s64, s64, 65536
  buffer_load_dwordx4 v[212:215], v14, s[4:7], s64 offen
  s_mul_i32 s3, s39, 458752
  s_mul_i32 s67, s43, 128
  s_add_u32 s3, s3, s67
  s_add_u32 s92, s3, 0
  buffer_load_dwordx4 a[0:3], v216, s[24:27], s92 offen
  s_add_u32 s92, s3, 8192
  buffer_load_dwordx4 a[4:7], v216, s[24:27], s92 offen
  s_add_u32 s92, s3, 16384
  buffer_load_dwordx4 a[8:11], v216, s[24:27], s92 offen
  s_add_u32 s92, s3, 24576
  buffer_load_dwordx4 a[12:15], v216, s[24:27], s92 offen
  s_waitcnt lgkmcnt(10)
  v_mfma_f32_32x32x16_bf16 v[16:31], v[92:95], v[156:159], v[16:31]
  ds_read_b64_tr_b16 v[104:105], v180 offset:1024
  ds_read_b64_tr_b16 v[106:107], v180 offset:1280
  ds_read_b64_tr_b16 v[108:109], v182 offset:0
  ds_read_b64_tr_b16 v[110:111], v182 offset:256
  ds_read_b64_tr_b16 v[112:113], v183 offset:0
  s_waitcnt lgkmcnt(14)
  ds_read_b64_tr_b16 v[114:115], v183 offset:256
  s_waitcnt vmcnt(16)
  v_mov_b32 v88, v220
  s_waitcnt lgkmcnt(12)
  v_mfma_f32_32x32x16_bf16 v[32:47], v[96:99], v[156:159], v[32:47]
  ds_read_b64_tr_b16 v[92:93], v180 offset:33792
  ds_read_b64_tr_b16 v[94:95], v180 offset:34048
  v_mov_b32 v89, v222
  v_mul_f32 v88, 0xbb000000, v88
  v_mul_f32 v89, 0x3b000000, v89
  s_waitcnt lgkmcnt(8)
  v_mfma_f32_32x32x16_bf16 v[48:63], v[100:103], v[156:159], v[48:63]
  ds_read_b64_tr_b16 v[96:97], v181 offset:1024
  ds_read_b64_tr_b16 v[98:99], v181 offset:1280
  s_add_u32 s64, s60, 98304
  buffer_load_dwordx4 v[240:243], v216, s[12:15], s64 offen
  s_add_u32 s64, s60, 106496
  v_fma_f32 v13, -v88, v88, v89
  s_waitcnt lgkmcnt(8)
  v_mfma_f32_32x32x16_bf16 v[16:31], v[104:107], v[160:163], v[16:31]
  ds_read_b64_tr_b16 v[100:101], v180 offset:2048
  ds_read_b64_tr_b16 v[102:103], v180 offset:2304
  buffer_load_dwordx4 v[244:247], v216, s[12:15], s64 offen
  s_add_u32 s64, s60, 114688
  v_max_f32 v13, 0, v13
  s_waitcnt lgkmcnt(4)
  v_mfma_f32_32x32x16_bf16 v[32:47], v[92:95], v[160:163], v[32:47]
  ds_read_b64_tr_b16 v[104:105], v180 offset:34816
  ds_read_b64_tr_b16 v[106:107], v180 offset:35072
  buffer_load_dwordx4 v[248:251], v216, s[12:15], s64 offen
  s_add_u32 s64, s60, 122880
  v_mfma_f32_16x16x32_bf16 v[72:75], v[108:111], v[136:139], v[72:75]
  v_add_f32 v13, 0x3727c5ac, v13
  v_mfma_f32_16x16x32_bf16 v[192:195], v[112:115], v[136:139], v[192:195]
  v_rsq_f32 v89, v13
  v_mfma_f32_16x16x32_bf16 v[64:67], v[108:111], v[188:191], v[64:67]
  buffer_load_dwordx4 v[252:255], v216, s[12:15], s64 offen
  v_cvt_pk_bf16_f32 v84, v88, v88
  s_waitcnt lgkmcnt(4)
  v_mfma_f32_32x32x16_bf16 v[48:63], v[96:99], v[160:163], v[48:63]
  ds_read_b64_tr_b16 v[92:93], v181 offset:2048
  ds_read_b64_tr_b16 v[94:95], v181 offset:2304
  ds_read_b64_tr_b16 v[108:109], v182 offset:2048
  ds_read_b64_tr_b16 v[110:111], v182 offset:2304
  ds_read_b64_tr_b16 v[112:113], v183 offset:2048
  ds_read_b64_tr_b16 v[114:115], v183 offset:2304
  v_lshlrev_b32 v13, 16, v84
  s_waitcnt lgkmcnt(8)
  v_mfma_f32_32x32x16_bf16 v[16:31], v[100:103], v[164:167], v[16:31]
  ds_read_b64_tr_b16 v[96:97], v180 offset:3072
  ds_read_b64_tr_b16 v[98:99], v180 offset:3328
  v_sub_f32 v13, v88, v13
  v_cvt_pk_bf16_f32 v13, v13, v13
  v_cndmask_b32 v84, v84, v13, s[52:53]
  s_waitcnt lgkmcnt(8)
  v_mfma_f32_32x32x16_bf16 v[32:47], v[104:107], v[164:167], v[32:47]
  ds_read_b64_tr_b16 v[100:101], v180 offset:35840
  ds_read_b64_tr_b16 v[102:103], v180 offset:36096
  v_mul_f32 v132, 0x3eb8aa3b, v89
  v_mov_b32 v88, v89
  v_sub_f32 v134, 0, v132
  s_waitcnt lgkmcnt(8)
  v_mfma_f32_32x32x16_bf16 v[48:63], v[92:95], v[164:167], v[48:63]
  ds_read_b64_tr_b16 v[104:105], v181 offset:3072
  ds_read_b64_tr_b16 v[106:107], v181 offset:3328
  v_mov_b32 v133, v132
  s_nop 1
  v_permlane16_swap_b32 v132, v133
  s_waitcnt lgkmcnt(8)
  v_mfma_f32_16x16x32_bf16 v[72:75], v[108:111], v[136:139], v[72:75]
  s_waitcnt vmcnt(19)
  v_mul_f32 v90, 0xbb000000, v90
  s_waitcnt vmcnt(18)
  v_mul_f32 v91, 0x3b000000, v91
  s_waitcnt lgkmcnt(6)
  v_mfma_f32_16x16x32_bf16 v[192:195], v[112:115], v[136:139], v[192:195]
  v_fma_f32 v13, -v90, v90, v91
  v_max_f32 v13, 0, v13
  v_mfma_f32_16x16x32_bf16 v[68:71], v[108:111], v[188:191], v[68:71]
  v_add_f32 v13, 0x3727c5ac, v13
  v_rsq_f32 v91, v13
  s_waitcnt vmcnt(17)
  ds_write_b128 v219, a[240:243] offset:0
  s_waitcnt vmcnt(16)
  ds_write_b128 v219, a[244:247] offset:1024
  s_waitcnt vmcnt(15)
  ds_write_b128 v219, a[248:251] offset:2048
  s_waitcnt lgkmcnt(7)
  v_mfma_f32_32x32x16_bf16 v[16:31], v[96:99], v[168:171], v[16:31]
  s_waitcnt vmcnt(14)
  ds_write_b128 v219, a[252:255] offset:3072
  ds_read_b64_tr_b16 a[240:241], v217 offset:0
  ds_read_b64_tr_b16 a[242:243], v217 offset:2048
  ds_read_b64_tr_b16 a[244:245], v218 offset:0
  ds_read_b64_tr_b16 a[246:247], v218 offset:2048
  ds_read_b64_tr_b16 a[248:249], v217 offset:1024
  s_waitcnt lgkmcnt(11)
  v_mfma_f32_32x32x16_bf16 v[32:47], v[100:103], v[168:171], v[32:47]
  ds_read_b64_tr_b16 a[250:251], v217 offset:3072
  ds_read_b64_tr_b16 a[252:253], v218 offset:1024
  ds_read_b64_tr_b16 a[254:255], v218 offset:3072
  s_waitcnt lgkmcnt(12)
  v_mfma_f32_32x32x16_bf16 v[48:63], v[104:107], v[168:171], v[48:63]
  s_lshr_b32 s65, s43, 1
  s_mul_i32 s64, s40, 8192
  s_mul_i32 s67, s65, 2048
  s_add_u32 s64, s64, s67
  s_mul_i32 s67, s42, 1024
  s_add_u32 s64, s64, s67
  s_add_u32 s64, s64, 1048576
  s_mov_b32 m0, 159744
  s_nop 0
  buffer_load_dword v8, s[32:35], s64 offen lds
  s_mul_i32 s66, s41, 4096
  s_mul_i32 s67, s40, 32
  s_add_u32 s66, s66, s67
  s_mul_i32 s67, s39, 8
  s_add_u32 s66, s66, s67
  s_add_u32 s66, s66, 131072
  v_mov_b32 v220, s36
  v_mov_b32 v221, s37
  s_mov_b64 exec, 1
  buffer_store_dwordx2 v[220:221], off, s[32:35], s66 sc1
  s_mov_b64 exec, -1
  s_add_u32 s92, s3, 32768
  buffer_load_dwordx4 a[16:19], v216, s[24:27], s92 offen
  s_add_u32 s92, s3, 40960
  buffer_load_dwordx4 a[20:23], v216, s[24:27], s92 offen
  s_add_u32 s92, s3, 49152
  buffer_load_dwordx4 a[24:27], v216, s[24:27], s92 offen
  s_add_u32 s92, s3, 57344
  buffer_load_dwordx4 a[28:31], v216, s[24:27], s92 offen
  s_mul_i32 s64, s39, 64
  s_add_u32 s64, s64, 163072
  v_lshrrev_b32 v13, 4, v0
  v_lshlrev_b32 v13, 4, v13
  v_add_u32 v13, s64, v13
  s_and_b32 s65, s39, 1
  s_mul_i32 s64, s65, 64
  s_add_u32 s64, s64, 163328
  v_lshrrev_b32 v14, 4, v0
  v_lshlrev_b32 v14, 4, v14
  v_add_u32 v14, s64, v14
  ds_write_b128 v13, v[72:75]
  ds_write_b128 v14, v[192:195]
  s_waitcnt lgkmcnt(0)
  s_add_u32 s92, s3, 65536
  buffer_load_dwordx4 a[32:35], v216, s[24:27], s92 offen
  s_add_u32 s92, s3, 73728
  buffer_load_dwordx4 a[36:39], v216, s[24:27], s92 offen
  s_barrier
  v_bfe_u32 v13, v0, 4, 1
  v_lshlrev_b32 v13, 6, v13
  v_bfe_u32 v15, v0, 0, 2
  v_lshl_add_u32 v13, v15, 2, v13
  v_bfe_u32 v15, v0, 2, 1
  v_lshl_add_u32 v13, v15, 5, v13
  v_bfe_u32 v15, v0, 3, 1
  v_lshl_add_u32 v13, v15, 4, v13
  v_add_u32 v13, 163072, v13
  ds_read_b32 v76, v13 offset:0
  ds_read_b32 v80, v13 offset:128
  ds_read_b32 v78, v13 offset:256
  s_waitcnt lgkmcnt(2)
  v_cvt_pk_bf16_f32 v14, v76, v76
  v_lshlrev_b32 v14, 16, v14
  v_sub_f32 v14, v76, v14
  v_cvt_pk_bf16_f32 v76, v76, v14
  s_waitcnt lgkmcnt(1)
  v_cvt_pk_bf16_f32 v14, v80, v80
  v_lshlrev_b32 v14, 16, v14
  v_sub_f32 v14, v80, v14
  v_cvt_pk_bf16_f32 v80, v80, v14
  s_waitcnt lgkmcnt(0)
  v_cvt_pk_bf16_f32 v14, v78, v78
  v_lshlrev_b32 v14, 16, v14
  v_sub_f32 v14, v78, v14
  v_cvt_pk_bf16_f32 v78, v78, v14
  s_add_u32 s92, s3, 81920
  buffer_load_dwordx4 a[40:43], v216, s[24:27], s92 offen
  s_add_u32 s92, s3, 90112
  buffer_load_dwordx4 a[44:47], v216, s[24:27], s92 offen
  s_mul_i32 s62, s40, 458752
  s_mul_i32 s67, s39, 114688
  s_add_u32 s62, s62, s67
  s_mul_i32 s67, s41, 1024
  s_add_u32 s62, s62, s67
  s_add_u32 s62, s62, 20971520
  s_add_u32 s63, s62, 57344
  v_mfma_f32_32x32x16_bf16 v[16:31], v[76:79], v[84:87], v[16:31]
  v_mfma_f32_32x32x16_bf16 v[32:47], v[78:81], v[82:85], v[32:47]
  v_mfma_f32_32x32x16_bf16 v[48:63], v[76:79], v[82:85], v[48:63]
  v_add_f32_dpp v64, v68, v64 row_ror:8 row_mask:0xf bank_mask:0xf
  v_add_f32_dpp v65, v69, v65 row_ror:8 row_mask:0xf bank_mask:0xf
  v_add_f32_dpp v66, v70, v66 row_ror:8 row_mask:0xf bank_mask:0xf
  v_add_f32_dpp v67, v71, v67 row_ror:8 row_mask:0xf bank_mask:0xf
  v_fma_f32 v64, v90, v72, v64
  v_fma_f32 v65, v90, v73, v65
  v_fma_f32 v66, v90, v74, v66
  v_fma_f32 v67, v90, v75, v67
  v_mul_f32 v64, v91, v64
  v_mul_f32 v65, v91, v65
  v_mul_f32 v66, v91, v66
  v_mul_f32 v67, v91, v67
  v_cvt_pk_bf16_f32 v64, v64, v65
  v_cvt_pk_bf16_f32 v65, v66, v67
  ds_write_b64 v10, v[64:65]
  s_add_u32 s92, s3, 98304
  buffer_load_dwordx4 a[48:51], v216, s[24:27], s92 offen
  s_add_u32 s92, s3, 106496
  buffer_load_dwordx4 a[52:55], v216, s[24:27], s92 offen
  v_pk_mul_f32 v[16:17], v[16:17], v[88:89]
  v_pk_mul_f32 v[18:19], v[18:19], v[88:89]
  v_pk_mul_f32 v[20:21], v[20:21], v[88:89]
  v_pk_mul_f32 v[22:23], v[22:23], v[88:89]
  v_pk_mul_f32 v[24:25], v[24:25], v[88:89]
  v_pk_mul_f32 v[26:27], v[26:27], v[88:89]
  v_pk_mul_f32 v[28:29], v[28:29], v[88:89]
  v_pk_mul_f32 v[30:31], v[30:31], v[88:89]
  v_cvt_pk_bf16_f32 v16, v16, v17
  v_cvt_pk_bf16_f32 v17, v18, v19
  v_cvt_pk_bf16_f32 v18, v20, v21
  v_cvt_pk_bf16_f32 v19, v22, v23
  v_cvt_pk_bf16_f32 v20, v24, v25
  v_cvt_pk_bf16_f32 v21, v26, v27
  v_cvt_pk_bf16_f32 v22, v28, v29
  v_cvt_pk_bf16_f32 v23, v30, v31
  ds_write_b128 v9, v[16:19] offset:0
  ds_write_b128 v9, v[20:23] offset:4608
  v_pk_mul_f32 v[32:33], v[32:33], v[88:89]
  v_pk_mul_f32 v[34:35], v[34:35], v[88:89]
  v_pk_mul_f32 v[36:37], v[36:37], v[88:89]
  v_pk_mul_f32 v[38:39], v[38:39], v[88:89]
  v_pk_mul_f32 v[40:41], v[40:41], v[88:89]
  v_pk_mul_f32 v[42:43], v[42:43], v[88:89]
  v_pk_mul_f32 v[44:45], v[44:45], v[88:89]
  v_pk_mul_f32 v[46:47], v[46:47], v[88:89]
  v_cvt_pk_bf16_f32 v32, v32, v33
  v_cvt_pk_bf16_f32 v33, v34, v35
  v_cvt_pk_bf16_f32 v34, v36, v37
  v_cvt_pk_bf16_f32 v35, v38, v39
  v_cvt_pk_bf16_f32 v36, v40, v41
  v_cvt_pk_bf16_f32 v37, v42, v43
  v_cvt_pk_bf16_f32 v38, v44, v45
  v_cvt_pk_bf16_f32 v39, v46, v47
  ds_write_b128 v9, v[32:35] offset:9216
  ds_write_b128 v9, v[36:39] offset:13824
  v_cvt_pk_bf16_f32 v48, v48, v49
  v_cvt_pk_bf16_f32 v49, v50, v51
  v_cvt_pk_bf16_f32 v50, v52, v53
  v_cvt_pk_bf16_f32 v51, v54, v55
  v_cvt_pk_bf16_f32 v52, v56, v57
  v_cvt_pk_bf16_f32 v53, v58, v59
  v_cvt_pk_bf16_f32 v54, v60, v61
  v_cvt_pk_bf16_f32 v55, v62, v63
  v_permlane16_swap_b32 v48, v50
  v_permlane16_swap_b32 v49, v51
  v_permlane16_swap_b32 v52, v54
  v_permlane16_swap_b32 v53, v55
  s_add_u32 s92, s3, 114688
  buffer_load_dwordx4 a[56:59], v216, s[24:27], s92 offen
  s_add_u32 s92, s3, 122880
  buffer_load_dwordx4 a[60:63], v216, s[24:27], s92 offen
  s_waitcnt lgkmcnt(0)
  s_barrier
  ds_read_b64 v[140:141], v11 offset:0
  ds_read_b64 v[142:143], v11 offset:512
  ds_read_b64 v[144:145], v11 offset:1024
  ds_read_b64 v[146:147], v11 offset:4608
  ds_read_b64 v[148:149], v11 offset:5120
  ds_read_b64 v[150:151], v11 offset:5632
  ds_read_b64_tr_b16 v[152:153], v12 offset:0
  ds_read_b64_tr_b16 v[154:155], v12 offset:512
  ds_read_b64_tr_b16 v[156:157], v12 offset:1024
  ds_read_b64_tr_b16 v[158:159], v12 offset:4608
  ds_read_b64_tr_b16 v[160:161], v12 offset:5120
  ds_read_b64_tr_b16 v[162:163], v12 offset:5632
  v_mov_b32 v223, v216
  s_waitcnt lgkmcnt(10)
  v_mfma_f32_16x16x16_bf16 v[164:167], v[142:143], v[48:49], v[116:119]
  v_mfma_f32_16x16x16_bf16 v[180:183], v[140:141], v[48:49], v[124:127]
  s_waitcnt lgkmcnt(7)
  v_mfma_f32_16x16x16_bf16 v[168:171], v[148:149], v[52:53], v[116:119]
  v_mfma_f32_16x16x16_bf16 v[184:187], v[146:147], v[52:53], v[124:127]
  v_mfma_f32_16x16x16_bf16 v[172:175], v[144:145], v[50:51], v[116:119]
  v_mfma_f32_16x16x16_bf16 v[188:191], v[142:143], v[50:51], v[120:123]
  s_waitcnt lgkmcnt(6)
  v_mfma_f32_16x16x16_bf16 v[176:179], v[150:151], v[54:55], v[116:119]
  v_mfma_f32_16x16x16_bf16 v[192:195], v[148:149], v[54:55], v[120:123]
  v_max_f32 v164, v164, v180
  v_max_f32 v165, v165, v181
  v_max_f32 v166, v166, v182
  v_max_f32 v167, v167, v183
  v_max_f32 v168, v168, v184
  v_max_f32 v169, v169, v185
  v_max_f32 v170, v170, v186
  v_max_f32 v171, v171, v187
  v_max_f32 v172, v172, v188
  v_max_f32 v173, v173, v189
  v_max_f32 v174, v174, v190
  v_max_f32 v175, v175, v191
  v_max_f32 v176, v176, v192
  v_max_f32 v177, v177, v193
  v_max_f32 v178, v178, v194
  v_max_f32 v179, v179, v195
  v_max3_f32 v196, v164, v165, v166
  v_max3_f32 v197, v168, v169, v170
  v_max3_f32 v198, v172, v173, v174
  v_max3_f32 v199, v176, v177, v178
  v_max_f32 v196, v196, v167
  v_max_f32 v197, v197, v171
  v_max_f32 v198, v198, v175
  v_max_f32 v199, v199, v179
  v_permlane32_swap_b32 v196, v197
  s_nop 0
  v_permlane32_swap_b32 v198, v199
  v_max_f32 v196, v196, v197
  v_max_f32 v198, v198, v199
  s_nop 1
  v_permlane16_swap_b32 v196, v198
  v_max_f32 v196, v196, v198
  v_mul_f32 v196, v196, v134
  v_mov_b32 v198, v196
  s_nop 1
  v_permlane16_swap_b32 v196, v198
  v_mov_b32 v197, v196
  v_mov_b32 v199, v198
  s_nop 0
  v_permlane32_swap_b32 v196, v197
  v_permlane32_swap_b32 v198, v199
  v_pk_fma_f32 v[164:165], v[164:165], v[132:133], v[196:197] op_sel:[0,0,0] op_sel_hi:[1,0,0]
  v_pk_fma_f32 v[166:167], v[166:167], v[132:133], v[196:197] op_sel:[0,0,0] op_sel_hi:[1,0,0]
  v_pk_fma_f32 v[168:169], v[168:169], v[132:133], v[196:197] op_sel:[0,0,1] op_sel_hi:[1,0,1]
  v_pk_fma_f32 v[170:171], v[170:171], v[132:133], v[196:197] op_sel:[0,0,1] op_sel_hi:[1,0,1]
  v_pk_fma_f32 v[172:173], v[172:173], v[132:133], v[198:199] op_sel:[0,1,0] op_sel_hi:[1,1,0]
  v_pk_fma_f32 v[174:175], v[174:175], v[132:133], v[198:199] op_sel:[0,1,0] op_sel_hi:[1,1,0]
  v_pk_fma_f32 v[176:177], v[176:177], v[132:133], v[198:199] op_sel:[0,1,1] op_sel_hi:[1,1,1]
  v_pk_fma_f32 v[178:179], v[178:179], v[132:133], v[198:199] op_sel:[0,1,1] op_sel_hi:[1,1,1]
  v_exp_f32 v164, v164
  v_exp_f32 v165, v165
  v_exp_f32 v166, v166
  v_exp_f32 v167, v167
  v_exp_f32 v168, v168
  v_exp_f32 v169, v169
  v_cvt_pk_bf16_f32 v164, v164, v165
  v_cvt_pk_bf16_f32 v165, v166, v167
  v_exp_f32 v170, v170
  v_exp_f32 v171, v171
  v_and_b32 v180, v164, v128
  v_and_b32 v181, v165, v129
  v_and_b32 v182, v164, v130
  v_and_b32 v183, v165, v131
  v_exp_f32 v172, v172
  v_exp_f32 v173, v173
  v_mfma_f32_16x16x16_bf16 v[32:35], v[136:137], v[164:165], 0
  v_cvt_pk_bf16_f32 v168, v168, v169
  v_cvt_pk_bf16_f32 v169, v170, v171
  v_exp_f32 v174, v174
  v_exp_f32 v175, v175
  s_waitcnt lgkmcnt(4)
  v_mfma_f32_16x16x16_bf16 v[16:19], v[154:155], v[180:181], 0
  v_and_b32 v184, v168, v128
  v_and_b32 v185, v169, v129
  v_and_b32 v186, v168, v130
  v_and_b32 v187, v169, v131
  v_mfma_f32_16x16x16_bf16 v[16:19], v[152:153], v[182:183], v[16:19]
  v_exp_f32 v176, v176
  v_exp_f32 v177, v177
  v_mfma_f32_16x16x16_bf16 v[36:39], v[136:137], v[168:169], 0
  v_cvt_pk_bf16_f32 v172, v172, v173
  v_cvt_pk_bf16_f32 v173, v174, v175
  v_exp_f32 v178, v178
  v_exp_f32 v179, v179
  s_waitcnt lgkmcnt(1)
  v_mfma_f32_16x16x16_bf16 v[20:23], v[160:161], v[184:185], 0
  v_and_b32 v188, v172, v128
  v_and_b32 v189, v173, v129
  v_and_b32 v190, v172, v130
  v_and_b32 v191, v173, v131
  v_mfma_f32_16x16x16_bf16 v[20:23], v[158:159], v[186:187], v[20:23]
  v_mfma_f32_16x16x16_bf16 v[40:43], v[136:137], v[172:173], 0
  v_cvt_pk_bf16_f32 v176, v176, v177
  v_cvt_pk_bf16_f32 v177, v178, v179
  v_mfma_f32_16x16x16_bf16 v[24:27], v[156:157], v[188:189], 0
  v_and_b32 v192, v176, v128
  v_and_b32 v193, v177, v129
  v_and_b32 v194, v176, v130
  v_and_b32 v195, v177, v131
  v_mfma_f32_16x16x16_bf16 v[24:27], v[154:155], v[190:191], v[24:27]
  v_mfma_f32_16x16x16_bf16 v[44:47], v[136:137], v[176:177], 0
  s_waitcnt lgkmcnt(0)
  v_mfma_f32_16x16x16_bf16 v[28:31], v[162:163], v[192:193], 0
  v_mfma_f32_16x16x16_bf16 v[28:31], v[160:161], v[194:195], v[28:31]
  v_rcp_f32 v32, v32
  v_rcp_f32 v36, v36
  v_rcp_f32 v40, v40
  s_nop 1
  v_rcp_f32 v44, v44
  v_pk_mul_f32 v[16:17], v[16:17], v[32:33] op_sel_hi:[1,0]
  v_pk_mul_f32 v[18:19], v[18:19], v[32:33] op_sel_hi:[1,0]
  v_pk_mul_f32 v[20:21], v[20:21], v[36:37] op_sel_hi:[1,0]
  v_pk_mul_f32 v[22:23], v[22:23], v[36:37] op_sel_hi:[1,0]
  v_pk_mul_f32 v[24:25], v[24:25], v[40:41] op_sel_hi:[1,0]
  v_pk_mul_f32 v[26:27], v[26:27], v[40:41] op_sel_hi:[1,0]
  v_pk_mul_f32 v[28:29], v[28:29], v[44:45] op_sel_hi:[1,0]
  v_pk_mul_f32 v[30:31], v[30:31], v[44:45] op_sel_hi:[1,0]
  v_cvt_pk_bf16_f32 v200, v16, v17
  v_cvt_pk_bf16_f32 v201, v18, v19
  v_cvt_pk_bf16_f32 v202, v20, v21
  v_cvt_pk_bf16_f32 v203, v22, v23
  buffer_store_dwordx4 v[200:203], v8, s[32:35], s62 offen sc1
  v_cvt_pk_bf16_f32 v204, v24, v25
  v_cvt_pk_bf16_f32 v205, v26, v27
  v_cvt_pk_bf16_f32 v206, v28, v29
  v_cvt_pk_bf16_f32 v207, v30, v31
  buffer_store_dwordx4 v[204:207], v8, s[32:35], s63 offen sc1
  v_mov_b32 v220, s36
  v_mov_b32 v221, s37
  v_mbcnt_lo_u32_b32 v0, -1, 0
  v_mbcnt_hi_u32_b32 v0, -1, v0
  v_lshlrev_b32 v222, 3, v0
  v_bfe_u32 v2, v0, 4, 1
  v_lshlrev_b32 v2, 14, v2
  v_lshrrev_b32 v15, 5, v0
  v_lshl_add_u32 v2, v15, 8, v2
  v_bfe_u32 v15, v0, 0, 4
  v_lshl_add_u32 v2, v15, 4, v2
  s_mul_i32 s56, s40, 131072
  s_mul_i32 s67, s42, 65536
  s_add_u32 s56, s56, s67
  s_mul_i32 s67, s43, 2048
  s_add_u32 s56, s56, s67
  s_mul_i32 s67, s39, 512
  s_add_u32 s56, s56, s67
  s_add_u32 s56, s56, 4194304
  s_add_u32 s57, s56, 32768
  v_lshlrev_b32 v8, 4, v0
  v_bfe_u32 v1, v0, 4, 1
  v_mul_u32_u24 v1, 57344, v1
  v_lshrrev_b32 v15, 5, v0
  v_lshl_add_u32 v1, v15, 8, v1
  v_bfe_u32 v15, v0, 0, 4
  v_lshl_add_u32 v1, v15, 4, v1
  s_mul_i32 s54, s40, 458752
  s_mul_i32 s67, s42, 229376
  s_add_u32 s54, s54, s67
  s_mul_i32 s67, s39, 4096
  s_add_u32 s54, s54, s67
  s_add_u32 s54, s54, 20971520
  s_add_u32 s55, s54, 114688
  s_add_u32 s64, s39, 1
  s_and_b32 s64, s64, 3
  s_mul_i32 s65, s64, 6144
  s_add_u32 s65, s65, 135168
  v_add_u32 v4, s65, v8
  s_add_u32 s64, s39, 2
  s_and_b32 s64, s64, 3
  s_mul_i32 s65, s64, 6144
  s_add_u32 s65, s65, 137216
  v_add_u32 v5, s65, v8
  s_add_u32 s64, s39, 3
  s_and_b32 s64, s64, 3
  s_mul_i32 s65, s64, 6144
  s_add_u32 s65, s65, 139264
  v_add_u32 v6, s65, v8
  s_mul_i32 s65, s39, 6144
  s_add_u32 s65, s65, 135168
  v_add_u32 v7, s65, v8
  s_mov_b64 exec, 1
  s_cmp_lg_u32 s38, 0
  s_waitcnt vmcnt(0)
  s_cbranch_scc1 L_slow_9
  buffer_store_dwordx2 v[220:221], off, s[32:35], s51
L_sigd_10:
  s_mov_b64 exec, -1
  ds_write_b128 v219, v[224:227] offset:0
  ds_write_b128 v219, v[228:231] offset:1024
  ds_write_b128 v219, v[232:235] offset:2048
  ds_write_b128 v219, v[236:239] offset:3072
  ds_read_b64_tr_b16 v[224:225], v217 offset:0
  ds_read_b64_tr_b16 v[226:227], v217 offset:2048
  ds_read_b64_tr_b16 v[228:229], v218 offset:0
  ds_read_b64_tr_b16 v[230:231], v218 offset:2048
  ds_read_b64_tr_b16 v[232:233], v217 offset:1024
  ds_read_b64_tr_b16 v[234:235], v217 offset:3072
  ds_read_b64_tr_b16 v[236:237], v218 offset:1024
  ds_read_b64_tr_b16 v[238:239], v218 offset:3072
  ds_write_b128 v219, v[240:243] offset:0
  ds_write_b128 v219, v[244:247] offset:1024
  ds_write_b128 v219, v[248:251] offset:2048
  s_waitcnt lgkmcnt(14)
  ds_write_b128 v219, v[252:255] offset:3072
  s_waitcnt lgkmcnt(14)
  ds_read_b64_tr_b16 v[240:241], v217 offset:0
  s_waitcnt lgkmcnt(14)
  ds_read_b64_tr_b16 v[242:243], v217 offset:2048
  s_waitcnt lgkmcnt(14)
  ds_read_b64_tr_b16 v[244:245], v218 offset:0
  s_waitcnt lgkmcnt(14)
  ds_read_b64_tr_b16 v[246:247], v218 offset:2048
  s_waitcnt lgkmcnt(14)
  ds_read_b64_tr_b16 v[248:249], v217 offset:1024
  s_waitcnt lgkmcnt(14)
  ds_read_b64_tr_b16 v[250:251], v217 offset:3072
  s_waitcnt lgkmcnt(14)
  ds_read_b64_tr_b16 v[252:253], v218 offset:1024
  s_waitcnt lgkmcnt(14)
  ds_read_b64_tr_b16 v[254:255], v218 offset:3072
  s_add_u32 s92, s3, 131072
  buffer_load_dwordx4 a[64:67], v223, s[24:27], s92 offen
  s_add_u32 s92, s3, 139264
  buffer_load_dwordx4 a[68:71], v223, s[24:27], s92 offen
  s_add_u32 s92, s3, 147456
  buffer_load_dwordx4 a[72:75], v223, s[24:27], s92 offen
  s_add_u32 s92, s3, 155648
  buffer_load_dwordx4 a[76:79], v223, s[24:27], s92 offen
  s_add_u32 s92, s3, 163840
  buffer_load_dwordx4 a[80:83], v223, s[24:27], s92 offen
  s_add_u32 s92, s3, 172032
  buffer_load_dwordx4 a[84:87], v223, s[24:27], s92 offen
  s_waitcnt lgkmcnt(0)
  s_barrier
  v_mov_b32 v104, v208
  v_mov_b32 v105, v209
  v_mov_b32 v106, v210
  v_mov_b32 v107, v211
  v_mov_b32 v108, v212
  v_mov_b32 v109, v213
  v_mov_b32 v110, v214
  v_mov_b32 v111, v215
  buffer_load_dwordx2 v[220:221], v222, s[32:35], s50 offen offset:0 sc1
  v_mov_b32 v11, 1065369472
  v_mov_b32 v112, 0
  v_mov_b32 v113, 0
  v_mov_b32 v114, 0
  v_mov_b32 v115, 0
  v_mov_b32 v24, 0
  v_mov_b32 v25, 0
  v_mov_b32 v26, 0
  v_mov_b32 v27, 0
  v_mov_b32 v28, 0
  v_mov_b32 v29, 0
  v_mov_b32 v30, 0
  v_mov_b32 v31, 0
  v_lshlrev_b32 v16, 16, v104
  v_and_b32 v17, 4294901760, v104
  v_lshlrev_b32 v18, 16, v105
  v_and_b32 v19, 4294901760, v105
  v_lshlrev_b32 v20, 16, v106
  v_and_b32 v21, 4294901760, v106
  v_lshlrev_b32 v22, 16, v107
  v_and_b32 v23, 4294901760, v107
  v_mov_b32 v56, 0
  v_mov_b32 v57, 0
  v_mov_b32 v58, 0
  v_mov_b32 v59, 0
  v_mov_b32 v60, 0
  v_mov_b32 v61, 0
  v_mov_b32 v62, 0
  v_mov_b32 v63, 0
  v_lshlrev_b32 v48, 16, v108
  v_and_b32 v49, 4294901760, v108
  v_lshlrev_b32 v50, 16, v109
  v_and_b32 v51, 4294901760, v109
  v_lshlrev_b32 v52, 16, v110
  v_and_b32 v53, 4294901760, v110
  v_lshlrev_b32 v54, 16, v111
  v_and_b32 v55, 4294901760, v111
  s_mov_b32 s69, 0
  s_waitcnt vmcnt(0)
L_chk_12:
  v_subrev_u32 v220, s36, v220
  v_xor_b32 v221, s37, v221
  v_subrev_u32 v220, 0, v220
  v_cmp_lt_u64 vcc, 31, v[220:221]
  s_nop 0
  s_and_b64 vcc, vcc, s[48:49]
  s_cbranch_scc1 L_poll_11
  s_cmp_lg_u32 s38, 0
  s_cbranch_scc1 L_inv_14
L_polld_13:
  buffer_load_dwordx4 v[128:131], v1, s[32:35], s54 offen offset:0 sc1
  buffer_load_dwordx4 v[132:135], v1, s[32:35], s54 offen offset:512 sc1
  buffer_load_dwordx4 v[136:139], v1, s[32:35], s54 offen offset:1024 sc1
  buffer_load_dwordx4 v[140:143], v1, s[32:35], s54 offen offset:1536 sc1
  buffer_load_dwordx4 v[144:147], v1, s[32:35], s54 offen offset:2048 sc1
  buffer_load_dwordx4 v[148:151], v1, s[32:35], s54 offen offset:2560 sc1
  buffer_load_dwordx4 v[152:155], v1, s[32:35], s54 offen offset:3072 sc1
  buffer_load_dwordx4 v[156:159], v1, s[32:35], s54 offen offset:3584 sc1
  s_add_u32 s69, s36, 1
  v_mov_b32 v220, s69
  v_mov_b32 v221, s37
  v_mov_b32 v218, v222
  s_mul_i32 s66, s41, 4096
  s_add_u32 s66, s66, 131072
  buffer_load_dwordx2 v[216:217], v218, s[32:35], s66 offen offset:0 sc1
  s_waitcnt vmcnt(8)
  v_mfma_f32_32x32x16_bf16 v[16:31], a[224:227], v[128:131], v[16:31]
  buffer_load_dwordx4 v[160:163], v1, s[32:35], s55 offen offset:0 sc1
  v_mfma_f32_32x32x16_bf16 v[32:47], a[228:231], v[128:131], 0
  s_waitcnt vmcnt(8)
  v_mfma_f32_32x32x16_bf16 v[16:31], a[232:235], v[132:135], v[16:31]
  buffer_load_dwordx4 v[164:167], v1, s[32:35], s55 offen offset:512 sc1
  v_mfma_f32_32x32x16_bf16 v[32:47], a[236:239], v[132:135], v[32:47]
  s_waitcnt vmcnt(8)
  v_mfma_f32_32x32x16_bf16 v[16:31], a[240:243], v[136:139], v[16:31]
  buffer_load_dwordx4 v[168:171], v1, s[32:35], s55 offen offset:1024 sc1
  v_mfma_f32_32x32x16_bf16 v[32:47], a[244:247], v[136:139], v[32:47]
  s_waitcnt vmcnt(8)
  v_mfma_f32_32x32x16_bf16 v[16:31], a[248:251], v[140:143], v[16:31]
  buffer_load_dwordx4 v[172:175], v1, s[32:35], s55 offen offset:1536 sc1
  v_mfma_f32_32x32x16_bf16 v[32:47], a[252:255], v[140:143], v[32:47]
  s_waitcnt vmcnt(8)
  v_mfma_f32_32x32x16_bf16 v[16:31], v[224:227], v[144:147], v[16:31]
  buffer_load_dwordx4 v[128:131], v1, s[32:35], s55 offen offset:2048 sc1
  v_mfma_f32_32x32x16_bf16 v[32:47], v[228:231], v[144:147], v[32:47]
  s_waitcnt vmcnt(8)
  v_mfma_f32_32x32x16_bf16 v[16:31], v[232:235], v[148:151], v[16:31]
  buffer_load_dwordx4 v[132:135], v1, s[32:35], s55 offen offset:2560 sc1
  v_mfma_f32_32x32x16_bf16 v[32:47], v[236:239], v[148:151], v[32:47]
  s_waitcnt vmcnt(8)
  v_mfma_f32_32x32x16_bf16 v[16:31], v[240:243], v[152:155], v[16:31]
  buffer_load_dwordx4 v[136:139], v1, s[32:35], s55 offen offset:3072 sc1
  v_mfma_f32_32x32x16_bf16 v[32:47], v[244:247], v[152:155], v[32:47]
  s_waitcnt vmcnt(8)
  v_mfma_f32_32x32x16_bf16 v[16:31], v[248:251], v[156:159], v[16:31]
  buffer_load_dwordx4 v[140:143], v1, s[32:35], s55 offen offset:3584 sc1
  v_mfma_f32_32x32x16_bf16 v[32:47], v[252:255], v[156:159], v[32:47]
  s_mov_b32 s69, 0
  s_waitcnt vmcnt(8)
L_chk_16:
  v_cmp_ne_u64 vcc, s[36:37], v[216:217]
  s_nop 0
  s_and_b64 vcc, vcc, -1
  s_cbranch_scc1 L_poll_15
  s_waitcnt vmcnt(7)
  v_mfma_f32_32x32x16_bf16 v[48:63], a[224:227], v[160:163], v[48:63]
  s_mul_i32 s63, s41, 262144
  s_mul_i32 s67, s39, 1024
  s_add_u32 s63, s63, s67
  s_add_u32 s63, s63, 16777216
  s_mul_i32 s62, s39, 1024
  v_mfma_f32_32x32x16_bf16 v[64:79], a[228:231], v[160:163], 0
  s_add_u32 m0, s62, 98304
  s_add_u32 s61, s63, 0
  buffer_load_dwordx4 v8, s[32:35], s61 offen sc1 lds
  s_add_u32 m0, s62, 102400
  s_waitcnt vmcnt(7)
  v_mfma_f32_32x32x16_bf16 v[48:63], a[232:235], v[164:167], v[48:63]
  s_add_u32 s61, s63, 32768
  buffer_load_dwordx4 v8, s[32:35], s61 offen sc1 lds
  s_add_u32 m0, s62, 106496
  s_add_u32 s61, s63, 4096
  v_mfma_f32_32x32x16_bf16 v[64:79], a[236:239], v[164:167], v[64:79]
  buffer_load_dwordx4 v8, s[32:35], s61 offen sc1 lds
  s_add_u32 m0, s62, 110592
  s_add_u32 s61, s63, 36864
  s_waitcnt vmcnt(8)
  v_mfma_f32_32x32x16_bf16 v[48:63], a[240:243], v[168:171], v[48:63]
  ds_write_b128 v4, v[24:27] offset:0
  ds_write_b128 v4, v[28:31] offset:1024
  buffer_load_dwordx4 v8, s[32:35], s61 offen sc1 lds
  s_add_u32 m0, s62, 114688
  s_add_u32 s61, s63, 8192
  v_mfma_f32_32x32x16_bf16 v[64:79], a[244:247], v[168:171], v[64:79]
  ds_write_b128 v5, v[32:35] offset:0
  ds_write_b128 v5, v[36:39] offset:1024
  buffer_load_dwordx4 v8, s[32:35], s61 offen sc1 lds
  s_add_u32 m0, s62, 118784
  s_add_u32 s61, s63, 40960
  s_waitcnt vmcnt(9)
  v_mfma_f32_32x32x16_bf16 v[48:63], a[248:251], v[172:175], v[48:63]
  ds_write_b128 v6, v[40:43] offset:0
  ds_write_b128 v6, v[44:47] offset:1024
  buffer_load_dwordx4 v8, s[32:35], s61 offen sc1 lds
  s_add_u32 m0, s62, 122880
  s_add_u32 s61, s63, 12288
  v_mfma_f32_32x32x16_bf16 v[64:79], a[252:255], v[172:175], v[64:79]
  buffer_load_dwordx4 v8, s[32:35], s61 offen sc1 lds
  s_add_u32 m0, s62, 126976
  s_add_u32 s61, s63, 45056
  s_waitcnt vmcnt(10)
  v_mfma_f32_32x32x16_bf16 v[48:63], v[224:227], v[128:131], v[48:63]
  s_waitcnt lgkmcnt(0)
  s_barrier
  ds_read_b128 v[80:83], v7 offset:0
  ds_read_b128 v[84:87], v7 offset:1024
  ds_read_b128 v[88:91], v7 offset:2048
  buffer_load_dwordx4 v8, s[32:35], s61 offen sc1 lds
  s_add_u32 m0, s62, 131072
  s_add_u32 s61, s63, 16384
  v_mfma_f32_32x32x16_bf16 v[64:79], v[228:231], v[128:131], v[64:79]
  ds_read_b128 v[92:95], v7 offset:3072
  ds_read_b128 v[96:99], v7 offset:4096
  ds_read_b128 v[100:103], v7 offset:5120
  buffer_load_dwordx4 v8, s[32:35], s61 offen sc1 lds
  s_waitcnt vmcnt(11)
  v_mfma_f32_32x32x16_bf16 v[48:63], v[232:235], v[132:135], v[48:63]
  v_mfma_f32_32x32x16_bf16 v[64:79], v[236:239], v[132:135], v[64:79]
  s_waitcnt lgkmcnt(5)
  v_add_f32 v16, v16, v80
  v_add_f32 v17, v17, v81
  v_add_f32 v18, v18, v82
  v_add_f32 v19, v19, v83
  s_waitcnt lgkmcnt(4)
  v_add_f32 v20, v20, v84
  s_waitcnt vmcnt(10)
  v_mfma_f32_32x32x16_bf16 v[48:63], v[240:243], v[136:139], v[48:63]
  v_add_f32 v21, v21, v85
  v_add_f32 v22, v22, v86
  v_add_f32 v23, v23, v87
  s_waitcnt lgkmcnt(3)
  v_add_f32 v16, v16, v88
  v_add_f32 v17, v17, v89
  v_mfma_f32_32x32x16_bf16 v[64:79], v[244:247], v[136:139], v[64:79]
  v_add_f32 v18, v18, v90
  v_add_f32 v19, v19, v91
  s_waitcnt lgkmcnt(2)
  v_add_f32 v20, v20, v92
  v_add_f32 v21, v21, v93
  v_add_f32 v22, v22, v94
  s_waitcnt vmcnt(9)
  v_mfma_f32_32x32x16_bf16 v[48:63], v[248:251], v[140:143], v[48:63]
  v_add_f32 v23, v23, v95
  s_waitcnt lgkmcnt(1)
  v_add_f32 v16, v16, v96
  v_add_f32 v17, v17, v97
  v_add_f32 v18, v18, v98
  v_add_f32 v19, v19, v99
  v_mfma_f32_32x32x16_bf16 v[64:79], v[252:255], v[140:143], v[64:79]
  s_waitcnt lgkmcnt(0)
  v_add_f32 v20, v20, v100
  v_add_f32 v21, v21, v101
  v_add_f32 v22, v22, v102
  v_add_f32 v23, v23, v103
  v_cvt_pk_bf16_f32 v104, v16, v17
  v_cvt_pk_bf16_f32 v105, v18, v19
  v_cvt_pk_bf16_f32 v106, v20, v21
  v_cvt_pk_bf16_f32 v107, v22, v23
  buffer_store_dwordx4 v[104:107], v2, s[32:35], s56 offen sc1
  s_barrier
  ds_write_b128 v4, v[56:59] offset:0
  ds_write_b128 v4, v[60:63] offset:1024
  ds_write_b128 v5, v[64:67] offset:0
  ds_write_b128 v5, v[68:71] offset:1024
  ds_write_b128 v6, v[72:75] offset:0
  ds_write_b128 v6, v[76:79] offset:1024
  s_waitcnt lgkmcnt(0)
  s_barrier
  ds_read_b128 v[80:83], v7 offset:0
  ds_read_b128 v[84:87], v7 offset:1024
  ds_read_b128 v[88:91], v7 offset:2048
  ds_read_b128 v[92:95], v7 offset:3072
  ds_read_b128 v[96:99], v7 offset:4096
  ds_read_b128 v[100:103], v7 offset:5120
  s_waitcnt lgkmcnt(5)
  v_pk_add_f32 v[48:49], v[48:49], v[80:81]
  v_pk_add_f32 v[50:51], v[50:51], v[82:83]
  s_waitcnt lgkmcnt(4)
  v_pk_add_f32 v[52:53], v[52:53], v[84:85]
  v_pk_add_f32 v[54:55], v[54:55], v[86:87]
  s_waitcnt lgkmcnt(3)
  v_pk_add_f32 v[48:49], v[48:49], v[88:89]
  v_pk_add_f32 v[50:51], v[50:51], v[90:91]
  s_waitcnt lgkmcnt(2)
  v_pk_add_f32 v[52:53], v[52:53], v[92:93]
  v_pk_add_f32 v[54:55], v[54:55], v[94:95]
  s_waitcnt lgkmcnt(1)
  v_pk_add_f32 v[48:49], v[48:49], v[96:97]
  v_pk_add_f32 v[50:51], v[50:51], v[98:99]
  s_waitcnt lgkmcnt(0)
  v_pk_add_f32 v[52:53], v[52:53], v[100:101]
  v_pk_add_f32 v[54:55], v[54:55], v[102:103]
  v_cvt_pk_bf16_f32 v108, v48, v49
  v_cvt_pk_bf16_f32 v109, v50, v51
  v_cvt_pk_bf16_f32 v110, v52, v53
  v_cvt_pk_bf16_f32 v111, v54, v55
  buffer_store_dwordx4 v[108:111], v2, s[32:35], s57 offen sc1
  v_mov_b32 v88, v104
  v_mov_b32 v89, v105
  v_mov_b32 v90, v106
  v_mov_b32 v91, v107
  v_mov_b32 v92, v108
  v_mov_b32 v93, v109
  v_mov_b32 v94, v110
  v_mov_b32 v95, v111
  v_dot2c_f32_bf16 v112, v104, v11
  v_dot2c_f32_bf16 v113, v104, v104
  v_dot2c_f32_bf16 v114, v108, v11
  v_dot2c_f32_bf16 v115, v108, v108
  v_dot2c_f32_bf16 v112, v105, v11
  v_dot2c_f32_bf16 v113, v105, v105
  v_dot2c_f32_bf16 v114, v109, v11
  v_dot2c_f32_bf16 v115, v109, v109
  v_dot2c_f32_bf16 v112, v106, v11
  v_dot2c_f32_bf16 v113, v106, v106
  v_dot2c_f32_bf16 v114, v110, v11
  v_dot2c_f32_bf16 v115, v110, v110
  v_dot2c_f32_bf16 v112, v107, v11
  v_dot2c_f32_bf16 v113, v107, v107
  v_dot2c_f32_bf16 v114, v111, v11
  v_dot2c_f32_bf16 v115, v111, v111
  v_lshrrev_b32 v12, 1, v8
  s_mul_i32 s65, s39, 512
  s_add_u32 s65, s65, 160000
  v_add_u32 v13, s65, v12
  v_permlane32_swap_b32 v112, v114
  v_permlane32_swap_b32 v113, v115
  v_add_u32 v12, 160000, v12
  v_pk_add_f32 v[112:113], v[112:113], v[114:115]
  ds_write_b64 v13, v[112:113]
  s_lshr_b32 s64, s43, 1
  s_and_b32 s65, s43, 1
  s_mul_i32 s66, s40, 8192
  s_mul_i32 s67, s64, 2048
  s_add_u32 s66, s66, s67
  s_mul_i32 s67, s42, 1024
  s_add_u32 s66, s66, s67
  s_mul_i32 s67, s65, 8
  s_add_u32 s66, s66, s67
  s_add_u32 s66, s66, 1048576
  s_cmp_eq_u32 s39, 0
  s_cselect_b32 s66, s66, 2147483648
  s_mov_b64 exec, 1
  s_cmp_lg_u32 s38, 0
  s_waitcnt vmcnt(0)
  s_cbranch_scc1 L_slow_18
  buffer_store_dwordx2 v[220:221], off, s[32:35], s51
L_sigd_19:
  s_mov_b64 exec, -1
  s_waitcnt lgkmcnt(0)
  s_barrier
  ds_read_b64 v[16:17], v12 offset:0
  ds_read_b64 v[18:19], v12 offset:512
  ds_read_b64 v[20:21], v12 offset:1024
  ds_read_b64 v[22:23], v12 offset:1536
  s_waitcnt lgkmcnt(2)
  v_pk_add_f32 v[16:17], v[16:17], v[18:19]
  s_waitcnt lgkmcnt(0)
  v_pk_add_f32 v[20:21], v[20:21], v[22:23]
  v_pk_add_f32 v[16:17], v[16:17], v[20:21]
  buffer_store_dwordx2 v[16:17], v8, s[32:35], s66 offen
  v_mbcnt_lo_u32_b32 v0, -1, 0
  v_mbcnt_hi_u32_b32 v0, -1, v0
  v_lshlrev_b32 v222, 3, v0
  v_lshrrev_b32 v9, 4, v0
  v_lshlrev_b32 v9, 13, v9
  v_bfe_u32 v15, v0, 0, 4
  v_lshl_add_u32 v9, v15, 4, v9
  s_mul_i32 s64, s41, 32768
  s_mul_i32 s67, s39, 256
  s_add_u32 s64, s64, s67
  s_add_u32 s64, s64, 2621440
  s_add_u32 s65, s64, 4096
  buffer_load_dwordx4 v[176:179], v9, s[32:35], s64 offen offset:0 sc1
  buffer_load_dwordx4 v[180:183], v9, s[32:35], s64 offen offset:1024 sc1
  buffer_load_dwordx4 v[184:187], v9, s[32:35], s64 offen offset:2048 sc1
  buffer_load_dwordx4 v[188:191], v9, s[32:35], s64 offen offset:3072 sc1
  buffer_load_dwordx4 v[192:195], v9, s[32:35], s65 offen offset:0 sc1
  buffer_load_dwordx4 v[196:199], v9, s[32:35], s65 offen offset:1024 sc1
  buffer_load_dwordx4 v[200:203], v9, s[32:35], s65 offen offset:2048 sc1
  buffer_load_dwordx4 v[204:207], v9, s[32:35], s65 offen offset:3072 sc1
  buffer_load_dwordx2 v[220:221], v222, s[32:35], s50 offen offset:0 sc1
  v_bfe_u32 v1, v0, 4, 1
  v_lshlrev_b32 v1, 14, v1
  v_lshrrev_b32 v15, 5, v0
  v_lshl_add_u32 v1, v15, 8, v1
  v_bfe_u32 v15, v0, 0, 4
  v_lshl_add_u32 v1, v15, 4, v1
  s_mul_i32 s54, s40, 131072
  s_mul_i32 s67, s39, 32768
  s_add_u32 s54, s54, s67
  s_add_u32 s54, s54, 4194304
  v_lshrrev_b32 v2, 5, v0
  v_lshlrev_b32 v2, 12, v2
  v_bfe_u32 v15, v0, 0, 5
  v_lshl_add_u32 v2, v15, 4, v2
  s_mul_i32 s55, s40, 8192
  s_mul_i32 s67, s39, 512
  s_add_u32 s55, s55, s67
  s_add_u32 s55, s55, 1048576
  v_mov_b32 v81, v222
  s_mul_i32 s56, s40, 458752
  s_mul_i32 s67, s39, 114688
  s_add_u32 s56, s56, s67
  s_mul_i32 s67, s41, 3584
  s_add_u32 s56, s56, s67
  s_add_u32 s56, s56, 20971520
  s_mul_i32 s59, s41, 262144
  s_mul_i32 s67, s39, 1024
  s_add_u32 s59, s59, s67
  s_add_u32 s59, s59, 16678912
  s_mul_i32 s60, s39, 1024
  v_lshlrev_b32 v6, 4, v0
  v_add_u32 v6, 98304, v6
  s_mul_i32 s64, s39, 256
  s_add_u32 s64, s64, 162048
  v_bfe_u32 v9, v0, 0, 4
  v_lshlrev_b32 v9, 4, v9
  v_add_u32 v9, s64, v9
  s_waitcnt vmcnt(7)
  v_pk_add_f32 v[176:177], v[176:177], v[180:181]
  v_pk_add_f32 v[178:179], v[178:179], v[182:183]
  s_waitcnt vmcnt(6)
  v_pk_add_f32 v[176:177], v[176:177], v[184:185]
  v_pk_add_f32 v[178:179], v[178:179], v[186:187]
  s_waitcnt vmcnt(5)
  v_pk_add_f32 v[176:177], v[176:177], v[188:189]
  v_pk_add_f32 v[178:179], v[178:179], v[190:191]
  s_waitcnt vmcnt(4)
  v_pk_add_f32 v[176:177], v[176:177], v[192:193]
  v_pk_add_f32 v[178:179], v[178:179], v[194:195]
  s_waitcnt vmcnt(3)
  v_pk_add_f32 v[176:177], v[176:177], v[196:197]
  v_pk_add_f32 v[178:179], v[178:179], v[198:199]
  s_waitcnt vmcnt(2)
  v_pk_add_f32 v[176:177], v[176:177], v[200:201]
  v_pk_add_f32 v[178:179], v[178:179], v[202:203]
  s_waitcnt vmcnt(1)
  v_pk_add_f32 v[176:177], v[176:177], v[204:205]
  v_pk_add_f32 v[178:179], v[178:179], v[206:207]
  v_mov_b32 v180, v176
  v_mov_b32 v181, v177
  v_mov_b32 v182, v178
  v_mov_b32 v183, v179
  v_permlane32_swap_b32 v176, v180
  v_permlane32_swap_b32 v177, v181
  v_permlane32_swap_b32 v178, v182
  v_permlane32_swap_b32 v179, v183
  v_add_f32 v176, v176, v180
  v_add_f32 v177, v177, v181
  v_add_f32 v178, v178, v182
  v_add_f32 v179, v179, v183
  v_mov_b32 v180, v176
  v_mov_b32 v181, v177
  v_mov_b32 v182, v178
  v_mov_b32 v183, v179
  v_permlane16_swap_b32 v176, v180
  v_permlane16_swap_b32 v177, v181
  v_permlane16_swap_b32 v178, v182
  v_permlane16_swap_b32 v179, v183
  v_add_f32 v176, v176, v180
  v_add_f32 v177, v177, v181
  v_add_f32 v178, v178, v182
  v_add_f32 v179, v179, v183
  v_cvt_pk_bf16_f32 v180, v176, v176
  v_cvt_pk_bf16_f32 v181, v177, v177
  v_cvt_pk_bf16_f32 v182, v178, v178
  v_cvt_pk_bf16_f32 v183, v179, v179
  v_lshlrev_b32 v180, 16, v180
  v_lshlrev_b32 v181, 16, v181
  v_lshlrev_b32 v182, 16, v182
  v_lshlrev_b32 v183, 16, v183
  v_sub_f32 v180, v176, v180
  v_sub_f32 v181, v177, v181
  v_sub_f32 v182, v178, v182
  v_sub_f32 v183, v179, v183
  v_cvt_pk_bf16_f32 v176, v176, v180
  v_cvt_pk_bf16_f32 v177, v177, v181
  v_cvt_pk_bf16_f32 v178, v178, v182
  v_cvt_pk_bf16_f32 v179, v179, v183
  ds_write_b128 v9, v[176:179]
  s_mul_i32 s57, s39, 6144
  s_add_u32 s57, s57, 135168
  s_mul_i32 s58, s39, 458752
  s_mul_i32 s67, s43, 128
  s_add_u32 s58, s58, s67
  v_lshlrev_b32 v80, 4, v0
  v_add_u32 v80, s57, v80
  v_bfe_u32 v14, v0, 4, 1
  v_add_u32 v14, s39, v14
  v_and_b32 v14, 3, v14
  v_lshlrev_b32 v14, 5, v14
  v_bfe_u32 v13, v0, 3, 1
  v_lshlrev_b32 v13, 6, v13
  v_xor_b32 v14, v14, v13
  v_lshrrev_b32 v7, 5, v0
  v_lshlrev_b32 v7, 10, v7
  v_bfe_u32 v15, v0, 2, 2
  v_lshl_add_u32 v7, v15, 7, v7
  v_bfe_u32 v15, v0, 0, 1
  v_lshl_add_u32 v7, v15, 4, v7
  v_bfe_u32 v15, v0, 1, 1
  v_lshl_add_u32 v7, v15, 3, v7
  v_add_u32 v7, v7, v14
  v_add_u32 v7, s57, v7
  v_bfe_u32 v14, v0, 4, 1
  v_lshlrev_b32 v14, 6, v14
  v_lshrrev_b32 v13, 3, v0
  v_lshlrev_b32 v13, 10, v13
  v_bfe_u32 v15, v0, 0, 3
  v_lshl_add_u32 v13, v15, 4, v13
  v_xor_b32 v0, v13, v14
  s_and_b32 s64, s46, 286331153
  s_and_b32 s65, s47, 286331153
  s_add_u32 s69, s36, 2
  v_mov_b32 v82, s69
  v_mov_b32 v83, s37
  s_mov_b64 exec, 1
  s_cmp_lg_u32 s38, 0
  s_cbranch_scc1 L_slow_20
  buffer_store_dwordx2 v[82:83], off, s[32:35], s51
L_sigd_21:
  s_mov_b64 exec, -1
  s_mov_b32 s69, 0
  s_waitcnt vmcnt(1)
L_chk_23:
  v_subrev_u32 v220, s36, v220
  v_xor_b32 v221, s37, v221
  v_subrev_u32 v220, 1, v220
  v_cmp_lt_u64 vcc, 31, v[220:221]
  s_nop 0
  s_and_b64 vcc, vcc, s[46:47]
  s_cbranch_scc1 L_poll_22
  s_cmp_lg_u32 s38, 0
  s_cbranch_scc1 L_inv_25
L_polld_24:
  buffer_load_dwordx4 v[96:99], v1, s[32:35], s54 offen offset:0 sc1
  buffer_load_dwordx4 v[100:103], v1, s[32:35], s54 offen offset:512 sc1
  buffer_load_dwordx4 v[104:107], v1, s[32:35], s54 offen offset:1024 sc1
  buffer_load_dwordx4 v[108:111], v1, s[32:35], s54 offen offset:1536 sc1
  buffer_load_dwordx4 v[112:115], v1, s[32:35], s54 offen offset:2048 sc1
  buffer_load_dwordx4 v[116:119], v1, s[32:35], s54 offen offset:2560 sc1
  buffer_load_dwordx4 v[120:123], v1, s[32:35], s54 offen offset:3072 sc1
  buffer_load_dwordx4 v[124:127], v1, s[32:35], s54 offen offset:3584 sc1
  s_waitcnt lgkmcnt(0)
  s_barrier
  ds_read_b128 v[16:19], v6 offset:0
  ds_read_b128 v[20:23], v6 offset:4096
  ds_read_b128 v[24:27], v6 offset:1024
  ds_read_b128 v[28:31], v6 offset:5120
  s_waitcnt vmcnt(7) lgkmcnt(2)
  v_mfma_f32_32x32x16_bf16 v[32:47], v[16:19], v[96:99], 0
  ds_read_b128 v[84:87], v6 offset:2048
  s_add_u32 s54, s54, 4096
  buffer_load_dwordx4 v[128:131], v1, s[32:35], s54 offen offset:0 sc1
  v_mfma_f32_32x32x16_bf16 v[48:63], v[20:23], v[96:99], 0
  ds_read_b128 v[16:19], v6 offset:6144
  s_waitcnt vmcnt(7) lgkmcnt(2)
  v_mfma_f32_32x32x16_bf16 v[32:47], v[24:27], v[100:103], v[32:47]
  ds_read_b128 v[20:23], v6 offset:3072
  buffer_load_dwordx4 v[132:135], v1, s[32:35], s54 offen offset:512 sc1
  v_mfma_f32_32x32x16_bf16 v[48:63], v[28:31], v[100:103], v[48:63]
  ds_read_b128 v[24:27], v6 offset:7168
  s_waitcnt vmcnt(7) lgkmcnt(2)
  v_mfma_f32_32x32x16_bf16 v[32:47], v[84:87], v[104:107], v[32:47]
  s_barrier
  ds_read_b128 v[28:31], v6 offset:8192
  buffer_load_dwordx4 v[136:139], v1, s[32:35], s54 offen offset:1024 sc1
  v_mfma_f32_32x32x16_bf16 v[48:63], v[16:19], v[104:107], v[48:63]
  ds_read_b128 v[84:87], v6 offset:12288
  s_waitcnt vmcnt(7) lgkmcnt(2)
  v_mfma_f32_32x32x16_bf16 v[32:47], v[20:23], v[108:111], v[32:47]
  ds_read_b128 v[16:19], v6 offset:9216
  buffer_load_dwordx4 v[140:143], v1, s[32:35], s54 offen offset:1536 sc1
  v_mfma_f32_32x32x16_bf16 v[48:63], v[24:27], v[108:111], v[48:63]
  ds_read_b128 v[20:23], v6 offset:13312
  s_waitcnt vmcnt(7) lgkmcnt(2)
  v_mfma_f32_32x32x16_bf16 v[32:47], v[28:31], v[112:115], v[32:47]
  ds_read_b128 v[24:27], v6 offset:10240
  buffer_load_dwordx4 v[144:147], v1, s[32:35], s54 offen offset:2048 sc1
  ds_write_b128 v80, a[0:3] offset:0
  v_mfma_f32_32x32x16_bf16 v[48:63], v[84:87], v[112:115], v[48:63]
  ds_read_b128 v[28:31], v6 offset:14336
  ds_write_b128 v80, a[4:7] offset:1024
  s_waitcnt vmcnt(7) lgkmcnt(4)
  v_mfma_f32_32x32x16_bf16 v[32:47], v[16:19], v[116:119], v[32:47]
  ds_read_b128 v[84:87], v6 offset:11264
  buffer_load_dwordx4 v[148:151], v1, s[32:35], s54 offen offset:2560 sc1
  ds_read_b64_tr_b16 a[0:1], v7 offset:0
  ds_read_b64_tr_b16 a[2:3], v7 offset:512
  v_mfma_f32_32x32x16_bf16 v[48:63], v[20:23], v[116:119], v[48:63]
  ds_read_b128 v[16:19], v6 offset:15360
  v_xor_b32 v7, 64, v7
  ds_read_b64_tr_b16 a[4:5], v7 offset:0
  s_waitcnt vmcnt(7) lgkmcnt(6)
  v_mfma_f32_32x32x16_bf16 v[32:47], v[24:27], v[120:123], v[32:47]
  s_barrier
  ds_read_b128 v[20:23], v6 offset:16384
  buffer_load_dwordx4 v[152:155], v1, s[32:35], s54 offen offset:3072 sc1
  ds_read_b64_tr_b16 a[6:7], v7 offset:512
  v_mfma_f32_32x32x16_bf16 v[48:63], v[28:31], v[120:123], v[48:63]
  ds_read_b128 v[24:27], v6 offset:20480
  s_add_u32 m0, s60, 98304
  s_add_u32 s61, s59, 49152
  buffer_load_dwordx4 v6, s[32:35], s61 offen sc1 lds
  ds_write_b128 v80, a[8:11] offset:0
  s_waitcnt vmcnt(8) lgkmcnt(5)
  v_mfma_f32_32x32x16_bf16 v[32:47], v[84:87], v[124:127], v[32:47]
  ds_read_b128 v[28:31], v6 offset:17408
  buffer_load_dwordx4 v[156:159], v1, s[32:35], s54 offen offset:3584 sc1
  ds_write_b128 v80, a[12:15] offset:1024
  v_mfma_f32_32x32x16_bf16 v[48:63], v[16:19], v[124:127], v[48:63]
  ds_read_b128 v[84:87], v6 offset:21504
  s_add_u32 m0, s60, 102400
  s_add_u32 s61, s59, 20480
  buffer_load_dwordx4 v6, s[32:35], s61 offen sc1 lds
  ds_read_b64_tr_b16 a[12:13], v7 offset:0
  s_waitcnt vmcnt(9) lgkmcnt(5)
  v_mfma_f32_32x32x16_bf16 v[32:47], v[20:23], v[128:131], v[32:47]
  ds_read_b128 v[16:19], v6 offset:18432
  s_add_u32 s54, s54, 4096
  buffer_load_dwordx4 v[160:163], v1, s[32:35], s54 offen offset:0 sc1
  buffer_load_dwordx2 v[82:83], v81, s[32:35], s50 offen offset:0 sc1
  ds_read_b64_tr_b16 a[14:15], v7 offset:512
  v_xor_b32 v7, 64, v7
  v_mfma_f32_32x32x16_bf16 v[48:63], v[24:27], v[128:131], v[48:63]
  ds_read_b128 v[20:23], v6 offset:22528
  ds_read_b64_tr_b16 a[8:9], v7 offset:0
  ds_read_b64_tr_b16 a[10:11], v7 offset:512
  s_waitcnt vmcnt(10) lgkmcnt(6)
  v_mfma_f32_32x32x16_bf16 v[32:47], v[28:31], v[132:135], v[32:47]
  ds_read_b128 v[24:27], v6 offset:19456
  buffer_load_dwordx4 v[164:167], v1, s[32:35], s54 offen offset:512 sc1
  ds_write_b128 v80, a[16:19] offset:0
  v_mfma_f32_32x32x16_bf16 v[48:63], v[84:87], v[132:135], v[48:63]
  ds_read_b128 v[28:31], v6 offset:23552
  ds_write_b128 v80, a[20:23] offset:1024
  s_waitcnt vmcnt(10) lgkmcnt(6)
  v_mfma_f32_32x32x16_bf16 v[32:47], v[16:19], v[136:139], v[32:47]
  s_barrier
  ds_read_b128 v[84:87], v6 offset:24576
  buffer_load_dwordx4 v[168:171], v1, s[32:35], s54 offen offset:1024 sc1
  ds_read_b64_tr_b16 a[16:17], v7 offset:0
  ds_read_b64_tr_b16 a[18:19], v7 offset:512
  v_mfma_f32_32x32x16_bf16 v[48:63], v[20:23], v[136:139], v[48:63]
  ds_read_b128 v[16:19], v6 offset:28672
  s_add_u32 m0, s60, 106496
  s_add_u32 s61, s59, 53248
  buffer_load_dwordx4 v6, s[32:35], s61 offen sc1 lds
  v_xor_b32 v7, 64, v7
  s_waitcnt vmcnt(11) lgkmcnt(5)
  v_mfma_f32_32x32x16_bf16 v[32:47], v[24:27], v[140:143], v[32:47]
  ds_read_b128 v[20:23], v6 offset:25600
  buffer_load_dwordx4 v[172:175], v1, s[32:35], s54 offen offset:1536 sc1
  ds_read_b64_tr_b16 a[20:21], v7 offset:0
  ds_read_b64_tr_b16 a[22:23], v7 offset:512
  v_mfma_f32_32x32x16_bf16 v[48:63], v[28:31], v[140:143], v[48:63]
  ds_read_b128 v[24:27], v6 offset:29696
  s_add_u32 m0, s60, 110592
  s_add_u32 s61, s59, 24576
  buffer_load_dwordx4 v6, s[32:35], s61 offen sc1 lds
  s_waitcnt vmcnt(12) lgkmcnt(4)
  v_mfma_f32_32x32x16_bf16 v[32:47], v[84:87], v[144:147], v[32:47]
  ds_read_b128 v[28:31], v6 offset:26624
  buffer_load_dwordx4 v[176:179], v1, s[32:35], s54 offen offset:2048 sc1
  ds_write_b128 v80, a[24:27] offset:0
  v_mfma_f32_32x32x16_bf16 v[48:63], v[16:19], v[144:147], v[48:63]
  ds_read_b128 v[84:87], v6 offset:30720
  ds_write_b128 v80, a[28:31] offset:1024
  s_waitcnt vmcnt(12) lgkmcnt(4)
  v_mfma_f32_32x32x16_bf16 v[32:47], v[20:23], v[148:151], v[32:47]
  ds_read_b128 v[16:19], v6 offset:27648
  buffer_load_dwordx4 v[180:183], v1, s[32:35], s54 offen offset:2560 sc1
  s_mov_b32 s69, 0
  s_waitcnt vmcnt(7)
L_chk_27:
  v_subrev_u32 v82, s36, v82
  v_xor_b32 v83, s37, v83
  v_subrev_u32 v82, 2, v82
  v_cmp_lt_u64 vcc, 31, v[82:83]
  s_nop 0
  s_and_b64 vcc, vcc, s[64:65]
  s_cbranch_scc1 L_poll_26
  s_cmp_lg_u32 s38, 0
  s_cbranch_scc1 L_inv_29
L_polld_28:
  ds_read_b64_tr_b16 a[28:29], v7 offset:0
  ds_read_b64_tr_b16 a[30:31], v7 offset:512
  v_mfma_f32_32x32x16_bf16 v[48:63], v[24:27], v[148:151], v[48:63]
  ds_read_b128 v[20:23], v6 offset:31744
  v_xor_b32 v7, 64, v7
  ds_read_b64_tr_b16 a[24:25], v7 offset:0
  buffer_load_dwordx4 v[64:67], v2, s[32:35], s55 offen offset:0 sc1
  s_waitcnt lgkmcnt(6)
  v_mfma_f32_32x32x16_bf16 v[32:47], v[28:31], v[152:155], v[32:47]
  s_barrier
  ds_read_b128 v[24:27], v6 offset:32768
  buffer_load_dwordx4 v[184:187], v1, s[32:35], s54 offen offset:3072 sc1
  ds_read_b64_tr_b16 a[26:27], v7 offset:512
  v_mfma_f32_32x32x16_bf16 v[48:63], v[84:87], v[152:155], v[48:63]
  ds_read_b128 v[28:31], v6 offset:0
  s_add_u32 m0, s60, 114688
  s_add_u32 s61, s59, 57344
  buffer_load_dwordx4 v6, s[32:35], s61 offen sc1 lds
  ds_write_b128 v80, a[32:35] offset:0
  s_waitcnt lgkmcnt(5)
  v_mfma_f32_32x32x16_bf16 v[32:47], v[16:19], v[156:159], v[32:47]
  ds_read_b128 v[84:87], v6 offset:33792
  buffer_load_dwordx4 v[188:191], v1, s[32:35], s54 offen offset:3584 sc1
  ds_write_b128 v80, a[36:39] offset:1024
  v_mfma_f32_32x32x16_bf16 v[48:63], v[20:23], v[156:159], v[48:63]
  ds_read_b128 v[16:19], v6 offset:1024
  s_add_u32 m0, s60, 118784
  s_add_u32 s61, s59, 28672
  buffer_load_dwordx4 v6, s[32:35], s61 offen sc1 lds
  ds_read_b64_tr_b16 a[32:33], v7 offset:0
  s_waitcnt lgkmcnt(5)
  v_mfma_f32_32x32x16_bf16 v[32:47], v[24:27], v[160:163], v[32:47]
  ds_read_b128 v[20:23], v6 offset:34816
  s_add_u32 s54, s54, 4096
  buffer_load_dwordx4 v[192:195], v1, s[32:35], s54 offen offset:0 sc1
  ds_read_b64_tr_b16 a[34:35], v7 offset:512
  v_xor_b32 v7, 64, v7
  v_mfma_f32_32x32x16_bf16 v[48:63], v[28:31], v[160:163], v[48:63]
  ds_read_b128 v[24:27], v6 offset:2048
  ds_read_b64_tr_b16 a[36:37], v7 offset:0
  ds_read_b64_tr_b16 a[38:39], v7 offset:512
  buffer_load_dwordx4 v[68:71], v2, s[32:35], s55 offen offset:2048 sc1
  s_waitcnt vmcnt(13) lgkmcnt(6)
  v_mfma_f32_32x32x16_bf16 v[32:47], v[84:87], v[164:167], v[32:47]
  ds_read_b128 v[28:31], v6 offset:35840
  buffer_load_dwordx4 v[196:199], v1, s[32:35], s54 offen offset:512 sc1
  ds_write_b128 v80, a[40:43] offset:0
  v_mfma_f32_32x32x16_bf16 v[48:63], v[16:19], v[164:167], v[48:63]
  ds_read_b128 v[84:87], v6 offset:3072
  ds_write_b128 v80, a[44:47] offset:1024
  s_waitcnt vmcnt(13) lgkmcnt(6)
  v_mfma_f32_32x32x16_bf16 v[32:47], v[20:23], v[168:171], v[32:47]
  s_waitcnt vmcnt(12)
  s_barrier
  ds_read_b128 v[16:19], v6 offset:4096
  buffer_load_dwordx4 v[200:203], v1, s[32:35], s54 offen offset:1024 sc1
  ds_read_b64_tr_b16 a[44:45], v7 offset:0
  ds_read_b64_tr_b16 a[46:47], v7 offset:512
  v_mfma_f32_32x32x16_bf16 v[48:63], v[24:27], v[168:171], v[48:63]
  ds_read_b128 v[20:23], v6 offset:8192
  s_add_u32 m0, s60, 122880
  s_add_u32 s61, s59, 61440
  buffer_load_dwordx4 v6, s[32:35], s61 offen sc1 lds
  v_xor_b32 v7, 64, v7
  s_waitcnt vmcnt(13) lgkmcnt(5)
  v_mfma_f32_32x32x16_bf16 v[32:47], v[28:31], v[172:175], v[32:47]
  ds_read_b128 v[24:27], v6 offset:5120
  buffer_load_dwordx4 v[204:207], v1, s[32:35], s54 offen offset:1536 sc1
  ds_read_b64_tr_b16 a[40:41], v7 offset:0
  ds_read_b64_tr_b16 a[42:43], v7 offset:512
  v_mfma_f32_32x32x16_bf16 v[48:63], v[84:87], v[172:175], v[48:63]
  ds_read_b128 v[28:31], v6 offset:9216
  s_add_u32 m0, s60, 126976
  s_add_u32 s61, s59, 65536
  buffer_load_dwordx4 v6, s[32:35], s61 offen sc1 lds
  s_waitcnt vmcnt(13) lgkmcnt(4)
  v_mfma_f32_32x32x16_bf16 v[32:47], v[16:19], v[176:179], v[32:47]
  ds_read_b128 v[84:87], v6 offset:6144
  buffer_load_dwordx4 v[208:211], v1, s[32:35], s54 offen offset:2048 sc1
  ds_write_b128 v80, a[48:51] offset:0
  v_mfma_f32_32x32x16_bf16 v[48:63], v[20:23], v[176:179], v[48:63]
  ds_read_b128 v[16:19], v6 offset:10240
  ds_write_b128 v80, a[52:55] offset:1024
  s_waitcnt vmcnt(13) lgkmcnt(4)
  v_mfma_f32_32x32x16_bf16 v[32:47], v[24:27], v[180:183], v[32:47]
  ds_read_b128 v[20:23], v6 offset:7168
  buffer_load_dwordx4 v[212:215], v1, s[32:35], s54 offen offset:2560 sc1
  ds_read_b64_tr_b16 a[48:49], v7 offset:0
  ds_read_b64_tr_b16 a[50:51], v7 offset:512
  v_mfma_f32_32x32x16_bf16 v[48:63], v[28:31], v[180:183], v[48:63]
  ds_read_b128 v[24:27], v6 offset:11264
  v_xor_b32 v7, 64, v7
  ds_read_b64_tr_b16 a[52:53], v7 offset:0
  s_waitcnt vmcnt(12) lgkmcnt(6)
  v_mfma_f32_32x32x16_bf16 v[32:47], v[84:87], v[184:187], v[32:47]
  s_waitcnt vmcnt(11)
  s_barrier
  ds_read_b128 v[28:31], v6 offset:12288
  buffer_load_dwordx4 v[216:219], v1, s[32:35], s54 offen offset:3072 sc1
  ds_read_b64_tr_b16 a[54:55], v7 offset:512
  v_mfma_f32_32x32x16_bf16 v[48:63], v[16:19], v[184:187], v[48:63]
  ds_read_b128 v[84:87], v6 offset:16384
  s_add_u32 m0, s60, 131072
  s_add_u32 s61, s59, 69632
  buffer_load_dwordx4 v6, s[32:35], s61 offen sc1 lds
  ds_write_b128 v80, a[56:59] offset:0
  s_waitcnt vmcnt(12) lgkmcnt(5)
  v_mfma_f32_32x32x16_bf16 v[32:47], v[20:23], v[188:191], v[32:47]
  ds_read_b128 v[16:19], v6 offset:13312
  buffer_load_dwordx4 v[220:223], v1, s[32:35], s54 offen offset:3584 sc1
  ds_write_b128 v80, a[60:63] offset:1024
  v_add_f32 v3, v64, v66
  v_mfma_f32_32x32x16_bf16 v[48:63], v[24:27], v[188:191], v[48:63]
  ds_read_b128 v[20:23], v6 offset:17408
  s_add_u32 m0, s60, 98304
  s_add_u32 s61, s59, 73728
  buffer_load_dwordx4 v6, s[32:35], s61 offen sc1 lds
  ds_read_b64_tr_b16 a[60:61], v7 offset:0
  s_waitcnt vmcnt(12) lgkmcnt(5)
  v_mfma_f32_32x32x16_bf16 v[32:47], v[28:31], v[192:195], v[32:47]
  ds_read_b128 v[24:27], v6 offset:14336
  ds_read_b64_tr_b16 a[62:63], v7 offset:512
  v_xor_b32 v7, 64, v7
  v_add_f32 v4, v65, v67
  s_waitcnt vmcnt(11)
  v_add_f32 v3, v3, v68
  v_add_f32 v4, v4, v69
  v_add_f32 v3, v3, v70
  v_add_f32 v4, v4, v71
  v_mov_b32 v8, v3
  v_mfma_f32_32x32x16_bf16 v[48:63], v[84:87], v[192:195], v[48:63]
  ds_read_b128 v[28:31], v6 offset:18432
  ds_read_b64_tr_b16 a[56:57], v7 offset:0
  ds_read_b64_tr_b16 a[58:59], v7 offset:512
  v_mov_b32 v9, v4
  v_permlane32_swap_b32 v3, v8
  s_nop 0
  v_permlane32_swap_b32 v4, v9
  v_add_f32 v3, v3, v8
  v_add_f32 v4, v4, v9
  v_mul_f32 v3, 0xbb000000, v3
  s_waitcnt vmcnt(10) lgkmcnt(6)
  v_mfma_f32_32x32x16_bf16 v[32:47], v[16:19], v[196:199], v[32:47]
  ds_read_b128 v[84:87], v6 offset:15360
  ds_write_b128 v80, a[64:67] offset:0
  v_mul_f32 v4, 0x3b000000, v4
  v_fma_f32 v8, -v3, v3, v4
  v_max_f32 v8, 0, v8
  v_add_f32 v8, 0x3727c5ac, v8
  v_rsq_f32 v4, v8
  v_mfma_f32_32x32x16_bf16 v[48:63], v[20:23], v[196:199], v[48:63]
  ds_read_b128 v[16:19], v6 offset:19456
  ds_write_b128 v80, a[68:71] offset:1024
  s_nop 0
  v_mul_f32 v5, v8, v4
  v_mul_f32 v4, 0xbfb8aa3b, v4
  v_bfe_u32 v2, v2, 2, 7
  v_add_u32 v2, 162048, v2
  v_cvt_pk_bf16_f32 v12, v3, v3
  v_lshlrev_b32 v8, 16, v12
  s_waitcnt vmcnt(9) lgkmcnt(6)
  v_mfma_f32_32x32x16_bf16 v[32:47], v[24:27], v[200:203], v[32:47]
  s_waitcnt vmcnt(8)
  s_barrier
  ds_read_b128 v[20:23], v6 offset:20480
  ds_read_b64_tr_b16 a[64:65], v7 offset:0
  ds_read_b64_tr_b16 a[66:67], v7 offset:512
  v_sub_f32 v8, v3, v8
  v_cvt_pk_bf16_f32 v8, v8, v8
  v_cndmask_b32 v12, v12, v8, s[52:53]
  ds_read_b32 v8, v2 offset:0
  v_mov_b32 v9, 0
  v_mov_b32 v10, 0
  v_mfma_f32_32x32x16_bf16 v[48:63], v[28:31], v[200:203], v[48:63]
  ds_read_b128 v[24:27], v6 offset:24576
  s_add_u32 m0, s60, 102400
  s_add_u32 s61, s59, 77824
  buffer_load_dwordx4 v6, s[32:35], s61 offen sc1 lds
  v_xor_b32 v7, 64, v7
  s_waitcnt vmcnt(8) lgkmcnt(6)
  v_mfma_f32_32x32x16_bf16 v[32:47], v[84:87], v[204:207], v[32:47]
  ds_read_b128 v[28:31], v6 offset:21504
  ds_read_b64_tr_b16 a[68:69], v7 offset:0
  ds_read_b64_tr_b16 a[70:71], v7 offset:512
  v_mov_b32 v11, 0
  v_mov_b32 v13, 0
  v_mov_b32 v14, 0
  v_mov_b32 v15, 0
  v_bfe_u32 v3, v1, 14, 1
  v_mul_u32_u24 v3, 40960, v3
  v_mfma_f32_32x32x16_bf16 v[48:63], v[16:19], v[204:207], v[48:63]
  ds_read_b128 v[84:87], v6 offset:25600
  s_add_u32 m0, s60, 106496
  s_add_u32 s61, s59, 81920
  buffer_load_dwordx4 v6, s[32:35], s61 offen sc1 lds
  s_waitcnt vmcnt(7) lgkmcnt(4)
  v_mfma_f32_32x32x16_bf16 v[32:47], v[20:23], v[208:211], v[32:47]
  ds_read_b128 v[16:19], v6 offset:22528
  ds_write_b128 v80, a[72:75] offset:0
  v_add_u32 v1, v1, v3
  v_mfma_f32_32x32x16_bf16 v[48:63], v[24:27], v[208:211], v[48:63]
  ds_read_b128 v[20:23], v6 offset:26624
  ds_write_b128 v80, a[76:79] offset:1024
  s_waitcnt vmcnt(6) lgkmcnt(4)
  v_mfma_f32_32x32x16_bf16 v[32:47], v[28:31], v[212:215], v[32:47]
  ds_read_b128 v[24:27], v6 offset:23552
  ds_read_b64_tr_b16 a[76:77], v7 offset:0
  ds_read_b64_tr_b16 a[78:79], v7 offset:512
  v_mfma_f32_32x32x16_bf16 v[48:63], v[84:87], v[212:215], v[48:63]
  ds_read_b128 v[28:31], v6 offset:27648
  v_xor_b32 v7, 64, v7
  ds_read_b64_tr_b16 a[72:73], v7 offset:0
  s_waitcnt vmcnt(5) lgkmcnt(6)
  v_mfma_f32_32x32x16_bf16 v[32:47], v[16:19], v[216:219], v[32:47]
  s_waitcnt vmcnt(4)
  s_barrier
  ds_read_b128 v[84:87], v6 offset:28672
  ds_read_b64_tr_b16 a[74:75], v7 offset:512
  v_mfma_f32_32x32x16_bf16 v[48:63], v[20:23], v[216:219], v[48:63]
  ds_read_b128 v[16:19], v6 offset:29696
  s_add_u32 m0, s60, 110592
  s_add_u32 s61, s59, 86016
  buffer_load_dwordx4 v6, s[32:35], s61 offen sc1 lds
  ds_write_b128 v80, a[80:83] offset:0
  s_waitcnt vmcnt(4) lgkmcnt(5)
  v_mfma_f32_32x32x16_bf16 v[32:47], v[24:27], v[220:223], v[32:47]
  v_mfma_f32_32x32x16_bf16 v[32:47], v[8:11], v[12:15], v[32:47]
  ds_read_b32 v8, v2 offset:128
  ds_read_b128 v[20:23], v6 offset:30720
  ds_write_b128 v80, a[84:87] offset:1024
  v_mfma_f32_32x32x16_bf16 v[48:63], v[28:31], v[220:223], v[48:63]
  s_waitcnt lgkmcnt(2)
  v_mfma_f32_32x32x16_bf16 v[48:63], v[8:11], v[12:15], v[48:63]
  ds_read_b32 v8, v2 offset:256
  ds_read_b128 v[24:27], v6 offset:31744
  s_add_u32 m0, s60, 114688
  s_add_u32 s61, s59, 90112
  buffer_load_dwordx4 v6, s[32:35], s61 offen sc1 lds
  ds_read_b64_tr_b16 a[80:81], v7 offset:0
  v_mfma_f32_32x32x16_bf16 v[64:79], v[84:87], v[96:99], 0
  ds_read_b128 v[28:31], v6 offset:32768
  ds_read_b64_tr_b16 a[82:83], v7 offset:512
  v_xor_b32 v7, 64, v7
  ds_read_b64_tr_b16 a[84:85], v7 offset:0
  ds_read_b64_tr_b16 a[86:87], v7 offset:512
  s_waitcnt lgkmcnt(0)
  s_add_u32 m0, s57, 0
  s_add_u32 s62, s58, 180224
  buffer_load_dwordx4 v0, s[24:27], s62 offen lds
  v_mfma_f32_32x32x16_bf16 v[64:79], v[16:19], v[100:103], v[64:79]
  ds_read_b128 v[84:87], v6 offset:33792
  s_add_u32 m0, s57, 1024
  s_add_u32 s62, s58, 188416
  buffer_load_dwordx4 v0, s[24:27], s62 offen lds
  v_mfma_f32_32x32x16_bf16 v[64:79], v[20:23], v[104:107], v[64:79]
  ds_read_b128 v[16:19], v6 offset:34816
  v_mul_f32 v32, v4, v32
  v_mul_f32 v33, v4, v33
  v_mul_f32 v34, v4, v34
  v_mul_f32 v35, v4, v35
  v_exp_f32 v32, v32
  v_exp_f32 v33, v33
  v_mfma_f32_32x32x16_bf16 v[64:79], v[24:27], v[108:111], v[64:79]
  ds_read_b128 v[20:23], v6 offset:35840
  v_exp_f32 v34, v34
  v_exp_f32 v35, v35
  v_fma_f32 v32, v32, v5, v5
  v_fma_f32 v33, v33, v5, v5
  v_fma_f32 v34, v34, v5, v5
  v_fma_f32 v35, v35, v5, v5
  s_waitcnt lgkmcnt(2)
  v_mfma_f32_32x32x16_bf16 v[64:79], v[28:31], v[112:115], v[64:79]
  s_waitcnt vmcnt(5)
  s_barrier
  ds_read_b128 v[24:27], v6 offset:0
  v_rcp_f32 v32, v32
  v_rcp_f32 v33, v33
  v_rcp_f32 v34, v34
  v_rcp_f32 v35, v35
  v_mfma_f32_32x32x16_bf16 v[64:79], v[84:87], v[116:119], v[64:79]
  ds_read_b128 v[28:31], v6 offset:1024
  s_add_u32 m0, s60, 118784
  s_add_u32 s61, s59, 94208
  buffer_load_dwordx4 v6, s[32:35], s61 offen sc1 lds
  v_mul_f32 v40, v40, v32
  s_waitcnt lgkmcnt(2)
  v_mfma_f32_32x32x16_bf16 v[64:79], v[16:19], v[120:123], v[64:79]
  ds_read_b128 v[84:87], v6 offset:2048
  v_mul_f32 v41, v41, v33
  v_mul_f32 v42, v42, v34
  v_mul_f32 v43, v43, v35
  v_mul_f32 v36, v4, v36
  v_mul_f32 v37, v4, v37
  v_mul_f32 v38, v4, v38
  v_mul_f32 v39, v4, v39
  v_mfma_f32_32x32x16_bf16 v[64:79], v[20:23], v[124:127], v[64:79]
  ds_read_b128 v[16:19], v6 offset:3072
  s_add_u32 m0, s60, 122880
  s_add_u32 s61, s59, 98304
  buffer_load_dwordx4 v6, s[32:35], s61 offen sc1 lds
  s_waitcnt lgkmcnt(2)
  v_mfma_f32_32x32x16_bf16 v[64:79], v[24:27], v[128:131], v[64:79]
  ds_read_b128 v[20:23], v6 offset:4096
  s_add_u32 m0, s57, 2048
  s_add_u32 s62, s58, 196608
  buffer_load_dwordx4 v0, s[24:27], s62 offen lds
  v_exp_f32 v36, v36
  v_exp_f32 v37, v37
  v_exp_f32 v38, v38
  v_mfma_f32_32x32x16_bf16 v[64:79], v[28:31], v[132:135], v[64:79]
  ds_read_b128 v[24:27], v6 offset:5120
  s_add_u32 m0, s60, 126976
  s_add_u32 s61, s59, 102400
  buffer_load_dwordx4 v6, s[32:35], s61 offen sc1 lds
  s_waitcnt lgkmcnt(2)
  v_mfma_f32_32x32x16_bf16 v[64:79], v[84:87], v[136:139], v[64:79]
  ds_read_b128 v[28:31], v6 offset:6144
  s_add_u32 m0, s57, 3072
  s_add_u32 s62, s58, 204800
  buffer_load_dwordx4 v0, s[24:27], s62 offen lds
  v_exp_f32 v39, v39
  v_fma_f32 v36, v36, v5, v5
  v_fma_f32 v37, v37, v5, v5
  v_fma_f32 v38, v38, v5, v5
  v_fma_f32 v39, v39, v5, v5
  v_mfma_f32_32x32x16_bf16 v[64:79], v[16:19], v[140:143], v[64:79]
  ds_read_b128 v[84:87], v6 offset:7168
  v_rcp_f32 v36, v36
  v_rcp_f32 v37, v37
  v_rcp_f32 v38, v38
  v_rcp_f32 v39, v39
  s_waitcnt lgkmcnt(2)
  v_mfma_f32_32x32x16_bf16 v[64:79], v[20:23], v[144:147], v[64:79]
  v_mfma_f32_32x32x16_bf16 v[64:79], v[8:11], v[12:15], v[64:79]
  ds_read_b32 v8, v2 offset:384
  s_waitcnt vmcnt(8)
  s_barrier
  ds_read_b128 v[16:19], v6 offset:8192
  v_mul_f32 v44, v44, v36
  v_mul_f32 v45, v45, v37
  v_mul_f32 v46, v46, v38
  v_mul_f32 v47, v47, v39
  v_cvt_pk_bf16_f32 v32, v40, v41
  v_cvt_pk_bf16_f32 v33, v42, v43
  v_cvt_pk_bf16_f32 v34, v44, v45
  v_cvt_pk_bf16_f32 v35, v46, v47
  v_mfma_f32_32x32x16_bf16 v[64:79], v[24:27], v[148:151], v[64:79]
  ds_read_b128 v[20:23], v6 offset:9216
  s_add_u32 m0, s60, 131072
  s_add_u32 s61, s59, 106496
  buffer_load_dwordx4 v6, s[32:35], s61 offen sc1 lds
  s_waitcnt lgkmcnt(3)
  v_mfma_f32_32x32x16_bf16 v[64:79], v[28:31], v[152:155], v[64:79]
  ds_read_b128 v[24:27], v6 offset:10240
  buffer_store_dwordx4 v[32:35], v1, s[32:35], s56 offen offset:0 sc1
  v_mfma_f32_32x32x16_bf16 v[64:79], v[84:87], v[156:159], v[64:79]
  ds_read_b128 v[28:31], v6 offset:11264
  s_add_u32 m0, s60, 98304
  s_add_u32 s61, s59, 110592
  buffer_load_dwordx4 v6, s[32:35], s61 offen sc1 lds
  s_waitcnt lgkmcnt(2)
  v_mfma_f32_32x32x16_bf16 v[64:79], v[16:19], v[160:163], v[64:79]
  ds_read_b128 v[84:87], v6 offset:12288
  s_add_u32 m0, s57, 4096
  s_add_u32 s62, s58, 212992
  buffer_load_dwordx4 v0, s[24:27], s62 offen lds
  v_mfma_f32_32x32x16_bf16 v[64:79], v[20:23], v[164:167], v[64:79]
  ds_read_b128 v[16:19], v6 offset:13312
  s_add_u32 m0, s57, 5120
  s_add_u32 s62, s58, 221184
  buffer_load_dwordx4 v0, s[24:27], s62 offen lds
  v_mul_f32 v48, v4, v48
  v_mul_f32 v49, v4, v49
  v_mul_f32 v50, v4, v50
  v_mul_f32 v51, v4, v51
  v_exp_f32 v48, v48
  s_waitcnt lgkmcnt(2)
  v_mfma_f32_32x32x16_bf16 v[64:79], v[24:27], v[168:171], v[64:79]
  ds_read_b128 v[20:23], v6 offset:14336
  v_exp_f32 v49, v49
  v_exp_f32 v50, v50
  v_exp_f32 v51, v51
  v_fma_f32 v48, v48, v5, v5
  v_fma_f32 v49, v49, v5, v5
  v_mfma_f32_32x32x16_bf16 v[64:79], v[28:31], v[172:175], v[64:79]
  ds_read_b128 v[24:27], v6 offset:15360
  v_fma_f32 v50, v50, v5, v5
  v_fma_f32 v51, v51, v5, v5
  v_rcp_f32 v48, v48
  v_rcp_f32 v49, v49
  v_rcp_f32 v50, v50
  s_waitcnt lgkmcnt(2)
  v_mfma_f32_32x32x16_bf16 v[64:79], v[84:87], v[176:179], v[64:79]
  s_waitcnt vmcnt(9)
  s_barrier
  ds_read_b128 v[28:31], v6 offset:16384
  v_rcp_f32 v51, v51
  v_mul_f32 v56, v56, v48
  v_mul_f32 v57, v57, v49
  v_mul_f32 v58, v58, v50
  v_mul_f32 v59, v59, v51
  v_mul_f32 v52, v4, v52
  v_mul_f32 v53, v4, v53
  v_mfma_f32_32x32x16_bf16 v[64:79], v[16:19], v[180:183], v[64:79]
  ds_read_b128 v[84:87], v6 offset:17408
  s_add_u32 m0, s60, 102400
  s_add_u32 s61, s59, 114688
  buffer_load_dwordx4 v6, s[32:35], s61 offen sc1 lds
  s_waitcnt lgkmcnt(2)
  v_mfma_f32_32x32x16_bf16 v[64:79], v[20:23], v[184:187], v[64:79]
  ds_read_b128 v[16:19], v6 offset:18432
  ds_read_b64_tr_b16 a[92:93], v7 offset:0
  ds_read_b64_tr_b16 a[94:95], v7 offset:512
  v_mul_f32 v54, v4, v54
  v_mul_f32 v55, v4, v55
  v_exp_f32 v52, v52
  v_exp_f32 v53, v53
  v_mfma_f32_32x32x16_bf16 v[64:79], v[24:27], v[188:191], v[64:79]
  ds_read_b128 v[20:23], v6 offset:19456
  s_add_u32 m0, s60, 106496
  s_add_u32 s61, s59, 118784
  buffer_load_dwordx4 v6, s[32:35], s61 offen sc1 lds
  v_xor_b32 v7, 64, v7
  s_waitcnt lgkmcnt(4)
  v_mfma_f32_32x32x16_bf16 v[64:79], v[28:31], v[192:195], v[64:79]
  ds_read_b128 v[24:27], v6 offset:20480
  ds_read_b64_tr_b16 a[88:89], v7 offset:0
  ds_read_b64_tr_b16 a[90:91], v7 offset:512
  s_waitcnt lgkmcnt(0)
  s_add_u32 m0, s57, 0
  s_add_u32 s62, s58, 229376
  buffer_load_dwordx4 v0, s[24:27], s62 offen lds
  v_exp_f32 v54, v54
  v_exp_f32 v55, v55
  v_fma_f32 v52, v52, v5, v5
  v_fma_f32 v53, v53, v5, v5
  v_mfma_f32_32x32x16_bf16 v[64:79], v[84:87], v[196:199], v[64:79]
  ds_read_b128 v[28:31], v6 offset:21504
  s_add_u32 m0, s57, 1024
  s_add_u32 s62, s58, 237568
  buffer_load_dwordx4 v0, s[24:27], s62 offen lds
  v_fma_f32 v54, v54, v5, v5
  v_fma_f32 v55, v55, v5, v5
  v_rcp_f32 v52, v52
  v_rcp_f32 v53, v53
  v_mfma_f32_32x32x16_bf16 v[64:79], v[16:19], v[200:203], v[64:79]
  ds_read_b128 v[84:87], v6 offset:22528
  v_rcp_f32 v54, v54
  v_rcp_f32 v55, v55
  v_mul_f32 v60, v60, v52
  v_mul_f32 v61, v61, v53
  v_mul_f32 v62, v62, v54
  v_mul_f32 v63, v63, v55
  v_mfma_f32_32x32x16_bf16 v[64:79], v[20:23], v[204:207], v[64:79]
  ds_read_b128 v[16:19], v6 offset:23552
  v_cvt_pk_bf16_f32 v48, v56, v57
  v_cvt_pk_bf16_f32 v49, v58, v59
  v_cvt_pk_bf16_f32 v50, v60, v61
  v_cvt_pk_bf16_f32 v51, v62, v63
  buffer_store_dwordx4 v[48:51], v1, s[32:35], s56 offen offset:512 sc1
  s_waitcnt lgkmcnt(2)
  v_mfma_f32_32x32x16_bf16 v[64:79], v[24:27], v[208:211], v[64:79]
  s_waitcnt vmcnt(11)
  s_barrier
  ds_read_b128 v[20:23], v6 offset:24576
  v_mfma_f32_32x32x16_bf16 v[64:79], v[28:31], v[212:215], v[64:79]
  ds_read_b128 v[24:27], v6 offset:25600
  s_add_u32 m0, s60, 110592
  s_add_u32 s61, s59, 122880
  buffer_load_dwordx4 v6, s[32:35], s61 offen sc1 lds
  s_waitcnt vmcnt(11) lgkmcnt(2)
  v_mfma_f32_32x32x16_bf16 v[64:79], v[84:87], v[216:219], v[64:79]
  ds_read_b128 v[28:31], v6 offset:26624
  ds_read_b64_tr_b16 a[96:97], v7 offset:2048
  ds_read_b64_tr_b16 a[98:99], v7 offset:2560
  v_mfma_f32_32x32x16_bf16 v[64:79], v[16:19], v[220:223], v[64:79]
  ds_read_b128 v[84:87], v6 offset:27648
  s_add_u32 m0, s60, 114688
  s_add_u32 s61, s59, 126976
  buffer_load_dwordx4 v6, s[32:35], s61 offen sc1 lds
  v_xor_b32 v7, 64, v7
  s_waitcnt lgkmcnt(4)
  v_mfma_f32_32x32x16_bf16 v[32:47], v[20:23], v[96:99], 0
  ds_read_b128 v[16:19], v6 offset:28672
  ds_read_b64_tr_b16 a[100:101], v7 offset:2048
  ds_read_b64_tr_b16 a[102:103], v7 offset:2560
  s_waitcnt lgkmcnt(0)
  s_add_u32 m0, s57, 2048
  s_add_u32 s62, s58, 245760
  buffer_load_dwordx4 v0, s[24:27], s62 offen lds
  v_mfma_f32_32x32x16_bf16 v[32:47], v[24:27], v[100:103], v[32:47]
  ds_read_b128 v[20:23], v6 offset:29696
  s_add_u32 m0, s57, 3072
  s_add_u32 s62, s58, 253952
  buffer_load_dwordx4 v0, s[24:27], s62 offen lds
  v_mfma_f32_32x32x16_bf16 v[32:47], v[28:31], v[104:107], v[32:47]
  ds_read_b128 v[24:27], v6 offset:30720
  v_mfma_f32_32x32x16_bf16 v[32:47], v[84:87], v[108:111], v[32:47]
  ds_read_b128 v[28:31], v6 offset:31744
  v_mul_f32 v64, v4, v64
  v_mul_f32 v65, v4, v65
  v_mul_f32 v66, v4, v66
  v_mul_f32 v67, v4, v67
  v_exp_f32 v64, v64
  v_exp_f32 v65, v65
  s_waitcnt lgkmcnt(2)
  v_mfma_f32_32x32x16_bf16 v[32:47], v[16:19], v[112:115], v[32:47]
  s_waitcnt vmcnt(11)
  s_barrier
  ds_read_b128 v[84:87], v6 offset:32768
  v_exp_f32 v66, v66
  v_exp_f32 v67, v67
  v_fma_f32 v64, v64, v5, v5
  v_fma_f32 v65, v65, v5, v5
  v_fma_f32 v66, v66, v5, v5
  v_fma_f32 v67, v67, v5, v5
  v_mfma_f32_32x32x16_bf16 v[32:47], v[20:23], v[116:119], v[32:47]
  ds_read_b128 v[16:19], v6 offset:33792
  s_add_u32 m0, s60, 118784
  s_add_u32 s61, s59, 131072
  buffer_load_dwordx4 v6, s[32:35], s61 offen sc1 lds
  s_waitcnt vmcnt(10) lgkmcnt(2)
  v_mfma_f32_32x32x16_bf16 v[32:47], v[24:27], v[120:123], v[32:47]
  ds_read_b128 v[20:23], v6 offset:34816
  ds_read_b64_tr_b16 a[108:109], v7 offset:4096
  ds_read_b64_tr_b16 a[110:111], v7 offset:4608
  v_rcp_f32 v64, v64
  v_rcp_f32 v65, v65
  v_rcp_f32 v66, v66
  v_mfma_f32_32x32x16_bf16 v[32:47], v[28:31], v[124:127], v[32:47]
  ds_read_b128 v[24:27], v6 offset:35840
  s_add_u32 m0, s60, 122880
  s_add_u32 s61, s59, 135168
  buffer_load_dwordx4 v6, s[32:35], s61 offen sc1 lds
  v_xor_b32 v7, 64, v7
  s_waitcnt lgkmcnt(4)
  v_mfma_f32_32x32x16_bf16 v[32:47], v[84:87], v[128:131], v[32:47]
  ds_read_b128 v[28:31], v6 offset:0
  ds_read_b64_tr_b16 a[104:105], v7 offset:4096
  ds_read_b64_tr_b16 a[106:107], v7 offset:4608
  v_rcp_f32 v67, v67
  v_mul_f32 v72, v72, v64
  v_mul_f32 v73, v73, v65
  v_mul_f32 v74, v74, v66
  v_mul_f32 v75, v75, v67
  v_mfma_f32_32x32x16_bf16 v[32:47], v[16:19], v[132:135], v[32:47]
  ds_read_b128 v[84:87], v6 offset:1024
  s_waitcnt lgkmcnt(1)
  s_add_u32 m0, s57, 4096
  s_add_u32 s62, s58, 262144
  buffer_load_dwordx4 v0, s[24:27], s62 offen lds
  v_mul_f32 v68, v4, v68
  v_mul_f32 v69, v4, v69
  v_mul_f32 v70, v4, v70
  v_mul_f32 v71, v4, v71
  v_exp_f32 v68, v68
  v_mfma_f32_32x32x16_bf16 v[32:47], v[20:23], v[136:139], v[32:47]
  ds_read_b128 v[16:19], v6 offset:2048
  s_add_u32 m0, s57, 5120
  s_add_u32 s62, s58, 270336
  buffer_load_dwordx4 v0, s[24:27], s62 offen lds
  v_exp_f32 v69, v69
  v_exp_f32 v70, v70
  v_exp_f32 v71, v71
  v_fma_f32 v68, v68, v5, v5
  v_mfma_f32_32x32x16_bf16 v[32:47], v[24:27], v[140:143], v[32:47]
  ds_read_b128 v[20:23], v6 offset:3072
  v_fma_f32 v69, v69, v5, v5
  v_fma_f32 v70, v70, v5, v5
  v_fma_f32 v71, v71, v5, v5
  v_rcp_f32 v68, v68
  v_rcp_f32 v69, v69
  s_waitcnt lgkmcnt(2)
  v_mfma_f32_32x32x16_bf16 v[32:47], v[28:31], v[144:147], v[32:47]
  v_mfma_f32_32x32x16_bf16 v[32:47], v[8:11], v[12:15], v[32:47]
  ds_read_b32 v8, v2 offset:512
  s_waitcnt vmcnt(11)
  s_barrier
  ds_read_b128 v[24:27], v6 offset:4096
  v_rcp_f32 v70, v70
  v_rcp_f32 v71, v71
  v_mul_f32 v76, v76, v68
  v_mul_f32 v77, v77, v69
  v_mul_f32 v78, v78, v70
  v_mul_f32 v79, v79, v71
  v_mfma_f32_32x32x16_bf16 v[32:47], v[84:87], v[148:151], v[32:47]
  ds_read_b128 v[28:31], v6 offset:5120
  s_add_u32 m0, s60, 126976
  s_add_u32 s61, s59, 139264
  buffer_load_dwordx4 v6, s[32:35], s61 offen sc1 lds
  s_waitcnt vmcnt(10) lgkmcnt(3)
  v_mfma_f32_32x32x16_bf16 v[32:47], v[16:19], v[152:155], v[32:47]
  ds_read_b128 v[84:87], v6 offset:6144
  ds_read_b64_tr_b16 a[112:113], v7 offset:0
  ds_read_b64_tr_b16 a[114:115], v7 offset:512
  v_cvt_pk_bf16_f32 v64, v72, v73
  v_cvt_pk_bf16_f32 v65, v74, v75
  v_cvt_pk_bf16_f32 v66, v76, v77
  v_cvt_pk_bf16_f32 v67, v78, v79
  buffer_store_dwordx4 v[64:67], v1, s[32:35], s56 offen offset:1024 sc1
  v_mfma_f32_32x32x16_bf16 v[32:47], v[20:23], v[156:159], v[32:47]
  ds_read_b128 v[16:19], v6 offset:7168
  s_add_u32 m0, s60, 131072
  s_add_u32 s61, s59, 143360
  buffer_load_dwordx4 v6, s[32:35], s61 offen sc1 lds
  v_xor_b32 v7, 64, v7
  s_waitcnt lgkmcnt(4)
  v_mfma_f32_32x32x16_bf16 v[32:47], v[24:27], v[160:163], v[32:47]
  ds_read_b128 v[20:23], v6 offset:8192
  ds_read_b64_tr_b16 a[116:117], v7 offset:0
  ds_read_b64_tr_b16 a[118:119], v7 offset:512
  v_mfma_f32_32x32x16_bf16 v[32:47], v[28:31], v[164:167], v[32:47]
  ds_read_b128 v[24:27], v6 offset:9216
  s_waitcnt lgkmcnt(1)
  s_add_u32 m0, s57, 0
  s_add_u32 s62, s58, 278528
  buffer_load_dwordx4 v0, s[24:27], s62 offen lds
  v_mfma_f32_32x32x16_bf16 v[32:47], v[84:87], v[168:171], v[32:47]
  ds_read_b128 v[28:31], v6 offset:10240
  s_add_u32 m0, s57, 1024
  s_add_u32 s62, s58, 286720
  buffer_load_dwordx4 v0, s[24:27], s62 offen lds
  v_mfma_f32_32x32x16_bf16 v[32:47], v[16:19], v[172:175], v[32:47]
  ds_read_b128 v[84:87], v6 offset:11264
  s_waitcnt lgkmcnt(2)
  v_mfma_f32_32x32x16_bf16 v[32:47], v[20:23], v[176:179], v[32:47]
  s_waitcnt vmcnt(11)
  s_barrier
  ds_read_b128 v[16:19], v6 offset:12288
  v_mfma_f32_32x32x16_bf16 v[32:47], v[24:27], v[180:183], v[32:47]
  ds_read_b128 v[20:23], v6 offset:13312
  s_add_u32 m0, s60, 98304
  s_add_u32 s61, s59, 147456
  buffer_load_dwordx4 v6, s[32:35], s61 offen sc1 lds
  s_waitcnt vmcnt(10) lgkmcnt(2)
  v_mfma_f32_32x32x16_bf16 v[32:47], v[28:31], v[184:187], v[32:47]
  ds_read_b128 v[24:27], v6 offset:14336
  ds_read_b64_tr_b16 a[124:125], v7 offset:2048
  ds_read_b64_tr_b16 a[126:127], v7 offset:2560
  v_mfma_f32_32x32x16_bf16 v[32:47], v[84:87], v[188:191], v[32:47]
  ds_read_b128 v[28:31], v6 offset:15360
  s_add_u32 m0, s60, 102400
  s_add_u32 s61, s59, 151552
  buffer_load_dwordx4 v6, s[32:35], s61 offen sc1 lds
  v_xor_b32 v7, 64, v7
  s_waitcnt lgkmcnt(4)
  v_mfma_f32_32x32x16_bf16 v[32:47], v[16:19], v[192:195], v[32:47]
  ds_read_b128 v[84:87], v6 offset:16384
  ds_read_b64_tr_b16 a[120:121], v7 offset:2048
  ds_read_b64_tr_b16 a[122:123], v7 offset:2560
  v_mfma_f32_32x32x16_bf16 v[32:47], v[20:23], v[196:199], v[32:47]
  ds_read_b128 v[16:19], v6 offset:17408
  s_waitcnt lgkmcnt(1)
  s_add_u32 m0, s57, 2048
  s_add_u32 s62, s58, 294912
  buffer_load_dwordx4 v0, s[24:27], s62 offen lds
  v_mfma_f32_32x32x16_bf16 v[32:47], v[24:27], v[200:203], v[32:47]
  ds_read_b128 v[20:23], v6 offset:18432
  s_add_u32 m0, s57, 3072
  s_add_u32 s62, s58, 303104
  buffer_load_dwordx4 v0, s[24:27], s62 offen lds
  v_mfma_f32_32x32x16_bf16 v[32:47], v[28:31], v[204:207], v[32:47]
  ds_read_b128 v[24:27], v6 offset:19456
  s_waitcnt lgkmcnt(2)
  v_mfma_f32_32x32x16_bf16 v[32:47], v[84:87], v[208:211], v[32:47]
  s_waitcnt vmcnt(11)
  s_barrier
  ds_read_b128 v[28:31], v6 offset:20480
  v_mfma_f32_32x32x16_bf16 v[32:47], v[16:19], v[212:215], v[32:47]
  ds_read_b128 v[84:87], v6 offset:21504
  s_add_u32 m0, s60, 106496
  s_add_u32 s61, s59, 155648
  buffer_load_dwordx4 v6, s[32:35], s61 offen sc1 lds
  s_waitcnt lgkmcnt(2)
  v_mfma_f32_32x32x16_bf16 v[32:47], v[20:23], v[216:219], v[32:47]
  ds_read_b128 v[16:19], v6 offset:22528
  s_waitcnt vmcnt(10)
  ds_read_b64_tr_b16 a[128:129], v7 offset:4096
  v_mfma_f32_32x32x16_bf16 v[32:47], v[24:27], v[220:223], v[32:47]
  ds_read_b128 v[20:23], v6 offset:23552
  s_add_u32 m0, s60, 110592
  s_add_u32 s61, s59, 159744
  buffer_load_dwordx4 v6, s[32:35], s61 offen sc1 lds
  ds_read_b64_tr_b16 a[130:131], v7 offset:4608
  s_waitcnt lgkmcnt(4)
  v_mfma_f32_32x32x16_bf16 v[48:63], v[28:31], v[96:99], 0
  ds_read_b128 v[24:27], v6 offset:24576
  v_xor_b32 v7, 64, v7
  ds_read_b64_tr_b16 a[132:133], v7 offset:4096
  v_mfma_f32_32x32x16_bf16 v[48:63], v[84:87], v[100:103], v[48:63]
  ds_read_b128 v[28:31], v6 offset:25600
  ds_read_b64_tr_b16 a[134:135], v7 offset:4608
  s_waitcnt lgkmcnt(0)
  s_add_u32 m0, s57, 4096
  s_add_u32 s62, s58, 311296
  buffer_load_dwordx4 v0, s[24:27], s62 offen lds
  v_mfma_f32_32x32x16_bf16 v[48:63], v[16:19], v[104:107], v[48:63]
  ds_read_b128 v[84:87], v6 offset:26624
  s_add_u32 m0, s57, 5120
  s_add_u32 s62, s58, 319488
  buffer_load_dwordx4 v0, s[24:27], s62 offen lds
  v_mfma_f32_32x32x16_bf16 v[48:63], v[20:23], v[108:111], v[48:63]
  ds_read_b128 v[16:19], v6 offset:27648
  v_mul_f32 v32, v4, v32
  v_mul_f32 v33, v4, v33
  v_mul_f32 v34, v4, v34
  v_mul_f32 v35, v4, v35
  v_exp_f32 v32, v32
  v_exp_f32 v33, v33
  v_mfma_f32_32x32x16_bf16 v[48:63], v[24:27], v[112:115], v[48:63]
  s_waitcnt vmcnt(10)
  s_barrier
  ds_read_b128 v[20:23], v6 offset:28672
  v_exp_f32 v34, v34
  v_exp_f32 v35, v35
  v_fma_f32 v32, v32, v5, v5
  v_fma_f32 v33, v33, v5, v5
  v_fma_f32 v34, v34, v5, v5
  v_fma_f32 v35, v35, v5, v5
  v_mfma_f32_32x32x16_bf16 v[48:63], v[28:31], v[116:119], v[48:63]
  ds_read_b128 v[24:27], v6 offset:29696
  s_add_u32 m0, s60, 114688
  s_add_u32 s61, s59, 163840
  buffer_load_dwordx4 v6, s[32:35], s61 offen sc1 lds
  s_waitcnt lgkmcnt(2)
  v_mfma_f32_32x32x16_bf16 v[48:63], v[84:87], v[120:123], v[48:63]
  ds_read_b128 v[28:31], v6 offset:30720
  s_waitcnt vmcnt(9)
  ds_read_b64_tr_b16 a[140:141], v7 offset:0
  v_rcp_f32 v32, v32
  v_rcp_f32 v33, v33
  v_rcp_f32 v34, v34
  v_mfma_f32_32x32x16_bf16 v[48:63], v[16:19], v[124:127], v[48:63]
  ds_read_b128 v[84:87], v6 offset:31744
  s_add_u32 m0, s60, 118784
  s_add_u32 s61, s59, 167936
  buffer_load_dwordx4 v6, s[32:35], s61 offen sc1 lds
  ds_read_b64_tr_b16 a[142:143], v7 offset:512
  s_waitcnt lgkmcnt(4)
  v_mfma_f32_32x32x16_bf16 v[48:63], v[20:23], v[128:131], v[48:63]
  ds_read_b128 v[16:19], v6 offset:32768
  v_xor_b32 v7, 64, v7
  ds_read_b64_tr_b16 a[136:137], v7 offset:0
  v_rcp_f32 v35, v35
  v_mul_f32 v40, v40, v32
  v_mul_f32 v41, v41, v33
  v_mul_f32 v42, v42, v34
  v_mul_f32 v43, v43, v35
  v_mfma_f32_32x32x16_bf16 v[48:63], v[24:27], v[132:135], v[48:63]
  ds_read_b128 v[20:23], v6 offset:33792
  ds_read_b64_tr_b16 a[138:139], v7 offset:512
  v_mul_f32 v36, v4, v36
  v_mul_f32 v37, v4, v37
  v_mul_f32 v38, v4, v38
  v_mul_f32 v39, v4, v39
  v_exp_f32 v36, v36
  s_waitcnt lgkmcnt(5)
  v_mfma_f32_32x32x16_bf16 v[48:63], v[28:31], v[136:139], v[48:63]
  ds_read_b128 v[24:27], v6 offset:34816
  s_waitcnt lgkmcnt(1)
  s_add_u32 m0, s57, 0
  s_add_u32 s62, s58, 327680
  buffer_load_dwordx4 v0, s[24:27], s62 offen lds
  v_exp_f32 v37, v37
  v_exp_f32 v38, v38
  v_exp_f32 v39, v39
  v_mfma_f32_32x32x16_bf16 v[48:63], v[84:87], v[140:143], v[48:63]
  ds_read_b128 v[28:31], v6 offset:35840
  s_add_u32 m0, s57, 1024
  s_add_u32 s62, s58, 335872
  buffer_load_dwordx4 v0, s[24:27], s62 offen lds
  v_fma_f32 v36, v36, v5, v5
  v_fma_f32 v37, v37, v5, v5
  v_fma_f32 v38, v38, v5, v5
  v_fma_f32 v39, v39, v5, v5
  v_rcp_f32 v36, v36
  v_mfma_f32_32x32x16_bf16 v[48:63], v[16:19], v[144:147], v[48:63]
  v_mfma_f32_32x32x16_bf16 v[48:63], v[8:11], v[12:15], v[48:63]
  ds_read_b32 v8, v2 offset:640
  s_waitcnt vmcnt(10)
  s_barrier
  ds_read_b128 v[84:87], v6 offset:0
  v_rcp_f32 v37, v37
  v_rcp_f32 v38, v38
  v_rcp_f32 v39, v39
  v_mul_f32 v44, v44, v36
  v_mul_f32 v45, v45, v37
  v_mfma_f32_32x32x16_bf16 v[48:63], v[20:23], v[148:151], v[48:63]
  ds_read_b128 v[16:19], v6 offset:1024
  s_add_u32 m0, s60, 122880
  s_add_u32 s61, s59, 172032
  buffer_load_dwordx4 v6, s[32:35], s61 offen sc1 lds
  v_mul_f32 v46, v46, v38
  s_waitcnt lgkmcnt(3)
  v_mfma_f32_32x32x16_bf16 v[48:63], v[24:27], v[152:155], v[48:63]
  ds_read_b128 v[20:23], v6 offset:2048
  s_waitcnt vmcnt(9)
  ds_read_b64_tr_b16 a[144:145], v7 offset:2048
  v_mul_f32 v47, v47, v39
  v_cvt_pk_bf16_f32 v32, v40, v41
  v_cvt_pk_bf16_f32 v33, v42, v43
  v_cvt_pk_bf16_f32 v34, v44, v45
  v_cvt_pk_bf16_f32 v35, v46, v47
  v_mfma_f32_32x32x16_bf16 v[48:63], v[28:31], v[156:159], v[48:63]
  ds_read_b128 v[24:27], v6 offset:3072
  s_add_u32 m0, s60, 126976
  s_add_u32 s61, s59, 176128
  buffer_load_dwordx4 v6, s[32:35], s61 offen sc1 lds
  ds_read_b64_tr_b16 a[146:147], v7 offset:2560
  s_waitcnt lgkmcnt(4)
  v_mfma_f32_32x32x16_bf16 v[48:63], v[84:87], v[160:163], v[48:63]
  ds_read_b128 v[28:31], v6 offset:4096
  v_xor_b32 v7, 64, v7
  ds_read_b64_tr_b16 a[148:149], v7 offset:2048
  buffer_store_dwordx4 v[32:35], v1, s[32:35], s56 offen offset:1536 sc1
  v_mfma_f32_32x32x16_bf16 v[48:63], v[16:19], v[164:167], v[48:63]
  ds_read_b128 v[84:87], v6 offset:5120
  ds_read_b64_tr_b16 a[150:151], v7 offset:2560
  s_waitcnt lgkmcnt(5)
  v_mfma_f32_32x32x16_bf16 v[48:63], v[20:23], v[168:171], v[48:63]
  ds_read_b128 v[16:19], v6 offset:6144
  s_waitcnt lgkmcnt(1)
  s_add_u32 m0, s57, 2048
  s_add_u32 s62, s58, 344064
  buffer_load_dwordx4 v0, s[24:27], s62 offen lds
  v_mfma_f32_32x32x16_bf16 v[48:63], v[24:27], v[172:175], v[48:63]
  ds_read_b128 v[20:23], v6 offset:7168
  s_add_u32 m0, s57, 3072
  s_add_u32 s62, s58, 352256
  buffer_load_dwordx4 v0, s[24:27], s62 offen lds
  v_mfma_f32_32x32x16_bf16 v[48:63], v[28:31], v[176:179], v[48:63]
  s_waitcnt vmcnt(11)
  s_barrier
  ds_read_b128 v[24:27], v6 offset:8192
  v_mfma_f32_32x32x16_bf16 v[48:63], v[84:87], v[180:183], v[48:63]
  ds_read_b128 v[28:31], v6 offset:9216
  s_add_u32 m0, s60, 131072
  s_add_u32 s61, s59, 180224
  buffer_load_dwordx4 v6, s[32:35], s61 offen sc1 lds
  s_waitcnt lgkmcnt(2)
  v_mfma_f32_32x32x16_bf16 v[48:63], v[16:19], v[184:187], v[48:63]
  ds_read_b128 v[84:87], v6 offset:10240
  s_waitcnt vmcnt(10)
  ds_read_b64_tr_b16 a[156:157], v7 offset:4096
  v_mfma_f32_32x32x16_bf16 v[48:63], v[20:23], v[188:191], v[48:63]
  ds_read_b128 v[16:19], v6 offset:11264
  s_add_u32 m0, s60, 98304
  s_add_u32 s61, s59, 184320
  buffer_load_dwordx4 v6, s[32:35], s61 offen sc1 lds
  ds_read_b64_tr_b16 a[158:159], v7 offset:4608
  s_waitcnt lgkmcnt(4)
  v_mfma_f32_32x32x16_bf16 v[48:63], v[24:27], v[192:195], v[48:63]
  ds_read_b128 v[20:23], v6 offset:12288
  v_xor_b32 v7, 64, v7
  ds_read_b64_tr_b16 a[152:153], v7 offset:4096
  v_mfma_f32_32x32x16_bf16 v[48:63], v[28:31], v[196:199], v[48:63]
  ds_read_b128 v[24:27], v6 offset:13312
  ds_read_b64_tr_b16 a[154:155], v7 offset:4608
  s_waitcnt lgkmcnt(5)
  v_mfma_f32_32x32x16_bf16 v[48:63], v[84:87], v[200:203], v[48:63]
  ds_read_b128 v[28:31], v6 offset:14336
  s_waitcnt lgkmcnt(1)
  s_add_u32 m0, s57, 4096
  s_add_u32 s62, s58, 360448
  buffer_load_dwordx4 v0, s[24:27], s62 offen lds
  v_mfma_f32_32x32x16_bf16 v[48:63], v[16:19], v[204:207], v[48:63]
  ds_read_b128 v[84:87], v6 offset:15360
  s_add_u32 m0, s57, 5120
  s_add_u32 s62, s58, 368640
  buffer_load_dwordx4 v0, s[24:27], s62 offen lds
  v_mfma_f32_32x32x16_bf16 v[48:63], v[20:23], v[208:211], v[48:63]
  s_waitcnt vmcnt(11)
  s_barrier
  ds_read_b128 v[16:19], v6 offset:16384
  v_mfma_f32_32x32x16_bf16 v[48:63], v[24:27], v[212:215], v[48:63]
  ds_read_b128 v[20:23], v6 offset:17408
  s_add_u32 m0, s60, 102400
  s_add_u32 s61, s59, 188416
  buffer_load_dwordx4 v6, s[32:35], s61 offen sc1 lds
  s_waitcnt lgkmcnt(2)
  v_mfma_f32_32x32x16_bf16 v[48:63], v[28:31], v[216:219], v[48:63]
  ds_read_b128 v[24:27], v6 offset:18432
  v_mfma_f32_32x32x16_bf16 v[48:63], v[84:87], v[220:223], v[48:63]
  ds_read_b128 v[28:31], v6 offset:19456
  s_add_u32 m0, s60, 106496
  s_add_u32 s61, s59, 192512
  buffer_load_dwordx4 v6, s[32:35], s61 offen sc1 lds
  s_waitcnt vmcnt(11) lgkmcnt(2)
  v_mfma_f32_32x32x16_bf16 v[64:79], v[16:19], v[96:99], 0
  ds_read_b128 v[84:87], v6 offset:20480
  ds_read_b64_tr_b16 a[160:161], v7 offset:0
  ds_read_b64_tr_b16 a[162:163], v7 offset:512
  v_mfma_f32_32x32x16_bf16 v[64:79], v[20:23], v[100:103], v[64:79]
  ds_read_b128 v[16:19], v6 offset:21504
  v_xor_b32 v7, 64, v7
  ds_read_b64_tr_b16 a[164:165], v7 offset:0
  s_waitcnt lgkmcnt(5)
  v_mfma_f32_32x32x16_bf16 v[64:79], v[24:27], v[104:107], v[64:79]
  ds_read_b128 v[20:23], v6 offset:22528
  ds_read_b64_tr_b16 a[166:167], v7 offset:512
  s_waitcnt lgkmcnt(0)
  s_add_u32 m0, s57, 0
  s_add_u32 s62, s58, 376832
  buffer_load_dwordx4 v0, s[24:27], s62 offen lds
  v_mfma_f32_32x32x16_bf16 v[64:79], v[28:31], v[108:111], v[64:79]
  ds_read_b128 v[24:27], v6 offset:23552
  s_add_u32 m0, s57, 1024
  s_add_u32 s62, s58, 385024
  buffer_load_dwordx4 v0, s[24:27], s62 offen lds
  v_mul_f32 v48, v4, v48
  v_mul_f32 v49, v4, v49
  v_mul_f32 v50, v4, v50
  v_mul_f32 v51, v4, v51
  v_exp_f32 v48, v48
  v_mfma_f32_32x32x16_bf16 v[64:79], v[84:87], v[112:115], v[64:79]
  s_waitcnt vmcnt(11)
  s_barrier
  ds_read_b128 v[28:31], v6 offset:24576
  v_exp_f32 v49, v49
  v_exp_f32 v50, v50
  v_exp_f32 v51, v51
  v_fma_f32 v48, v48, v5, v5
  v_fma_f32 v49, v49, v5, v5
  v_mfma_f32_32x32x16_bf16 v[64:79], v[16:19], v[116:119], v[64:79]
  ds_read_b128 v[84:87], v6 offset:25600
  s_add_u32 m0, s60, 110592
  s_add_u32 s61, s59, 196608
  buffer_load_dwordx4 v6, s[32:35], s61 offen sc1 lds
  v_fma_f32 v50, v50, v5, v5
  s_waitcnt lgkmcnt(2)
  v_mfma_f32_32x32x16_bf16 v[64:79], v[20:23], v[120:123], v[64:79]
  ds_read_b128 v[16:19], v6 offset:26624
  v_fma_f32 v51, v51, v5, v5
  v_rcp_f32 v48, v48
  v_rcp_f32 v49, v49
  v_rcp_f32 v50, v50
  v_mfma_f32_32x32x16_bf16 v[64:79], v[24:27], v[124:127], v[64:79]
  ds_read_b128 v[20:23], v6 offset:27648
  s_add_u32 m0, s60, 114688
  s_add_u32 s61, s59, 200704
  buffer_load_dwordx4 v6, s[32:35], s61 offen sc1 lds
  s_waitcnt vmcnt(10) lgkmcnt(2)
  v_mfma_f32_32x32x16_bf16 v[64:79], v[28:31], v[128:131], v[64:79]
  ds_read_b128 v[24:27], v6 offset:28672
  ds_read_b64_tr_b16 a[172:173], v7 offset:2048
  ds_read_b64_tr_b16 a[174:175], v7 offset:2560
  v_rcp_f32 v51, v51
  v_mul_f32 v56, v56, v48
  v_mul_f32 v57, v57, v49
  v_mul_f32 v58, v58, v50
  v_mul_f32 v59, v59, v51
  s_add_u32 s69, s36, 3
  v_mov_b32 v82, s69
  v_mov_b32 v83, s37
  s_mov_b64 exec, 1
  s_cmp_lg_u32 s38, 0
  s_cbranch_scc1 L_slow_30
  buffer_store_dwordx2 v[82:83], off, s[32:35], s51
L_sigd_31:
  s_mov_b64 exec, -1
  v_mfma_f32_32x32x16_bf16 v[64:79], v[84:87], v[132:135], v[64:79]
  ds_read_b128 v[28:31], v6 offset:29696
  v_xor_b32 v7, 64, v7
  ds_read_b64_tr_b16 a[168:169], v7 offset:2048
  v_mul_f32 v52, v4, v52
  v_mul_f32 v53, v4, v53
  v_mul_f32 v54, v4, v54
  v_mul_f32 v55, v4, v55
  v_exp_f32 v52, v52
  s_waitcnt lgkmcnt(5)
  v_mfma_f32_32x32x16_bf16 v[64:79], v[16:19], v[136:139], v[64:79]
  ds_read_b128 v[84:87], v6 offset:30720
  ds_read_b64_tr_b16 a[170:171], v7 offset:2560
  v_exp_f32 v53, v53
  v_exp_f32 v54, v54
  v_exp_f32 v55, v55
  v_mfma_f32_32x32x16_bf16 v[64:79], v[20:23], v[140:143], v[64:79]
  ds_read_b128 v[16:19], v6 offset:31744
  s_waitcnt lgkmcnt(1)
  s_add_u32 m0, s57, 2048
  s_add_u32 s62, s58, 393216
  buffer_load_dwordx4 v0, s[24:27], s62 offen lds
  v_fma_f32 v52, v52, v5, v5
  v_fma_f32 v53, v53, v5, v5
  v_fma_f32 v54, v54, v5, v5
  v_fma_f32 v55, v55, v5, v5
  v_rcp_f32 v52, v52
  v_mfma_f32_32x32x16_bf16 v[64:79], v[24:27], v[144:147], v[64:79]
  v_mfma_f32_32x32x16_bf16 v[64:79], v[8:11], v[12:15], v[64:79]
  ds_read_b32 v8, v2 offset:768
  s_waitcnt vmcnt(10)
  s_barrier
  ds_read_b128 v[20:23], v6 offset:32768
  s_add_u32 m0, s57, 3072
  s_add_u32 s62, s58, 401408
  buffer_load_dwordx4 v0, s[24:27], s62 offen lds
  v_rcp_f32 v53, v53
  v_rcp_f32 v54, v54
  v_rcp_f32 v55, v55
  v_mul_f32 v60, v60, v52
  v_mfma_f32_32x32x16_bf16 v[64:79], v[28:31], v[148:151], v[64:79]
  ds_read_b128 v[24:27], v6 offset:33792
  s_add_u32 m0, s60, 118784
  s_add_u32 s61, s59, 204800
  buffer_load_dwordx4 v6, s[32:35], s61 offen sc1 lds
  v_mul_f32 v61, v61, v53
  s_waitcnt lgkmcnt(3)
  v_mfma_f32_32x32x16_bf16 v[64:79], v[84:87], v[152:155], v[64:79]
  ds_read_b128 v[28:31], v6 offset:34816
  v_mul_f32 v62, v62, v54
  v_mul_f32 v63, v63, v55
  v_cvt_pk_bf16_f32 v48, v56, v57
  v_cvt_pk_bf16_f32 v49, v58, v59
  v_cvt_pk_bf16_f32 v50, v60, v61
  v_cvt_pk_bf16_f32 v51, v62, v63
  buffer_store_dwordx4 v[48:51], v1, s[32:35], s56 offen offset:2048 sc1
  v_mfma_f32_32x32x16_bf16 v[64:79], v[16:19], v[156:159], v[64:79]
  ds_read_b128 v[84:87], v6 offset:35840
  s_add_u32 m0, s60, 122880
  s_add_u32 s61, s59, 208896
  buffer_load_dwordx4 v6, s[32:35], s61 offen sc1 lds
  s_waitcnt vmcnt(12) lgkmcnt(2)
  v_mfma_f32_32x32x16_bf16 v[64:79], v[20:23], v[160:163], v[64:79]
  ds_read_b128 v[16:19], v6 offset:0
  ds_read_b64_tr_b16 a[176:177], v7 offset:4096
  ds_read_b64_tr_b16 a[178:179], v7 offset:4608
  v_mfma_f32_32x32x16_bf16 v[64:79], v[24:27], v[164:167], v[64:79]
  ds_read_b128 v[20:23], v6 offset:1024
  v_xor_b32 v7, 64, v7
  ds_read_b64_tr_b16 a[180:181], v7 offset:4096
  s_waitcnt lgkmcnt(5)
  v_mfma_f32_32x32x16_bf16 v[64:79], v[28:31], v[168:171], v[64:79]
  ds_read_b128 v[24:27], v6 offset:2048
  ds_read_b64_tr_b16 a[182:183], v7 offset:4608
  v_mfma_f32_32x32x16_bf16 v[64:79], v[84:87], v[172:175], v[64:79]
  ds_read_b128 v[28:31], v6 offset:3072
  s_waitcnt lgkmcnt(1)
  s_add_u32 m0, s57, 4096
  s_add_u32 s62, s58, 409600
  buffer_load_dwordx4 v0, s[24:27], s62 offen lds
  v_mfma_f32_32x32x16_bf16 v[64:79], v[16:19], v[176:179], v[64:79]
  s_waitcnt vmcnt(11)
  s_barrier
  ds_read_b128 v[84:87], v6 offset:4096
  s_add_u32 m0, s57, 5120
  s_add_u32 s62, s58, 417792
  buffer_load_dwordx4 v0, s[24:27], s62 offen lds
  v_subrev_u32 v81, 98304, v6
  v_lshrrev_b32 v81, 1, v81
  buffer_load_dwordx2 v[82:83], v81, s[32:35], s50 offen offset:0 sc1
  s_mul_i32 s63, s40, 458752
  s_mul_i32 s67, s42, 229376
  s_add_u32 s63, s63, s67
  s_mul_i32 s67, s39, 14336
  s_add_u32 s63, s63, s67
  s_add_u32 s63, s63, 20971520
  v_mfma_f32_32x32x16_bf16 v[64:79], v[20:23], v[180:183], v[64:79]
  ds_read_b128 v[16:19], v6 offset:5120
  s_add_u32 m0, s60, 126976
  s_add_u32 s61, s59, 212992
  buffer_load_dwordx4 v6, s[32:35], s61 offen sc1 lds
  s_waitcnt lgkmcnt(2)
  v_mfma_f32_32x32x16_bf16 v[64:79], v[24:27], v[184:187], v[64:79]
  ds_read_b128 v[20:23], v6 offset:6144
  v_mfma_f32_32x32x16_bf16 v[64:79], v[28:31], v[188:191], v[64:79]
  ds_read_b128 v[24:27], v6 offset:7168
  s_add_u32 m0, s60, 131072
  s_add_u32 s61, s59, 217088
  buffer_load_dwordx4 v6, s[32:35], s61 offen sc1 lds
  s_waitcnt vmcnt(13) lgkmcnt(2)
  v_mfma_f32_32x32x16_bf16 v[64:79], v[84:87], v[192:195], v[64:79]
  ds_read_b128 v[28:31], v6 offset:8192
  ds_read_b64_tr_b16 a[188:189], v7 offset:0
  ds_read_b64_tr_b16 a[190:191], v7 offset:512
  v_mfma_f32_32x32x16_bf16 v[64:79], v[16:19], v[196:199], v[64:79]
  ds_read_b128 v[84:87], v6 offset:9216
  v_xor_b32 v7, 64, v7
  ds_read_b64_tr_b16 a[184:185], v7 offset:0
  s_waitcnt lgkmcnt(5)
  v_mfma_f32_32x32x16_bf16 v[64:79], v[20:23], v[200:203], v[64:79]
  ds_read_b128 v[16:19], v6 offset:10240
  ds_read_b64_tr_b16 a[186:187], v7 offset:512
  v_mfma_f32_32x32x16_bf16 v[64:79], v[24:27], v[204:207], v[64:79]
  ds_read_b128 v[20:23], v6 offset:11264
  s_waitcnt lgkmcnt(1)
  s_add_u32 m0, s57, 0
  s_add_u32 s62, s58, 425984
  buffer_load_dwordx4 v0, s[24:27], s62 offen lds
  v_mfma_f32_32x32x16_bf16 v[64:79], v[28:31], v[208:211], v[64:79]
  s_waitcnt vmcnt(12)
  s_barrier
  ds_read_b128 v[24:27], v6 offset:12288
  s_add_u32 m0, s57, 1024
  s_add_u32 s62, s58, 434176
  buffer_load_dwordx4 v0, s[24:27], s62 offen lds
  v_mfma_f32_32x32x16_bf16 v[64:79], v[84:87], v[212:215], v[64:79]
  ds_read_b128 v[28:31], v6 offset:13312
  s_add_u32 m0, s60, 98304
  s_add_u32 s61, s59, 221184
  buffer_load_dwordx4 v6, s[32:35], s61 offen sc1 lds
  s_waitcnt lgkmcnt(2)
  v_mfma_f32_32x32x16_bf16 v[64:79], v[16:19], v[216:219], v[64:79]
  ds_read_b128 v[84:87], v6 offset:14336
  v_mfma_f32_32x32x16_bf16 v[64:79], v[20:23], v[220:223], v[64:79]
  ds_read_b128 v[16:19], v6 offset:15360
  s_add_u32 m0, s60, 102400
  s_add_u32 s61, s59, 225280
  buffer_load_dwordx4 v6, s[32:35], s61 offen sc1 lds
  s_waitcnt lgkmcnt(2)
  v_mfma_f32_32x32x16_bf16 v[32:47], v[24:27], v[96:99], 0
  ds_read_b128 v[20:23], v6 offset:16384
  s_waitcnt vmcnt(12)
  ds_read_b64_tr_b16 a[192:193], v7 offset:2048
  s_mov_b32 s69, 0
  s_waitcnt vmcnt(6)
L_chk_33:
  v_subrev_u32 v82, s36, v82
  v_xor_b32 v83, s37, v83
  v_subrev_u32 v82, 3, v82
  v_cmp_lt_u64 vcc, 31, v[82:83]
  s_nop 0
  s_and_b64 vcc, vcc, s[48:49]
  s_cbranch_scc1 L_poll_32
  s_cmp_lg_u32 s38, 0
  s_cbranch_scc1 L_inv_35
L_polld_34:
  v_mfma_f32_32x32x16_bf16 v[32:47], v[28:31], v[100:103], v[32:47]
  ds_read_b128 v[24:27], v6 offset:17408
  ds_read_b64_tr_b16 a[194:195], v7 offset:2560
  v_xor_b32 v7, 64, v7
  s_add_u32 s64, s63, 0
  buffer_load_dwordx4 v[96:99], v1, s[32:35], s64 offen offset:0 sc1
  s_waitcnt lgkmcnt(4)
  v_mfma_f32_32x32x16_bf16 v[32:47], v[84:87], v[104:107], v[32:47]
  ds_read_b128 v[28:31], v6 offset:18432
  ds_read_b64_tr_b16 a[196:197], v7 offset:2048
  ds_read_b64_tr_b16 a[198:199], v7 offset:2560
  v_mfma_f32_32x32x16_bf16 v[32:47], v[16:19], v[108:111], v[32:47]
  ds_read_b128 v[84:87], v6 offset:19456
  s_waitcnt lgkmcnt(1)
  s_add_u32 m0, s57, 2048
  s_add_u32 s62, s58, 442368
  buffer_load_dwordx4 v0, s[24:27], s62 offen lds
  v_mul_f32 v64, v4, v64
  v_mul_f32 v65, v4, v65
  v_mul_f32 v66, v4, v66
  v_mul_f32 v67, v4, v67
  v_exp_f32 v64, v64
  buffer_load_dwordx4 v[100:103], v1, s[32:35], s64 offen offset:512 sc1
  v_mfma_f32_32x32x16_bf16 v[32:47], v[20:23], v[112:115], v[32:47]
  s_barrier
  ds_read_b128 v[16:19], v6 offset:20480
  s_add_u32 m0, s57, 3072
  s_add_u32 s62, s58, 450560
  buffer_load_dwordx4 v0, s[24:27], s62 offen lds
  v_exp_f32 v65, v65
  v_exp_f32 v66, v66
  v_exp_f32 v67, v67
  v_fma_f32 v64, v64, v5, v5
  v_mfma_f32_32x32x16_bf16 v[32:47], v[24:27], v[116:119], v[32:47]
  ds_read_b128 v[20:23], v6 offset:21504
  v_fma_f32 v65, v65, v5, v5
  v_fma_f32 v66, v66, v5, v5
  v_fma_f32 v67, v67, v5, v5
  v_rcp_f32 v64, v64
  v_rcp_f32 v65, v65
  buffer_load_dwordx4 v[104:107], v1, s[32:35], s64 offen offset:1024 sc1
  s_waitcnt lgkmcnt(2)
  v_mfma_f32_32x32x16_bf16 v[32:47], v[28:31], v[120:123], v[32:47]
  ds_read_b128 v[24:27], v6 offset:22528
  v_rcp_f32 v66, v66
  v_rcp_f32 v67, v67
  v_mul_f32 v72, v72, v64
  v_mul_f32 v73, v73, v65
  v_mul_f32 v74, v74, v66
  v_mul_f32 v75, v75, v67
  v_mfma_f32_32x32x16_bf16 v[32:47], v[84:87], v[124:127], v[32:47]
  ds_read_b128 v[28:31], v6 offset:23552
  v_mul_f32 v68, v4, v68
  v_mul_f32 v69, v4, v69
  v_mul_f32 v70, v4, v70
  v_mul_f32 v71, v4, v71
  v_exp_f32 v68, v68
  v_exp_f32 v69, v69
  buffer_load_dwordx4 v[108:111], v1, s[32:35], s64 offen offset:1536 sc1
  s_waitcnt lgkmcnt(2)
  v_mfma_f32_32x32x16_bf16 v[32:47], v[16:19], v[128:131], v[32:47]
  ds_read_b128 v[84:87], v6 offset:24576
  ds_read_b64_tr_b16 a[204:205], v7 offset:4096
  v_exp_f32 v70, v70
  v_exp_f32 v71, v71
  v_fma_f32 v68, v68, v5, v5
  v_fma_f32 v69, v69, v5, v5
  v_mfma_f32_32x32x16_bf16 v[32:47], v[20:23], v[132:135], v[32:47]
  ds_read_b128 v[16:19], v6 offset:25600
  ds_read_b64_tr_b16 a[206:207], v7 offset:4608
  v_xor_b32 v7, 64, v7
  v_fma_f32 v70, v70, v5, v5
  v_fma_f32 v71, v71, v5, v5
  v_rcp_f32 v68, v68
  v_rcp_f32 v69, v69
  buffer_load_dwordx4 v[112:115], v1, s[32:35], s64 offen offset:3584 sc1
  s_waitcnt lgkmcnt(4)
  v_mfma_f32_32x32x16_bf16 v[32:47], v[24:27], v[136:139], v[32:47]
  ds_read_b128 v[20:23], v6 offset:26624
  ds_read_b64_tr_b16 a[200:201], v7 offset:4096
  ds_read_b64_tr_b16 a[202:203], v7 offset:4608
  v_rcp_f32 v70, v70
  v_rcp_f32 v71, v71
  v_mul_f32 v76, v76, v68
  v_mul_f32 v77, v77, v69
  v_mfma_f32_32x32x16_bf16 v[32:47], v[28:31], v[140:143], v[32:47]
  ds_read_b128 v[24:27], v6 offset:27648
  v_mul_f32 v78, v78, v70
  v_mul_f32 v79, v79, v71
  v_cvt_pk_bf16_f32 v64, v72, v73
  v_cvt_pk_bf16_f32 v65, v74, v75
  v_cvt_pk_bf16_f32 v66, v76, v77
  v_cvt_pk_bf16_f32 v67, v78, v79
  s_add_u32 s64, s63, 4096
  buffer_load_dwordx4 v[116:119], v1, s[32:35], s64 offen offset:0 sc1
  s_waitcnt lgkmcnt(5)
  v_mfma_f32_32x32x16_bf16 v[32:47], v[84:87], v[144:147], v[32:47]
  v_mfma_f32_32x32x16_bf16 v[32:47], v[8:11], v[12:15], v[32:47]
  s_waitcnt vmcnt(12)
  s_barrier
  ds_read_b128 v[28:31], v6 offset:28672
  buffer_store_dwordx4 v[64:67], v1, s[32:35], s56 offen offset:2560 sc1
  v_mfma_f32_32x32x16_bf16 v[32:47], v[16:19], v[148:151], v[32:47]
  ds_read_b128 v[84:87], v6 offset:29696
  buffer_load_dwordx4 v[120:123], v1, s[32:35], s64 offen offset:512 sc1
  s_waitcnt lgkmcnt(2)
  v_mfma_f32_32x32x16_bf16 v[32:47], v[20:23], v[152:155], v[32:47]
  ds_read_b128 v[16:19], v6 offset:30720
  v_mfma_f32_32x32x16_bf16 v[32:47], v[24:27], v[156:159], v[32:47]
  ds_read_b128 v[20:23], v6 offset:31744
  buffer_load_dwordx4 v[124:127], v1, s[32:35], s64 offen offset:1024 sc1
  s_waitcnt lgkmcnt(2)
  v_mfma_f32_32x32x16_bf16 v[32:47], v[28:31], v[160:163], v[32:47]
  ds_read_b128 v[24:27], v6 offset:32768
  s_waitcnt vmcnt(13)
  ds_read_b64_tr_b16 a[208:209], v7 offset:0
  v_mfma_f32_32x32x16_bf16 v[32:47], v[84:87], v[164:167], v[32:47]
  ds_read_b128 v[28:31], v6 offset:33792
  ds_read_b64_tr_b16 a[210:211], v7 offset:512
  v_xor_b32 v7, 64, v7
  buffer_load_dwordx4 v[128:131], v1, s[32:35], s64 offen offset:3072 sc1
  s_waitcnt lgkmcnt(4)
  v_mfma_f32_32x32x16_bf16 v[32:47], v[16:19], v[168:171], v[32:47]
  ds_read_b128 v[84:87], v6 offset:34816
  ds_read_b64_tr_b16 a[212:213], v7 offset:0
  ds_read_b64_tr_b16 a[214:215], v7 offset:512
  v_mfma_f32_32x32x16_bf16 v[32:47], v[20:23], v[172:175], v[32:47]
  ds_read_b128 v[16:19], v6 offset:35840
  buffer_load_dwordx4 v[132:135], v1, s[32:35], s64 offen offset:3584 sc1
  s_waitcnt lgkmcnt(5)
  v_mfma_f32_32x32x16_bf16 v[32:47], v[24:27], v[176:179], v[32:47]
  s_waitcnt vmcnt(13)
  s_barrier
  ds_read_b128 v[20:23], v6 offset:0
  v_mfma_f32_32x32x16_bf16 v[32:47], v[28:31], v[180:183], v[32:47]
  ds_read_b128 v[24:27], v6 offset:1024
  s_add_u32 s64, s63, 8192
  buffer_load_dwordx4 v[136:139], v1, s[32:35], s64 offen offset:0 sc1
  s_waitcnt lgkmcnt(2)
  v_mfma_f32_32x32x16_bf16 v[32:47], v[84:87], v[184:187], v[32:47]
  ds_read_b128 v[28:31], v6 offset:2048
  v_mfma_f32_32x32x16_bf16 v[32:47], v[16:19], v[188:191], v[32:47]
  ds_read_b128 v[84:87], v6 offset:3072
  buffer_load_dwordx4 v[140:143], v1, s[32:35], s64 offen offset:512 sc1
  s_waitcnt lgkmcnt(2)
  v_mfma_f32_32x32x16_bf16 v[32:47], v[20:23], v[192:195], v[32:47]
  ds_read_b128 v[16:19], v6 offset:4096
  s_waitcnt vmcnt(11)
  ds_read_b64_tr_b16 a[220:221], v7 offset:2048
  v_mfma_f32_32x32x16_bf16 v[32:47], v[24:27], v[196:199], v[32:47]
  ds_read_b128 v[20:23], v6 offset:5120
  ds_read_b64_tr_b16 a[222:223], v7 offset:2560
  v_xor_b32 v7, 64, v7
  buffer_load_dwordx4 v[144:147], v1, s[32:35], s64 offen offset:2560 sc1
  s_waitcnt lgkmcnt(4)
  v_mfma_f32_32x32x16_bf16 v[32:47], v[28:31], v[200:203], v[32:47]
  ds_read_b128 v[24:27], v6 offset:6144
  ds_read_b64_tr_b16 a[216:217], v7 offset:2048
  ds_read_b64_tr_b16 a[218:219], v7 offset:2560
  v_mfma_f32_32x32x16_bf16 v[32:47], v[84:87], v[204:207], v[32:47]
  ds_read_b128 v[28:31], v6 offset:7168
  buffer_load_dwordx4 v[148:151], v1, s[32:35], s64 offen offset:3072 sc1
  s_waitcnt lgkmcnt(5)
  v_mfma_f32_32x32x16_bf16 v[32:47], v[16:19], v[208:211], v[32:47]
  v_mfma_f32_32x32x16_bf16 v[32:47], v[20:23], v[212:215], v[32:47]
  s_waitcnt lgkmcnt(0)
  v_mfma_f32_32x32x16_bf16 v[32:47], v[24:27], v[216:219], v[32:47]
  v_mfma_f32_32x32x16_bf16 v[32:47], v[28:31], v[220:223], v[32:47]
  v_mfma_f32_32x32x16_bf16 v[48:63], a[0:3], v[96:99], 0
  v_mfma_f32_32x32x16_bf16 v[64:79], a[4:7], v[96:99], 0
  v_mfma_f32_32x32x16_bf16 v[48:63], a[8:11], v[100:103], v[48:63]
  v_mfma_f32_32x32x16_bf16 v[64:79], a[12:15], v[100:103], v[64:79]
  s_nop 7
  v_mul_f32 v32, v4, v32
  v_mul_f32 v33, v4, v33
  v_mul_f32 v34, v4, v34
  v_mul_f32 v35, v4, v35
  v_exp_f32 v32, v32
  v_exp_f32 v33, v33
  v_exp_f32 v34, v34
  v_exp_f32 v35, v35
  v_fma_f32 v32, v32, v5, v5
  v_fma_f32 v33, v33, v5, v5
  s_waitcnt vmcnt(12)
  v_mfma_f32_32x32x16_bf16 v[48:63], a[16:19], v[104:107], v[48:63]
  v_fma_f32 v34, v34, v5, v5
  v_fma_f32 v35, v35, v5, v5
  v_rcp_f32 v32, v32
  v_rcp_f32 v33, v33
  v_rcp_f32 v34, v34
  v_rcp_f32 v35, v35
  v_mul_f32 v40, v40, v32
  v_mul_f32 v41, v41, v33
  v_mul_f32 v42, v42, v34
  v_mul_f32 v43, v43, v35
  v_mfma_f32_32x32x16_bf16 v[64:79], a[20:23], v[104:107], v[64:79]
  v_mul_f32 v36, v4, v36
  v_mul_f32 v37, v4, v37
  v_mul_f32 v38, v4, v38
  v_mul_f32 v39, v4, v39
  v_exp_f32 v36, v36
  v_exp_f32 v37, v37
  v_exp_f32 v38, v38
  v_exp_f32 v39, v39
  v_fma_f32 v36, v36, v5, v5
  v_fma_f32 v37, v37, v5, v5
  s_waitcnt vmcnt(11)
  v_mfma_f32_32x32x16_bf16 v[48:63], a[24:27], v[108:111], v[48:63]
  v_fma_f32 v38, v38, v5, v5
  v_fma_f32 v39, v39, v5, v5
  v_rcp_f32 v36, v36
  v_rcp_f32 v37, v37
  v_rcp_f32 v38, v38
  v_rcp_f32 v39, v39
  v_mul_f32 v44, v44, v36
  v_mul_f32 v45, v45, v37
  v_mul_f32 v46, v46, v38
  v_mul_f32 v47, v47, v39
  v_mfma_f32_32x32x16_bf16 v[64:79], a[28:31], v[108:111], v[64:79]
  v_cvt_pk_bf16_f32 v32, v40, v41
  v_cvt_pk_bf16_f32 v33, v42, v43
  v_cvt_pk_bf16_f32 v34, v44, v45
  v_cvt_pk_bf16_f32 v35, v46, v47
  buffer_store_dwordx4 v[32:35], v1, s[32:35], s56 offen offset:3072 sc1
  v_mbcnt_lo_u32_b32 v0, -1, 0
  v_mbcnt_hi_u32_b32 v0, -1, v0
  v_lshlrev_b32 v218, 3, v0
  v_bfe_u32 v2, v0, 4, 1
  v_lshlrev_b32 v2, 14, v2
  v_lshrrev_b32 v15, 5, v0
  v_lshl_add_u32 v2, v15, 8, v2
  s_waitcnt vmcnt(11)
  v_mfma_f32_32x32x16_bf16 v[48:63], a[56:59], v[112:115], v[48:63]
  buffer_load_dwordx4 v[152:155], v1, s[32:35], s64 offen offset:3584 sc1
  v_bfe_u32 v15, v0, 0, 4
  v_lshl_add_u32 v2, v15, 4, v2
  v_mfma_f32_32x32x16_bf16 v[64:79], a[60:63], v[112:115], v[64:79]
  s_mul_i32 s54, s40, 131072
  s_mul_i32 s67, s42, 65536
  s_add_u32 s54, s54, s67
  s_mul_i32 s67, s43, 2048
  s_add_u32 s54, s54, s67
  s_waitcnt vmcnt(11)
  v_mfma_f32_32x32x16_bf16 v[48:63], a[64:67], v[116:119], v[48:63]
  s_add_u32 s64, s63, 12288
  buffer_load_dwordx4 v[156:159], v1, s[32:35], s64 offen offset:0 sc1
  s_mul_i32 s67, s39, 512
  s_add_u32 s54, s54, s67
  v_mfma_f32_32x32x16_bf16 v[64:79], a[68:71], v[116:119], v[64:79]
  s_add_u32 s54, s54, 4194304
  s_add_u32 s55, s54, 32768
  v_lshlrev_b32 v8, 4, v0
  s_lshr_b32 s66, s43, 1
  s_and_b32 s65, s43, 1
  s_waitcnt vmcnt(10)
  v_mfma_f32_32x32x16_bf16 v[48:63], a[72:75], v[120:123], v[48:63]
  s_add_u32 s64, s63, 114688
  buffer_load_dwordx4 v[160:163], v1, s[32:35], s64 offen offset:0 sc1
  s_mul_i32 s58, s40, 8192
  s_mul_i32 s67, s66, 2048
  v_mfma_f32_32x32x16_bf16 v[64:79], a[76:79], v[120:123], v[64:79]
  s_add_u32 s58, s58, s67
  s_mul_i32 s67, s42, 1024
  s_add_u32 s58, s58, s67
  s_add_u32 s58, s58, 1048576
  s_mul_i32 s59, s40, 16384
  s_waitcnt vmcnt(10)
  v_mfma_f32_32x32x16_bf16 v[48:63], a[80:83], v[124:127], v[48:63]
  buffer_load_dwordx4 v[164:167], v1, s[32:35], s64 offen offset:512 sc1
  s_mul_i32 s67, s43, 1024
  s_add_u32 s59, s59, s67
  v_mfma_f32_32x32x16_bf16 v[64:79], a[84:87], v[124:127], v[64:79]
  s_mul_i32 s67, s39, 256
  s_add_u32 s59, s59, s67
  s_add_u32 s59, s59, 278528
  s_mul_i32 s60, s40, 16384
  s_mul_i32 s67, s66, 128
  s_waitcnt vmcnt(10)
  v_mfma_f32_32x32x16_bf16 v[48:63], a[112:115], v[128:131], v[48:63]
  buffer_load_dwordx4 v[168:171], v1, s[32:35], s64 offen offset:1024 sc1
  s_add_u32 s60, s60, s67
  s_mul_i32 s67, s65, 8
  v_mfma_f32_32x32x16_bf16 v[64:79], a[116:119], v[128:131], v[64:79]
  s_add_u32 s60, s60, s67
  s_add_u32 s60, s60, 286720
  s_mul_i32 s3, s40, 8192
  s_mul_i32 s67, s43, 32
  s_add_u32 s3, s3, s67
  s_waitcnt vmcnt(10)
  v_mfma_f32_32x32x16_bf16 v[48:63], a[120:123], v[132:135], v[48:63]
  buffer_load_dwordx4 v[172:175], v1, s[32:35], s64 offen offset:1536 sc1
  s_mul_i32 s67, s39, 8
  s_add_u32 s3, s3, s67
  v_mfma_f32_32x32x16_bf16 v[64:79], a[124:127], v[132:135], v[64:79]
  s_add_u32 s3, s3, 12800
  s_cmp_eq_u32 s44, 7
  s_cselect_b32 s66, 0, s42
  s_cmp_eq_u32 s66, 0
  s_cselect_b32 s59, 1073741824, s59
  s_cselect_b32 s60, 1073741824, s60
  s_cselect_b32 s3, 1073741824, s3
  v_lshrrev_b32 v9, 5, v0
  v_lshlrev_b32 v9, 7, v9
  s_waitcnt vmcnt(10)
  v_mfma_f32_32x32x16_bf16 v[48:63], a[128:131], v[136:139], v[48:63]
  buffer_load_dwordx4 v[96:99], v1, s[32:35], s64 offen offset:3584 sc1
  v_bfe_u32 v15, v0, 0, 5
  v_lshl_add_u32 v9, v15, 4, v9
  v_mfma_f32_32x32x16_bf16 v[64:79], a[132:135], v[136:139], v[64:79]
  v_add_u32 v9, -384, v9
  v_and_b32 v13, 31, v0
  v_mov_b32 v12, 2147483648
  v_cmp_gt_u32 vcc, 24, v13
  s_nop 1
  v_cndmask_b32 v9, v9, v12, vcc
  v_add_u32 v10, -896, v8
  s_waitcnt vmcnt(10)
  v_mfma_f32_32x32x16_bf16 v[48:63], a[136:139], v[140:143], v[48:63]
  s_add_u32 s64, s63, 118784
  buffer_load_dwordx4 v[100:103], v1, s[32:35], s64 offen offset:0 sc1
  v_cmp_gt_u32 vcc, 56, v0
  s_nop 1
  v_cndmask_b32 v10, v10, v12, vcc
  s_add_u32 s62, s2, s39
  v_mfma_f32_32x32x16_bf16 v[64:79], a[140:143], v[140:143], v[64:79]
  s_cmp_eq_u32 s62, 0
  s_mov_b32 s65, 196608
  s_cselect_b32 s62, s65, 2147483648
  v_mov_b32 v11, 1065369472
  v_mov_b32 v208, 0
  v_mov_b32 v209, 0
  v_mov_b32 v210, 0
  s_waitcnt vmcnt(10)
  v_mfma_f32_32x32x16_bf16 v[48:63], a[168:171], v[144:147], v[48:63]
  buffer_load_dwordx4 v[104:107], v1, s[32:35], s64 offen offset:512 sc1
  v_mov_b32 v211, 0
  v_mov_b32 v220, s36
  v_mfma_f32_32x32x16_bf16 v[64:79], a[172:175], v[144:147], v[64:79]
  v_mov_b32 v221, s37
  s_add_u32 s66, s39, 1
  s_and_b32 s66, s66, 3
  s_mul_i32 s65, s66, 6144
  s_add_u32 s65, s65, 98304
  s_add_u32 s69, s36, 4
  v_mov_b32 v212, s69
  v_mov_b32 v213, s37
  s_mov_b64 exec, 1
  s_cmp_lg_u32 s38, 0
  s_waitcnt vmcnt(9)
  s_cbranch_scc1 L_slow_36
  buffer_store_dwordx2 v[212:213], off, s[32:35], s51
L_sigd_37:
  s_mov_b64 exec, -1
  v_mfma_f32_32x32x16_bf16 v[48:63], a[176:179], v[148:151], v[48:63]
  buffer_load_dwordx4 v[108:111], v1, s[32:35], s64 offen offset:1024 sc1
  v_add_u32 v4, s65, v8
  s_add_u32 s66, s39, 2
  v_mfma_f32_32x32x16_bf16 v[64:79], a[180:183], v[148:151], v[64:79]
  s_and_b32 s66, s66, 3
  s_mul_i32 s65, s66, 6144
  s_add_u32 s65, s65, 100352
  v_add_u32 v5, s65, v8
  s_add_u32 s66, s39, 3
  s_waitcnt vmcnt(10)
  v_mfma_f32_32x32x16_bf16 v[48:63], a[184:187], v[152:155], v[48:63]
  buffer_load_dwordx4 v[112:115], v1, s[32:35], s64 offen offset:3072 sc1
  s_and_b32 s66, s66, 3
  s_mul_i32 s65, s66, 6144
  v_mfma_f32_32x32x16_bf16 v[64:79], a[188:191], v[152:155], v[64:79]
  s_add_u32 s65, s65, 102400
  v_add_u32 v6, s65, v8
  s_mul_i32 s65, s39, 6144
  s_add_u32 s65, s65, 98304
  v_add_u32 v7, s65, v8
  s_waitcnt vmcnt(10)
  v_mfma_f32_32x32x16_bf16 v[48:63], a[192:195], v[156:159], v[48:63]
  buffer_load_dwordx4 v[116:119], v1, s[32:35], s64 offen offset:3584 sc1
  v_mov_b32 v200, v88
  v_mov_b32 v201, v89
  v_mfma_f32_32x32x16_bf16 v[64:79], a[196:199], v[156:159], v[64:79]
  v_mov_b32 v202, v90
  v_mov_b32 v203, v91
  v_mov_b32 v204, v92
  v_mov_b32 v205, v93
  v_mov_b32 v206, v94
  s_waitcnt vmcnt(10)
  v_mfma_f32_32x32x16_bf16 v[16:31], a[0:3], v[160:163], 0
  s_add_u32 s64, s63, 122880
  buffer_load_dwordx4 v[120:123], v1, s[32:35], s64 offen offset:0 sc1
  v_mov_b32 v207, v95
  v_lshlrev_b32 v80, 16, v200
  v_mfma_f32_32x32x16_bf16 v[32:47], a[4:7], v[160:163], 0
  v_and_b32 v81, 4294901760, v200
  v_lshlrev_b32 v82, 16, v201
  v_and_b32 v83, 4294901760, v201
  v_lshlrev_b32 v84, 16, v202
  v_and_b32 v85, 4294901760, v202
  s_waitcnt vmcnt(10)
  v_mfma_f32_32x32x16_bf16 v[16:31], a[8:11], v[164:167], v[16:31]
  buffer_load_dwordx4 v[124:127], v1, s[32:35], s64 offen offset:512 sc1
  v_lshlrev_b32 v86, 16, v203
  v_and_b32 v87, 4294901760, v203
  v_mfma_f32_32x32x16_bf16 v[32:47], a[12:15], v[164:167], v[32:47]
  v_lshlrev_b32 v88, 16, v204
  v_and_b32 v89, 4294901760, v204
  v_lshlrev_b32 v90, 16, v205
  v_and_b32 v91, 4294901760, v205
  v_lshlrev_b32 v92, 16, v206
  s_waitcnt vmcnt(10)
  v_mfma_f32_32x32x16_bf16 v[16:31], a[16:19], v[168:171], v[16:31]
  buffer_load_dwordx4 v[128:131], v1, s[32:35], s64 offen offset:2560 sc1
  v_and_b32 v93, 4294901760, v206
  v_lshlrev_b32 v94, 16, v207
  v_mfma_f32_32x32x16_bf16 v[32:47], a[20:23], v[168:171], v[32:47]
  v_and_b32 v95, 4294901760, v207
  buffer_load_dwordx2 v[216:217], v218, s[32:35], s50 offen offset:0 sc1
  s_waitcnt vmcnt(11)
  v_mfma_f32_32x32x16_bf16 v[16:31], a[24:27], v[172:175], v[16:31]
  buffer_load_dwordx4 v[132:135], v1, s[32:35], s64 offen offset:3072 sc1
  v_mfma_f32_32x32x16_bf16 v[32:47], a[28:31], v[172:175], v[32:47]
  s_waitcnt vmcnt(11)
  v_mfma_f32_32x32x16_bf16 v[16:31], a[56:59], v[96:99], v[16:31]
  buffer_load_dwordx4 v[136:139], v1, s[32:35], s64 offen offset:3584 sc1
  v_mfma_f32_32x32x16_bf16 v[32:47], a[60:63], v[96:99], v[32:47]
  s_waitcnt vmcnt(11)
  v_mfma_f32_32x32x16_bf16 v[16:31], a[64:67], v[100:103], v[16:31]
  s_add_u32 s64, s63, 126976
  buffer_load_dwordx4 v[140:143], v1, s[32:35], s64 offen offset:0 sc1
  v_mfma_f32_32x32x16_bf16 v[32:47], a[68:71], v[100:103], v[32:47]
  s_waitcnt vmcnt(11)
  v_mfma_f32_32x32x16_bf16 v[16:31], a[72:75], v[104:107], v[16:31]
  v_mfma_f32_32x32x16_bf16 v[32:47], a[76:79], v[104:107], v[32:47]
  s_waitcnt vmcnt(9)
  v_mfma_f32_32x32x16_bf16 v[16:31], a[80:83], v[108:111], v[16:31]
  v_mfma_f32_32x32x16_bf16 v[32:47], a[84:87], v[108:111], v[32:47]
  s_mov_b32 s69, 0
  s_waitcnt vmcnt(3)
L_chk_39:
  v_subrev_u32 v216, s36, v216
  v_xor_b32 v217, s37, v217
  v_subrev_u32 v216, 4, v216
  v_cmp_lt_u64 vcc, 31, v[216:217]
  s_nop 0
  s_and_b64 vcc, vcc, s[48:49]
  s_cbranch_scc1 L_poll_38
  s_cmp_lg_u32 s38, 0
  s_cbranch_scc1 L_inv_41
L_polld_40:
  v_mfma_f32_32x32x16_bf16 v[16:31], a[112:115], v[112:115], v[16:31]
  s_add_u32 s64, s63, 0
  buffer_load_dwordx4 v[144:147], v1, s[32:35], s64 offen offset:2048 sc1
  v_mfma_f32_32x32x16_bf16 v[32:47], a[116:119], v[112:115], v[32:47]
  v_mfma_f32_32x32x16_bf16 v[16:31], a[120:123], v[116:119], v[16:31]
  buffer_load_dwordx4 v[148:151], v1, s[32:35], s64 offen offset:2560 sc1
  v_mfma_f32_32x32x16_bf16 v[32:47], a[124:127], v[116:119], v[32:47]
  s_mov_b32 m0, 159744
  s_nop 0
  buffer_load_dword v2, s[32:35], s54 offen lds
  s_mov_b32 m0, 159744
  s_nop 0
  buffer_load_dword v2, s[32:35], s55 offen lds
  s_mov_b32 m0, 159744
  s_nop 0
  buffer_load_dword v8, s[32:35], s58 offen lds
  s_getpc_b64 s[92:93]
L_pc_42:
  s_and_b32 s93, s93, 65535
  s_mov_b32 s94, L_codeend-L_pc_42
  s_mov_b32 s95, 131072
  s_lshr_b32 s65, s2, 3
  s_mul_i32 s65, s65, 1024
  s_mul_i32 s67, s39, 256
  s_add_u32 s65, s65, s67
  v_lshlrev_b32 v14, 7, v0
  v_mov_b32 v13, 2147483648
  v_cmp_gt_u32 vcc, 2, v0
  s_nop 1
  v_cndmask_b32 v14, v13, v14, vcc
  s_mov_b32 m0, 159744
  s_nop 0
  buffer_load_dword v14, s[92:95], s65 offen lds
  v_mfma_f32_32x32x16_bf16 v[16:31], a[128:131], v[120:123], v[16:31]
  buffer_load_dwordx4 v[152:155], v1, s[32:35], s64 offen offset:3072 sc1
  v_mfma_f32_32x32x16_bf16 v[32:47], a[132:135], v[120:123], v[32:47]
  v_mfma_f32_32x32x16_bf16 v[16:31], a[136:139], v[124:127], v[16:31]
  s_add_u32 s64, s63, 4096
  buffer_load_dwordx4 v[156:159], v1, s[32:35], s64 offen offset:1536 sc1
  v_mfma_f32_32x32x16_bf16 v[32:47], a[140:143], v[124:127], v[32:47]
  v_mfma_f32_32x32x16_bf16 v[16:31], a[168:171], v[128:131], v[16:31]
  buffer_load_dwordx4 v[160:163], v1, s[32:35], s64 offen offset:2048 sc1
  v_mfma_f32_32x32x16_bf16 v[32:47], a[172:175], v[128:131], v[32:47]
  s_waitcnt vmcnt(11)
  v_mfma_f32_32x32x16_bf16 v[16:31], a[176:179], v[132:135], v[16:31]
  buffer_load_dwordx4 v[164:167], v1, s[32:35], s64 offen offset:2560 sc1
  v_mfma_f32_32x32x16_bf16 v[32:47], a[180:183], v[132:135], v[32:47]
  s_waitcnt vmcnt(11)
  v_mfma_f32_32x32x16_bf16 v[16:31], a[184:187], v[136:139], v[16:31]
  s_add_u32 s64, s63, 8192
  buffer_load_dwordx4 v[168:171], v1, s[32:35], s64 offen offset:1024 sc1
  v_mfma_f32_32x32x16_bf16 v[32:47], a[188:191], v[136:139], v[32:47]
  s_waitcnt vmcnt(11)
  v_mfma_f32_32x32x16_bf16 v[16:31], a[192:195], v[140:143], v[16:31]
  buffer_load_dwordx4 v[172:175], v1, s[32:35], s64 offen offset:1536 sc1
  v_mfma_f32_32x32x16_bf16 v[32:47], a[196:199], v[140:143], v[32:47]
  s_waitcnt vmcnt(11)
  v_mfma_f32_32x32x16_bf16 v[48:63], a[32:35], v[144:147], v[48:63]
  buffer_load_dwordx4 v[96:99], v1, s[32:35], s64 offen offset:2048 sc1
  v_mfma_f32_32x32x16_bf16 v[64:79], a[36:39], v[144:147], v[64:79]
  s_waitcnt vmcnt(11)
  v_mfma_f32_32x32x16_bf16 v[48:63], a[40:43], v[148:151], v[48:63]
  s_add_u32 s64, s63, 12288
  buffer_load_dwordx4 v[100:103], v1, s[32:35], s64 offen offset:512 sc1
  v_mfma_f32_32x32x16_bf16 v[64:79], a[44:47], v[148:151], v[64:79]
  s_waitcnt vmcnt(7)
  v_mfma_f32_32x32x16_bf16 v[48:63], a[48:51], v[152:155], v[48:63]
  buffer_load_dwordx4 v[104:107], v1, s[32:35], s64 offen offset:1024 sc1
  v_mfma_f32_32x32x16_bf16 v[64:79], a[52:55], v[152:155], v[64:79]
  s_waitcnt vmcnt(7)
  v_mfma_f32_32x32x16_bf16 v[48:63], a[88:91], v[156:159], v[48:63]
  buffer_load_dwordx4 v[108:111], v1, s[32:35], s64 offen offset:1536 sc1
  v_mfma_f32_32x32x16_bf16 v[64:79], a[92:95], v[156:159], v[64:79]
  s_waitcnt vmcnt(7)
  v_mfma_f32_32x32x16_bf16 v[48:63], a[96:99], v[160:163], v[48:63]
  s_add_u32 s64, s63, 114688
  buffer_load_dwordx4 v[112:115], v1, s[32:35], s64 offen offset:2048 sc1
  v_mfma_f32_32x32x16_bf16 v[64:79], a[100:103], v[160:163], v[64:79]
  s_waitcnt vmcnt(7)
  v_mfma_f32_32x32x16_bf16 v[48:63], a[104:107], v[164:167], v[48:63]
  buffer_load_dwordx4 v[116:119], v1, s[32:35], s64 offen offset:2560 sc1
  v_mfma_f32_32x32x16_bf16 v[64:79], a[108:111], v[164:167], v[64:79]
  s_waitcnt vmcnt(7)
  v_mfma_f32_32x32x16_bf16 v[48:63], a[144:147], v[168:171], v[48:63]
  buffer_load_dwordx4 v[120:123], v1, s[32:35], s64 offen offset:3072 sc1
  v_mfma_f32_32x32x16_bf16 v[64:79], a[148:151], v[168:171], v[64:79]
  s_waitcnt vmcnt(7)
  v_mfma_f32_32x32x16_bf16 v[48:63], a[152:155], v[172:175], v[48:63]
  s_add_u32 s64, s63, 118784
  buffer_load_dwordx4 v[124:127], v1, s[32:35], s64 offen offset:1536 sc1
  v_mfma_f32_32x32x16_bf16 v[64:79], a[156:159], v[172:175], v[64:79]
  s_barrier
  s_waitcnt vmcnt(7)
  v_mfma_f32_32x32x16_bf16 v[48:63], a[160:163], v[96:99], v[48:63]
  buffer_load_dwordx4 v[128:131], v1, s[32:35], s64 offen offset:2048 sc1
  v_mfma_f32_32x32x16_bf16 v[64:79], a[164:167], v[96:99], v[64:79]
  s_waitcnt vmcnt(7)
  v_mfma_f32_32x32x16_bf16 v[48:63], a[200:203], v[100:103], v[48:63]
  buffer_load_dwordx4 v[132:135], v1, s[32:35], s64 offen offset:2560 sc1
  v_mfma_f32_32x32x16_bf16 v[64:79], a[204:207], v[100:103], v[64:79]
  s_waitcnt vmcnt(7)
  v_mfma_f32_32x32x16_bf16 v[48:63], a[208:211], v[104:107], v[48:63]
  s_add_u32 s64, s63, 122880
  buffer_load_dwordx4 v[136:139], v1, s[32:35], s64 offen offset:1024 sc1
  v_mfma_f32_32x32x16_bf16 v[64:79], a[212:215], v[104:107], v[64:79]
  s_waitcnt vmcnt(7)
  v_mfma_f32_32x32x16_bf16 v[48:63], a[216:219], v[108:111], v[48:63]
  buffer_load_dwordx4 v[140:143], v1, s[32:35], s64 offen offset:1536 sc1
  v_mfma_f32_32x32x16_bf16 v[64:79], a[220:223], v[108:111], v[64:79]
  s_waitcnt vmcnt(7)
  v_mfma_f32_32x32x16_bf16 v[16:31], a[32:35], v[112:115], v[16:31]
  buffer_load_dwordx4 v[144:147], v1, s[32:35], s64 offen offset:2048 sc1
  v_mfma_f32_32x32x16_bf16 v[32:47], a[36:39], v[112:115], v[32:47]
  s_waitcnt vmcnt(7)
  v_mfma_f32_32x32x16_bf16 v[16:31], a[40:43], v[116:119], v[16:31]
  s_add_u32 s64, s63, 126976
  buffer_load_dwordx4 v[148:151], v1, s[32:35], s64 offen offset:512 sc1
  s_nop 1
  v_add_f32 v48, v48, v80
  v_add_f32 v49, v49, v81
  v_mfma_f32_32x32x16_bf16 v[32:47], a[44:47], v[116:119], v[32:47]
  v_add_f32 v50, v50, v82
  v_add_f32 v51, v51, v83
  v_add_f32 v52, v52, v84
  v_add_f32 v53, v53, v85
  v_add_f32 v54, v54, v86
  s_waitcnt vmcnt(7)
  v_mfma_f32_32x32x16_bf16 v[16:31], a[48:51], v[120:123], v[16:31]
  buffer_load_dwordx4 v[152:155], v1, s[32:35], s64 offen offset:1024 sc1
  v_add_f32 v55, v55, v87
  ds_write_b128 v4, v[56:59] offset:0
  v_mfma_f32_32x32x16_bf16 v[32:47], a[52:55], v[120:123], v[32:47]
  ds_write_b128 v4, v[60:63] offset:1024
  s_waitcnt vmcnt(7)
  v_mfma_f32_32x32x16_bf16 v[16:31], a[88:91], v[124:127], v[16:31]
  buffer_load_dwordx4 v[156:159], v1, s[32:35], s64 offen offset:1536 sc1
  ds_write_b128 v5, v[64:67] offset:0
  v_mfma_f32_32x32x16_bf16 v[32:47], a[92:95], v[124:127], v[32:47]
  ds_write_b128 v5, v[68:71] offset:1024
  s_waitcnt vmcnt(7)
  v_mfma_f32_32x32x16_bf16 v[16:31], a[96:99], v[128:131], v[16:31]
  ds_write_b128 v6, v[72:75] offset:0
  v_mfma_f32_32x32x16_bf16 v[32:47], a[100:103], v[128:131], v[32:47]
  ds_write_b128 v6, v[76:79] offset:1024
  s_waitcnt vmcnt(6)
  v_mfma_f32_32x32x16_bf16 v[16:31], a[104:107], v[132:135], v[16:31]
  v_mfma_f32_32x32x16_bf16 v[32:47], a[108:111], v[132:135], v[32:47]
  s_waitcnt lgkmcnt(0)
  s_barrier
  ds_read_b128 v[176:179], v7 offset:0
  ds_read_b128 v[180:183], v7 offset:1024
  s_waitcnt vmcnt(5)
  v_mfma_f32_32x32x16_bf16 v[16:31], a[144:147], v[136:139], v[16:31]
  ds_read_b128 v[184:187], v7 offset:2048
  ds_read_b128 v[188:191], v7 offset:3072
  v_mfma_f32_32x32x16_bf16 v[32:47], a[148:151], v[136:139], v[32:47]
  ds_read_b128 v[192:195], v7 offset:4096
  ds_read_b128 v[196:199], v7 offset:5120
  s_waitcnt vmcnt(4)
  v_mfma_f32_32x32x16_bf16 v[16:31], a[152:155], v[140:143], v[16:31]
  v_mfma_f32_32x32x16_bf16 v[32:47], a[156:159], v[140:143], v[32:47]
  s_waitcnt lgkmcnt(5)
  v_add_f32 v48, v48, v176
  v_add_f32 v49, v49, v177
  v_add_f32 v50, v50, v178
  v_add_f32 v51, v51, v179
  s_waitcnt lgkmcnt(4)
  v_add_f32 v52, v52, v180
  s_waitcnt vmcnt(3)
  v_mfma_f32_32x32x16_bf16 v[16:31], a[160:163], v[144:147], v[16:31]
  v_add_f32 v53, v53, v181
  v_add_f32 v54, v54, v182
  v_add_f32 v55, v55, v183
  s_waitcnt lgkmcnt(3)
  v_add_f32 v48, v48, v184
  v_add_f32 v49, v49, v185
  v_mfma_f32_32x32x16_bf16 v[32:47], a[164:167], v[144:147], v[32:47]
  v_add_f32 v50, v50, v186
  v_add_f32 v51, v51, v187
  s_waitcnt lgkmcnt(2)
  v_add_f32 v52, v52, v188
  v_add_f32 v53, v53, v189
  v_add_f32 v54, v54, v190
  s_waitcnt vmcnt(2)
  v_mfma_f32_32x32x16_bf16 v[16:31], a[200:203], v[148:151], v[16:31]
  v_add_f32 v55, v55, v191
  s_waitcnt lgkmcnt(1)
  v_add_f32 v48, v48, v192
  v_add_f32 v49, v49, v193
  v_add_f32 v50, v50, v194
  v_add_f32 v51, v51, v195
  v_mfma_f32_32x32x16_bf16 v[32:47], a[204:207], v[148:151], v[32:47]
  s_waitcnt lgkmcnt(0)
  v_add_f32 v52, v52, v196
  v_add_f32 v53, v53, v197
  v_add_f32 v54, v54, v198
  v_add_f32 v55, v55, v199
  v_cvt_pk_bf16_f32 v200, v48, v49
  s_waitcnt vmcnt(1)
  v_mfma_f32_32x32x16_bf16 v[16:31], a[208:211], v[152:155], v[16:31]
  v_cvt_pk_bf16_f32 v201, v50, v51
  v_cvt_pk_bf16_f32 v202, v52, v53
  v_cvt_pk_bf16_f32 v203, v54, v55
  buffer_store_dwordx4 v[200:203], v2, s[32:35], s54 offen
  v_mfma_f32_32x32x16_bf16 v[32:47], a[212:215], v[152:155], v[32:47]
  s_waitcnt vmcnt(1)
  v_mfma_f32_32x32x16_bf16 v[16:31], a[216:219], v[156:159], v[16:31]
  v_mfma_f32_32x32x16_bf16 v[32:47], a[220:223], v[156:159], v[32:47]
  s_nop 10
  ds_write_b128 v4, v[24:27] offset:24576
  ds_write_b128 v4, v[28:31] offset:25600
  ds_write_b128 v5, v[32:35] offset:24576
  ds_write_b128 v5, v[36:39] offset:25600
  ds_write_b128 v6, v[40:43] offset:24576
  ds_write_b128 v6, v[44:47] offset:25600
  v_pk_add_f32 v[16:17], v[16:17], v[88:89]
  v_pk_add_f32 v[18:19], v[18:19], v[90:91]
  v_pk_add_f32 v[20:21], v[20:21], v[92:93]
  v_pk_add_f32 v[22:23], v[22:23], v[94:95]
  s_add_u32 s69, s36, 5
  v_mov_b32 v212, s69
  v_mov_b32 v213, s37
  s_waitcnt lgkmcnt(0)
  s_barrier
  ds_read_b128 v[176:179], v7 offset:24576
  ds_read_b128 v[180:183], v7 offset:25600
  ds_read_b128 v[184:187], v7 offset:26624
  ds_read_b128 v[188:191], v7 offset:27648
  ds_read_b128 v[192:195], v7 offset:28672
  ds_read_b128 v[196:199], v7 offset:29696
  s_waitcnt lgkmcnt(5)
  v_pk_add_f32 v[16:17], v[16:17], v[176:177]
  v_pk_add_f32 v[18:19], v[18:19], v[178:179]
  s_waitcnt lgkmcnt(4)
  v_pk_add_f32 v[20:21], v[20:21], v[180:181]
  v_pk_add_f32 v[22:23], v[22:23], v[182:183]
  s_waitcnt lgkmcnt(3)
  v_pk_add_f32 v[16:17], v[16:17], v[184:185]
  v_pk_add_f32 v[18:19], v[18:19], v[186:187]
  s_waitcnt lgkmcnt(2)
  v_pk_add_f32 v[20:21], v[20:21], v[188:189]
  v_pk_add_f32 v[22:23], v[22:23], v[190:191]
  s_waitcnt lgkmcnt(1)
  v_pk_add_f32 v[16:17], v[16:17], v[192:193]
  v_pk_add_f32 v[18:19], v[18:19], v[194:195]
  s_waitcnt lgkmcnt(0)
  v_pk_add_f32 v[20:21], v[20:21], v[196:197]
  v_pk_add_f32 v[22:23], v[22:23], v[198:199]
  v_cvt_pk_bf16_f32 v204, v16, v17
  v_cvt_pk_bf16_f32 v205, v18, v19
  v_cvt_pk_bf16_f32 v206, v20, v21
  v_cvt_pk_bf16_f32 v207, v22, v23
  buffer_store_dwordx4 v[204:207], v2, s[32:35], s55 offen
  buffer_store_dwordx4 v[204:207], v9, s[32:35], s59 offen sc1
  v_dot2c_f32_bf16 v208, v200, v11
  v_dot2c_f32_bf16 v209, v200, v200
  v_dot2c_f32_bf16 v210, v204, v11
  v_dot2c_f32_bf16 v211, v204, v204
  v_dot2c_f32_bf16 v208, v201, v11
  v_dot2c_f32_bf16 v209, v201, v201
  v_dot2c_f32_bf16 v210, v205, v11
  v_dot2c_f32_bf16 v211, v205, v205
  v_dot2c_f32_bf16 v208, v202, v11
  v_dot2c_f32_bf16 v209, v202, v202
  v_dot2c_f32_bf16 v210, v206, v11
  v_dot2c_f32_bf16 v211, v206, v206
  v_dot2c_f32_bf16 v208, v203, v11
  v_dot2c_f32_bf16 v209, v203, v203
  v_dot2c_f32_bf16 v210, v207, v11
  v_dot2c_f32_bf16 v211, v207, v207
  v_lshrrev_b32 v12, 1, v8
  s_mul_i32 s65, s39, 512
  s_add_u32 s65, s65, 160000
  v_add_u32 v13, s65, v12
  v_permlane32_swap_b32 v208, v210
  v_permlane32_swap_b32 v209, v211
  v_add_u32 v12, 160000, v12
  v_pk_add_f32 v[208:209], v[208:209], v[210:211]
  ds_write_b64 v13, v[208:209]
  s_lshr_b32 s64, s43, 1
  s_and_b32 s65, s43, 1
  s_mul_i32 s66, s40, 8192
  s_mul_i32 s67, s64, 2048
  s_add_u32 s66, s66, s67
  s_mul_i32 s67, s42, 1024
  s_add_u32 s66, s66, s67
  s_mul_i32 s67, s65, 8
  s_add_u32 s66, s66, s67
  s_add_u32 s66, s66, 1048576
  s_cmp_eq_u32 s39, 0
  s_cselect_b32 s66, s66, 2147483648
  s_cselect_b32 s60, s60, 1073741824
  s_mov_b64 exec, 1
  s_cmp_lg_u32 s38, 0
  s_waitcnt vmcnt(1)
  s_cbranch_scc1 L_slow_43
  buffer_store_dwordx2 v[212:213], off, s[32:35], s51
L_sigd_44:
  s_mov_b64 exec, -1
  s_mov_b64 exec, 1
  buffer_store_dwordx2 v[220:221], off, s[32:35], s62 sc1
  s_mov_b64 exec, -1
  s_waitcnt lgkmcnt(0)
  s_barrier
  ds_read_b64 v[16:17], v12 offset:0
  ds_read_b64 v[18:19], v12 offset:512
  ds_read_b64 v[20:21], v12 offset:1024
  ds_read_b64 v[22:23], v12 offset:1536
  s_waitcnt lgkmcnt(2)
  v_pk_add_f32 v[16:17], v[16:17], v[18:19]
  s_waitcnt lgkmcnt(0)
  v_pk_add_f32 v[20:21], v[20:21], v[22:23]
  v_pk_add_f32 v[16:17], v[16:17], v[20:21]
  buffer_store_dwordx2 v[16:17], v8, s[32:35], s66 offen
  buffer_store_dwordx2 v[16:17], v10, s[32:35], s60 offen sc1
  v_mbcnt_lo_u32_b32 v0, -1, 0
  v_mbcnt_hi_u32_b32 v0, -1, v0
  v_lshlrev_b32 v222, 3, v0
  buffer_load_dwordx2 v[220:221], v222, s[32:35], s50 offen offset:0 sc1
  v_bfe_u32 v1, v0, 4, 1
  v_lshlrev_b32 v1, 14, v1
  v_lshrrev_b32 v15, 5, v0
  v_lshl_add_u32 v1, v15, 8, v1
  v_bfe_u32 v15, v0, 0, 4
  v_lshl_add_u32 v1, v15, 4, v1
  s_mul_i32 s54, s40, 131072
  s_mul_i32 s67, s39, 32768
  s_add_u32 s54, s54, s67
  s_add_u32 s54, s54, 4194304
  v_lshlrev_b32 v8, 4, v0
  v_lshlrev_b32 v222, 3, v0
  v_lshrrev_b32 v3, 5, v0
  v_lshlrev_b32 v3, 9, v3
  v_bfe_u32 v15, v0, 2, 2
  v_lshl_add_u32 v3, v15, 6, v3
  v_bfe_u32 v15, v0, 4, 1
  v_lshl_add_u32 v3, v15, 5, v3
  v_bfe_u32 v15, v0, 0, 1
  v_lshl_add_u32 v3, v15, 4, v3
  v_bfe_u32 v15, v0, 1, 1
  v_lshl_add_u32 v3, v15, 3, v3
  v_add_u32 v4, 65536, v3
  s_and_b32 s64, s39, 1
  s_lshr_b32 s65, s39, 1
  s_mul_i32 s66, s64, 32
  s_mul_i32 s67, s65, 32768
  s_add_u32 s66, s66, s67
  v_lshrrev_b32 v5, 4, v0
  v_lshlrev_b32 v5, 9, v5
  v_bfe_u32 v15, v0, 2, 2
  v_lshl_add_u32 v5, v15, 6, v5
  v_bfe_u32 v15, v0, 0, 2
  v_lshl_add_u32 v5, v15, 3, v5
  v_add_u32 v5, s66, v5
  v_lshrrev_b32 v2, 5, v0
  v_lshlrev_b32 v2, 12, v2
  v_bfe_u32 v15, v0, 0, 5
  v_lshl_add_u32 v2, v15, 4, v2
  s_mul_i32 s55, s40, 8192
  s_mul_i32 s67, s39, 512
  s_add_u32 s55, s55, s67
  s_add_u32 s55, s55, 1048576
  s_and_b32 s58, s46, 286331153
  s_and_b32 s59, s47, 286331153
  s_add_u32 s57, s50, 4096
  v_bfe_u32 v13, v0, 4, 1
  v_lshlrev_b32 v13, 6, v13
  v_bfe_u32 v15, v0, 0, 2
  v_lshl_add_u32 v13, v15, 2, v13
  v_bfe_u32 v15, v0, 2, 1
  v_lshl_add_u32 v13, v15, 5, v13
  v_bfe_u32 v15, v0, 3, 1
  v_lshl_add_u32 v13, v15, 4, v13
  v_add_u32 v13, 163072, v13
  ds_read_b32 v76, v13 offset:0
  ds_read_b32 v80, v13 offset:128
  ds_read_b32 v78, v13 offset:256
  s_waitcnt lgkmcnt(2)
  v_cvt_pk_bf16_f32 v14, v76, v76
  v_lshlrev_b32 v14, 16, v14
  v_sub_f32 v14, v76, v14
  v_cvt_pk_bf16_f32 v76, v76, v14
  s_waitcnt lgkmcnt(1)
  v_cvt_pk_bf16_f32 v14, v80, v80
  v_lshlrev_b32 v14, 16, v14
  v_sub_f32 v14, v80, v14
  v_cvt_pk_bf16_f32 v80, v80, v14
  s_waitcnt lgkmcnt(0)
  v_cvt_pk_bf16_f32 v14, v78, v78
  v_lshlrev_b32 v14, 16, v14
  v_sub_f32 v14, v78, v14
  v_cvt_pk_bf16_f32 v78, v78, v14
  s_add_u32 s69, s36, 6
  v_mov_b32 v216, s69
  v_mov_b32 v217, s37
  s_mov_b64 exec, 1
  s_cmp_lg_u32 s38, 0
  s_waitcnt vmcnt(2)
  s_cbranch_scc1 L_slow_45
  buffer_store_dwordx2 v[216:217], off, s[32:35], s51
L_sigd_46:
  s_mov_b64 exec, -1
  v_mov_b32 v218, s36
  v_mov_b32 v219, s37
  s_mov_b64 exec, 1
  s_waitcnt vmcnt(2)
  buffer_store_dwordx2 v[218:219], off, s[32:35], s3 sc1
  s_mov_b64 exec, -1
  s_mov_b32 s69, 0
  s_waitcnt vmcnt(2)
L_chk_48:
  v_subrev_u32 v220, s36, v220
  v_xor_b32 v221, s37, v221
  v_subrev_u32 v220, 5, v220
  v_cmp_lt_u64 vcc, 31, v[220:221]
  s_nop 0
  s_and_b64 vcc, vcc, s[46:47]
  s_cbranch_scc1 L_poll_47
  s_cmp_lg_u32 s38, 0
  s_cbranch_scc1 L_inv_50
L_polld_49:
  buffer_load_dwordx4 v[140:143], v1, s[32:35], s54 offen offset:0 sc1
  buffer_load_dwordx4 v[144:147], v1, s[32:35], s54 offen offset:512 sc1
  buffer_load_dwordx4 v[148:151], v1, s[32:35], s54 offen offset:1024 sc1
  buffer_load_dwordx4 v[152:155], v1, s[32:35], s54 offen offset:1536 sc1
  buffer_load_dwordx4 v[156:159], v1, s[32:35], s54 offen offset:2048 sc1
  buffer_load_dwordx4 v[160:163], v1, s[32:35], s54 offen offset:2560 sc1
  buffer_load_dwordx4 v[164:167], v1, s[32:35], s54 offen offset:3072 sc1
  buffer_load_dwordx4 v[168:171], v1, s[32:35], s54 offen offset:3584 sc1
  ds_read_b64_tr_b16 v[92:93], v3 offset:0
  ds_read_b64_tr_b16 v[94:95], v3 offset:256
  ds_read_b64_tr_b16 v[96:97], v3 offset:32768
  ds_read_b64_tr_b16 v[98:99], v3 offset:33024
  ds_read_b64_tr_b16 v[100:101], v4 offset:0
  ds_read_b64_tr_b16 v[102:103], v4 offset:256
  s_waitcnt vmcnt(7) lgkmcnt(4)
  v_mfma_f32_32x32x16_bf16 v[16:31], v[92:95], v[140:143], 0
  ds_read_b64_tr_b16 v[104:105], v3 offset:1024
  ds_read_b64_tr_b16 v[106:107], v3 offset:1280
  s_add_u32 s54, s54, 4096
  buffer_load_dwordx4 v[172:175], v1, s[32:35], s54 offen offset:0 sc1
  v_lshrrev_b32 v7, 4, v0
  s_waitcnt lgkmcnt(4)
  v_mfma_f32_32x32x16_bf16 v[32:47], v[96:99], v[140:143], 0
  ds_read_b64_tr_b16 v[92:93], v3 offset:33792
  ds_read_b64_tr_b16 v[94:95], v3 offset:34048
  v_lshlrev_b32 v7, 7, v7
  v_bfe_u32 v15, v0, 0, 3
  v_lshl_add_u32 v7, v15, 4, v7
  s_waitcnt lgkmcnt(4)
  v_mfma_f32_32x32x16_bf16 v[48:63], v[100:103], v[140:143], 0
  ds_read_b64_tr_b16 v[96:97], v4 offset:1024
  ds_read_b64_tr_b16 v[98:99], v4 offset:1280
  v_lshrrev_b32 v6, 4, v0
  v_lshlrev_b32 v6, 7, v6
  v_bfe_u32 v15, v0, 0, 3
  s_waitcnt vmcnt(7) lgkmcnt(4)
  v_mfma_f32_32x32x16_bf16 v[16:31], v[104:107], v[144:147], v[16:31]
  ds_read_b64_tr_b16 v[100:101], v3 offset:2048
  ds_read_b64_tr_b16 v[102:103], v3 offset:2304
  buffer_load_dwordx4 v[140:143], v1, s[32:35], s54 offen offset:512 sc1
  v_lshl_add_u32 v6, v15, 4, v6
  s_waitcnt lgkmcnt(4)
  v_mfma_f32_32x32x16_bf16 v[32:47], v[92:95], v[144:147], v[32:47]
  ds_read_b64_tr_b16 v[104:105], v3 offset:34816
  ds_read_b64_tr_b16 v[106:107], v3 offset:35072
  v_add_u32 v6, 512, v6
  v_bfe_u32 v13, v0, 3, 1
  v_lshlrev_b32 v13, 9, v13
  s_waitcnt lgkmcnt(4)
  v_mfma_f32_32x32x16_bf16 v[48:63], v[96:99], v[144:147], v[48:63]
  ds_read_b64_tr_b16 v[92:93], v4 offset:2048
  ds_read_b64_tr_b16 v[94:95], v4 offset:2304
  v_sub_u32 v6, v6, v13
  s_mul_i32 s56, s40, 16384
  s_add_u32 s56, s56, 262144
  s_waitcnt vmcnt(7) lgkmcnt(4)
  v_mfma_f32_32x32x16_bf16 v[16:31], v[100:103], v[148:151], v[16:31]
  ds_read_b64_tr_b16 v[96:97], v3 offset:3072
  ds_read_b64_tr_b16 v[98:99], v3 offset:3328
  buffer_load_dwordx4 v[144:147], v1, s[32:35], s54 offen offset:1024 sc1
  s_cmp_eq_u32 s44, 0
  s_cselect_b32 s56, 2147483648, s56
  s_cselect_b32 s60, 0, -1
  s_mov_b32 s61, 0
  s_waitcnt lgkmcnt(4)
  v_mfma_f32_32x32x16_bf16 v[32:47], v[104:107], v[148:151], v[32:47]
  ds_read_b64_tr_b16 v[100:101], v3 offset:35840
  ds_read_b64_tr_b16 v[102:103], v3 offset:36096
  s_mul_i32 s64, s39, 64
  s_add_u32 s64, s64, 163072
  v_lshrrev_b32 v13, 4, v0
  s_waitcnt lgkmcnt(4)
  v_mfma_f32_32x32x16_bf16 v[48:63], v[92:95], v[148:151], v[48:63]
  ds_read_b64_tr_b16 v[104:105], v4 offset:3072
  ds_read_b64_tr_b16 v[106:107], v4 offset:3328
  v_lshlrev_b32 v13, 4, v13
  v_add_u32 v13, s64, v13
  ds_read_b128 v[72:75], v13
  s_waitcnt vmcnt(7) lgkmcnt(5)
  v_mfma_f32_32x32x16_bf16 v[16:31], v[96:99], v[152:155], v[16:31]
  ds_read_b64_tr_b16 v[92:93], v3 offset:4096
  ds_read_b64_tr_b16 v[94:95], v3 offset:4352
  buffer_load_dwordx4 v[148:151], v1, s[32:35], s54 offen offset:1536 sc1
  v_mov_b32 v82, 0
  s_waitcnt lgkmcnt(5)
  v_mfma_f32_32x32x16_bf16 v[32:47], v[100:103], v[152:155], v[32:47]
  ds_read_b64_tr_b16 v[96:97], v3 offset:36864
  ds_read_b64_tr_b16 v[98:99], v3 offset:37120
  v_mov_b32 v83, 0
  v_mov_b32 v85, 0
  v_mov_b32 v86, 0
  s_waitcnt lgkmcnt(5)
  v_mfma_f32_32x32x16_bf16 v[48:63], v[104:107], v[152:155], v[48:63]
  ds_read_b64_tr_b16 v[100:101], v4 offset:4096
  ds_read_b64_tr_b16 v[102:103], v4 offset:4352
  v_mov_b32 v87, 0
  v_mov_b32 v77, 0
  v_mov_b32 v79, 0
  s_waitcnt vmcnt(7) lgkmcnt(4)
  v_mfma_f32_32x32x16_bf16 v[16:31], v[92:95], v[156:159], v[16:31]
  ds_read_b64_tr_b16 v[104:105], v3 offset:5120
  ds_read_b64_tr_b16 v[106:107], v3 offset:5376
  buffer_load_dwordx4 v[152:155], v1, s[32:35], s54 offen offset:2048 sc1
  v_mov_b32 v81, 0
  s_waitcnt lgkmcnt(4)
  v_mfma_f32_32x32x16_bf16 v[32:47], v[96:99], v[156:159], v[32:47]
  ds_read_b64_tr_b16 v[92:93], v3 offset:37888
  ds_read_b64_tr_b16 v[94:95], v3 offset:38144
  s_mul_i32 s62, s40, 458752
  s_mul_i32 s67, s39, 114688
  s_add_u32 s62, s62, s67
  s_waitcnt lgkmcnt(4)
  v_mfma_f32_32x32x16_bf16 v[48:63], v[100:103], v[156:159], v[48:63]
  ds_read_b64_tr_b16 v[96:97], v4 offset:5120
  ds_read_b64_tr_b16 v[98:99], v4 offset:5376
  s_mul_i32 s67, s41, 1024
  s_add_u32 s62, s62, s67
  s_add_u32 s62, s62, 20971520
  s_waitcnt vmcnt(7) lgkmcnt(4)
  v_mfma_f32_32x32x16_bf16 v[16:31], v[104:107], v[160:163], v[16:31]
  ds_read_b64_tr_b16 v[100:101], v3 offset:6144
  ds_read_b64_tr_b16 v[102:103], v3 offset:6400
  buffer_load_dwordx4 v[156:159], v1, s[32:35], s54 offen offset:2560 sc1
  s_add_u32 s63, s62, 57344
  s_waitcnt lgkmcnt(4)
  v_mfma_f32_32x32x16_bf16 v[32:47], v[92:95], v[160:163], v[32:47]
  ds_read_b64_tr_b16 v[104:105], v3 offset:38912
  ds_read_b64_tr_b16 v[106:107], v3 offset:39168
  v_mov_b32 v136, 1065369472
  v_mov_b32 v137, 1065369472
  s_mul_i32 s64, s39, 1024
  s_waitcnt lgkmcnt(4)
  v_mfma_f32_32x32x16_bf16 v[48:63], v[96:99], v[160:163], v[48:63]
  ds_read_b64_tr_b16 v[92:93], v4 offset:6144
  ds_read_b64_tr_b16 v[94:95], v4 offset:6400
  s_add_u32 s64, s64, 141312
  v_bfe_u32 v9, v0, 0, 5
  v_lshlrev_b32 v9, 5, v9
  s_waitcnt vmcnt(7) lgkmcnt(4)
  v_mfma_f32_32x32x16_bf16 v[16:31], v[100:103], v[164:167], v[16:31]
  ds_read_b64_tr_b16 v[96:97], v3 offset:7168
  ds_read_b64_tr_b16 v[98:99], v3 offset:7424
  buffer_load_dwordx4 v[160:163], v1, s[32:35], s54 offen offset:3072 sc1
  v_lshrrev_b32 v15, 5, v0
  s_waitcnt lgkmcnt(4)
  v_mfma_f32_32x32x16_bf16 v[32:47], v[104:107], v[164:167], v[32:47]
  ds_read_b64_tr_b16 v[100:101], v3 offset:39936
  ds_read_b64_tr_b16 v[102:103], v3 offset:40192
  v_lshl_add_u32 v9, v15, 4, v9
  v_add_u32 v9, 512, v9
  v_add_u32 v9, s64, v9
  s_waitcnt lgkmcnt(4)
  v_mfma_f32_32x32x16_bf16 v[48:63], v[92:95], v[164:167], v[48:63]
  ds_read_b64_tr_b16 v[104:105], v4 offset:7168
  ds_read_b64_tr_b16 v[106:107], v4 offset:7424
  v_bfe_u32 v11, v0, 0, 4
  v_lshlrev_b32 v11, 5, v11
  v_lshrrev_b32 v15, 4, v0
  s_waitcnt vmcnt(7) lgkmcnt(4)
  v_mfma_f32_32x32x16_bf16 v[16:31], v[96:99], v[168:171], v[16:31]
  ds_read_b64_tr_b16 v[92:93], v3 offset:8192
  ds_read_b64_tr_b16 v[94:95], v3 offset:8448
  buffer_load_dwordx4 v[164:167], v1, s[32:35], s54 offen offset:3584 sc1
  v_lshl_add_u32 v11, v15, 3, v11
  s_waitcnt lgkmcnt(4)
  v_mfma_f32_32x32x16_bf16 v[32:47], v[100:103], v[168:171], v[32:47]
  ds_read_b64_tr_b16 v[96:97], v3 offset:40960
  ds_read_b64_tr_b16 v[98:99], v3 offset:41216
  buffer_load_dwordx2 v[220:221], v222, s[32:35], s50 offen offset:0 sc1
  s_mul_i32 s65, s39, 4608
  s_waitcnt lgkmcnt(4)
  v_mfma_f32_32x32x16_bf16 v[48:63], v[104:107], v[168:171], v[48:63]
  ds_read_b64_tr_b16 v[100:101], v4 offset:8192
  ds_read_b64_tr_b16 v[102:103], v4 offset:8448
  s_add_u32 s65, s65, 141312
  v_add_u32 v10, s65, v11
  v_add_u32 v11, s64, v11
  s_waitcnt vmcnt(8) lgkmcnt(4)
  v_mfma_f32_32x32x16_bf16 v[16:31], v[92:95], v[172:175], v[16:31]
  ds_read_b64_tr_b16 v[104:105], v3 offset:9216
  ds_read_b64_tr_b16 v[106:107], v3 offset:9472
  s_add_u32 s54, s54, 4096
  buffer_load_dwordx4 v[168:171], v1, s[32:35], s54 offen offset:0 sc1
  v_lshlrev_b32 v12, 3, v0
  s_waitcnt lgkmcnt(4)
  v_mfma_f32_32x32x16_bf16 v[32:47], v[96:99], v[172:175], v[32:47]
  ds_read_b64_tr_b16 v[92:93], v3 offset:41984
  ds_read_b64_tr_b16 v[94:95], v3 offset:42240
  v_add_u32 v12, 9216, v12
  v_add_u32 v12, s64, v12
  v_and_b32 v13, 15, v0
  s_waitcnt lgkmcnt(4)
  v_mfma_f32_32x32x16_bf16 v[48:63], v[100:103], v[172:175], v[48:63]
  ds_read_b64_tr_b16 v[96:97], v4 offset:9216
  ds_read_b64_tr_b16 v[98:99], v4 offset:9472
  v_lshrrev_b32 v14, 4, v0
  v_lshlrev_b32 v14, 2, v14
  v_sub_u32 v13, v13, v14
  s_waitcnt vmcnt(8) lgkmcnt(4)
  v_mfma_f32_32x32x16_bf16 v[16:31], v[104:107], v[140:143], v[16:31]
  ds_read_b64_tr_b16 v[100:101], v3 offset:10240
  ds_read_b64_tr_b16 v[102:103], v3 offset:10496
  buffer_load_dwordx4 v[172:175], v1, s[32:35], s54 offen offset:512 sc1
  v_mov_b32 v64, 4286578688
  s_waitcnt lgkmcnt(4)
  v_mfma_f32_32x32x16_bf16 v[32:47], v[92:95], v[140:143], v[32:47]
  ds_read_b64_tr_b16 v[104:105], v3 offset:43008
  ds_read_b64_tr_b16 v[106:107], v3 offset:43264
  v_mov_b32 v65, 0
  s_add_u32 s66, s44, s39
  s_cmp_eq_u32 s66, 0
  s_cselect_b64 s[64:65], -1, 0
  s_waitcnt lgkmcnt(4)
  v_mfma_f32_32x32x16_bf16 v[48:63], v[96:99], v[140:143], v[48:63]
  ds_read_b64_tr_b16 v[92:93], v4 offset:10240
  ds_read_b64_tr_b16 v[94:95], v4 offset:10496
  v_subrev_u32 v14, 0, v13
  v_cmp_gt_u32 vcc, 8, v14
  v_cmp_gt_i32 s[66:67], -8, v14
  s_nop 0
  v_cndmask_b32 v116, v64, v65, vcc
  v_cndmask_b32 v120, v64, v65, s[66:67]
  s_waitcnt vmcnt(8) lgkmcnt(4)
  v_mfma_f32_32x32x16_bf16 v[16:31], v[100:103], v[144:147], v[16:31]
  ds_read_b64_tr_b16 v[96:97], v3 offset:11264
  ds_read_b64_tr_b16 v[98:99], v3 offset:11520
  buffer_load_dwordx4 v[140:143], v1, s[32:35], s54 offen offset:1024 sc1
  v_cndmask_b32 v124, v120, v64, s[64:65]
  s_waitcnt lgkmcnt(4)
  v_mfma_f32_32x32x16_bf16 v[32:47], v[104:107], v[144:147], v[32:47]
  ds_read_b64_tr_b16 v[100:101], v3 offset:44032
  ds_read_b64_tr_b16 v[102:103], v3 offset:44288
  s_mov_b32 s69, 0
  s_waitcnt vmcnt(3)
L_chk_52:
  v_subrev_u32 v220, s36, v220
  v_xor_b32 v221, s37, v221
  v_subrev_u32 v220, 6, v220
  v_cmp_lt_u64 vcc, 31, v[220:221]
  s_nop 0
  s_and_b64 vcc, vcc, s[58:59]
  s_cbranch_scc1 L_poll_51
  s_cmp_lg_u32 s38, 0
  s_cbranch_scc1 L_inv_54
L_polld_53:
  buffer_load_dwordx4 v[176:179], v2, s[32:35], s55 offen offset:0 sc1
  s_waitcnt lgkmcnt(4)
  v_mfma_f32_32x32x16_bf16 v[48:63], v[92:95], v[144:147], v[48:63]
  ds_read_b64_tr_b16 v[104:105], v4 offset:11264
  ds_read_b64_tr_b16 v[106:107], v4 offset:11520
  buffer_load_dwordx4 v[180:183], v2, s[32:35], s55 offen offset:2048 sc1
  v_subrev_u32 v14, 1, v13
  s_waitcnt lgkmcnt(4)
  v_mfma_f32_32x32x16_bf16 v[16:31], v[96:99], v[148:151], v[16:31]
  ds_read_b64_tr_b16 v[92:93], v3 offset:12288
  ds_read_b64_tr_b16 v[94:95], v3 offset:12544
  buffer_load_dwordx4 v[144:147], v1, s[32:35], s54 offen offset:1536 sc1
  v_cmp_gt_u32 vcc, 8, v14
  v_cmp_gt_i32 s[66:67], -8, v14
  s_nop 0
  v_cndmask_b32 v117, v64, v65, vcc
  s_waitcnt lgkmcnt(4)
  v_mfma_f32_32x32x16_bf16 v[32:47], v[100:103], v[148:151], v[32:47]
  ds_read_b64_tr_b16 v[96:97], v3 offset:45056
  ds_read_b64_tr_b16 v[98:99], v3 offset:45312
  v_cndmask_b32 v121, v64, v65, s[66:67]
  v_cndmask_b32 v125, v121, v64, s[64:65]
  v_subrev_u32 v14, 2, v13
  s_waitcnt lgkmcnt(4)
  v_mfma_f32_32x32x16_bf16 v[48:63], v[104:107], v[148:151], v[48:63]
  ds_read_b64_tr_b16 v[100:101], v4 offset:12288
  ds_read_b64_tr_b16 v[102:103], v4 offset:12544
  v_cmp_gt_u32 vcc, 8, v14
  v_cmp_gt_i32 s[66:67], -8, v14
  s_nop 0
  v_cndmask_b32 v118, v64, v65, vcc
  v_cndmask_b32 v122, v64, v65, s[66:67]
  v_cndmask_b32 v126, v122, v64, s[64:65]
  s_waitcnt lgkmcnt(4)
  v_mfma_f32_32x32x16_bf16 v[16:31], v[92:95], v[152:155], v[16:31]
  ds_read_b64_tr_b16 v[104:105], v3 offset:13312
  ds_read_b64_tr_b16 v[106:107], v3 offset:13568
  buffer_load_dwordx4 v[148:151], v1, s[32:35], s54 offen offset:2048 sc1
  v_subrev_u32 v14, 3, v13
  s_waitcnt lgkmcnt(4)
  v_mfma_f32_32x32x16_bf16 v[32:47], v[96:99], v[152:155], v[32:47]
  ds_read_b64_tr_b16 v[92:93], v3 offset:46080
  ds_read_b64_tr_b16 v[94:95], v3 offset:46336
  v_cmp_gt_u32 vcc, 8, v14
  v_cmp_gt_i32 s[66:67], -8, v14
  s_nop 0
  v_cndmask_b32 v119, v64, v65, vcc
  v_cndmask_b32 v123, v64, v65, s[66:67]
  v_cndmask_b32 v127, v123, v64, s[64:65]
  s_waitcnt lgkmcnt(4)
  v_mfma_f32_32x32x16_bf16 v[48:63], v[100:103], v[152:155], v[48:63]
  ds_read_b64_tr_b16 v[96:97], v4 offset:13312
  ds_read_b64_tr_b16 v[98:99], v4 offset:13568
  v_subrev_u32 v14, 0, v13
  v_subrev_u32 v15, 1, v13
  v_ashrrev_i32 v14, 31, v14
  s_waitcnt lgkmcnt(4)
  v_mfma_f32_32x32x16_bf16 v[16:31], v[104:107], v[156:159], v[16:31]
  ds_read_b64_tr_b16 v[100:101], v3 offset:14336
  ds_read_b64_tr_b16 v[102:103], v3 offset:14592
  buffer_load_dwordx4 v[152:155], v1, s[32:35], s54 offen offset:2560 sc1
  v_ashrrev_i32 v15, 31, v15
  s_waitcnt lgkmcnt(4)
  v_mfma_f32_32x32x16_bf16 v[32:47], v[92:95], v[156:159], v[32:47]
  ds_read_b64_tr_b16 v[104:105], v3 offset:47104
  ds_read_b64_tr_b16 v[106:107], v3 offset:47360
  buffer_load_dwordx2 v[220:221], v222, s[32:35], s57 offen offset:512 sc1
  v_and_b32 v14, 65535, v14
  s_waitcnt lgkmcnt(4)
  v_mfma_f32_32x32x16_bf16 v[48:63], v[96:99], v[156:159], v[48:63]
  ds_read_b64_tr_b16 v[92:93], v4 offset:14336
  ds_read_b64_tr_b16 v[94:95], v4 offset:14592
  v_lshl_or_b32 v130, v15, 16, v14
  v_not_b32 v128, v130
  v_subrev_u32 v14, 2, v13
  s_waitcnt lgkmcnt(4)
  v_mfma_f32_32x32x16_bf16 v[16:31], v[100:103], v[160:163], v[16:31]
  ds_read_b64_tr_b16 v[96:97], v3 offset:15360
  ds_read_b64_tr_b16 v[98:99], v3 offset:15616
  buffer_load_dwordx4 v[156:159], v1, s[32:35], s54 offen offset:3072 sc1
  v_subrev_u32 v15, 3, v13
  s_waitcnt lgkmcnt(4)
  v_mfma_f32_32x32x16_bf16 v[32:47], v[104:107], v[160:163], v[32:47]
  ds_read_b64_tr_b16 v[100:101], v3 offset:48128
  ds_read_b64_tr_b16 v[102:103], v3 offset:48384
  v_ashrrev_i32 v14, 31, v14
  v_ashrrev_i32 v15, 31, v15
  v_and_b32 v14, 65535, v14
  s_waitcnt lgkmcnt(4)
  v_mfma_f32_32x32x16_bf16 v[48:63], v[92:95], v[160:163], v[48:63]
  ds_read_b64_tr_b16 v[104:105], v4 offset:15360
  ds_read_b64_tr_b16 v[106:107], v4 offset:15616
  v_lshl_or_b32 v131, v15, 16, v14
  v_not_b32 v129, v131
  s_waitcnt lgkmcnt(4)
  v_mfma_f32_32x32x16_bf16 v[16:31], v[96:99], v[164:167], v[16:31]
  ds_read_b64_tr_b16 v[92:93], v3 offset:16384
  ds_read_b64_tr_b16 v[94:95], v3 offset:16640
  buffer_load_dwordx4 v[160:163], v1, s[32:35], s54 offen offset:3584 sc1
  s_waitcnt vmcnt(7)
  v_add_f32 v88, v176, v178
  s_waitcnt lgkmcnt(4)
  v_mfma_f32_32x32x16_bf16 v[32:47], v[100:103], v[164:167], v[32:47]
  ds_read_b64_tr_b16 v[96:97], v3 offset:49152
  ds_read_b64_tr_b16 v[98:99], v3 offset:49408
  v_add_f32 v89, v177, v179
  s_waitcnt vmcnt(6)
  v_add_f32 v88, v88, v180
  v_add_f32 v89, v89, v181
  s_waitcnt lgkmcnt(4)
  v_mfma_f32_32x32x16_bf16 v[48:63], v[104:107], v[164:167], v[48:63]
  ds_read_b64_tr_b16 v[100:101], v4 offset:16384
  ds_read_b64_tr_b16 v[102:103], v4 offset:16640
  v_add_f32 v88, v88, v182
  v_add_f32 v89, v89, v183
  v_mov_b32 v13, v88
  s_waitcnt lgkmcnt(4)
  v_mfma_f32_32x32x16_bf16 v[16:31], v[92:95], v[168:171], v[16:31]
  ds_read_b64_tr_b16 v[104:105], v3 offset:17408
  ds_read_b64_tr_b16 v[106:107], v3 offset:17664
  s_add_u32 s54, s54, 4096
  buffer_load_dwordx4 v[164:167], v1, s[32:35], s54 offen offset:0 sc1
  v_mov_b32 v14, v89
  s_waitcnt lgkmcnt(4)
  v_mfma_f32_32x32x16_bf16 v[32:47], v[96:99], v[168:171], v[32:47]
  ds_read_b64_tr_b16 v[92:93], v3 offset:50176
  ds_read_b64_tr_b16 v[94:95], v3 offset:50432
  v_permlane32_swap_b32 v88, v13
  v_permlane32_swap_b32 v89, v14
  v_add_f32 v88, v88, v13
  s_waitcnt lgkmcnt(4)
  v_mfma_f32_32x32x16_bf16 v[48:63], v[100:103], v[168:171], v[48:63]
  ds_read_b64_tr_b16 v[96:97], v4 offset:17408
  ds_read_b64_tr_b16 v[98:99], v4 offset:17664
  v_add_f32 v89, v89, v14
  v_mul_f32 v88, 0xbb000000, v88
  v_mul_f32 v89, 0x3b000000, v89
  s_waitcnt lgkmcnt(4)
  v_mfma_f32_32x32x16_bf16 v[16:31], v[104:107], v[172:175], v[16:31]
  ds_read_b64_tr_b16 v[100:101], v3 offset:18432
  ds_read_b64_tr_b16 v[102:103], v3 offset:18688
  buffer_load_dwordx4 v[168:171], v1, s[32:35], s54 offen offset:512 sc1
  v_fma_f32 v13, -v88, v88, v89
  s_waitcnt lgkmcnt(4)
  v_mfma_f32_32x32x16_bf16 v[32:47], v[92:95], v[172:175], v[32:47]
  ds_read_b64_tr_b16 v[104:105], v3 offset:51200
  ds_read_b64_tr_b16 v[106:107], v3 offset:51456
  v_max_f32 v13, 0, v13
  v_add_f32 v13, 0x3727c5ac, v13
  s_waitcnt lgkmcnt(4)
  v_mfma_f32_32x32x16_bf16 v[48:63], v[96:99], v[172:175], v[48:63]
  ds_read_b64_tr_b16 v[92:93], v4 offset:18432
  ds_read_b64_tr_b16 v[94:95], v4 offset:18688
  v_rsq_f32 v89, v13
  v_cvt_pk_bf16_f32 v84, v88, v88
  s_waitcnt lgkmcnt(4)
  v_mfma_f32_32x32x16_bf16 v[16:31], v[100:103], v[140:143], v[16:31]
  ds_read_b64_tr_b16 v[96:97], v3 offset:19456
  ds_read_b64_tr_b16 v[98:99], v3 offset:19712
  buffer_load_dwordx4 v[172:175], v1, s[32:35], s54 offen offset:1024 sc1
  v_lshlrev_b32 v13, 16, v84
  s_waitcnt lgkmcnt(4)
  v_mfma_f32_32x32x16_bf16 v[32:47], v[104:107], v[140:143], v[32:47]
  ds_read_b64_tr_b16 v[100:101], v3 offset:52224
  ds_read_b64_tr_b16 v[102:103], v3 offset:52480
  v_sub_f32 v13, v88, v13
  v_cvt_pk_bf16_f32 v13, v13, v13
  v_cndmask_b32 v84, v84, v13, s[52:53]
  v_mul_f32 v132, 0x3eb8aa3b, v89
  v_mov_b32 v88, v89
  v_sub_f32 v134, 0, v132
  v_mov_b32 v133, v132
  s_nop 1
  v_permlane16_swap_b32 v132, v133
  s_mov_b32 s69, 0
  s_waitcnt vmcnt(5)
L_chk_56:
  v_cmp_ne_u64 vcc, s[36:37], v[220:221]
  s_nop 0
  s_and_b64 vcc, vcc, s[60:61]
  s_cbranch_scc1 L_poll_55
  s_add_u32 s58, s56, 8192
  buffer_load_dwordx4 v[208:211], v7, s[32:35], s58 offen sc1
  s_waitcnt lgkmcnt(4)
  v_mfma_f32_32x32x16_bf16 v[48:63], v[92:95], v[140:143], v[48:63]
  ds_read_b64_tr_b16 v[104:105], v4 offset:19456
  ds_read_b64_tr_b16 v[106:107], v4 offset:19712
  s_waitcnt lgkmcnt(4)
  v_mfma_f32_32x32x16_bf16 v[16:31], v[96:99], v[144:147], v[16:31]
  ds_read_b64_tr_b16 v[92:93], v3 offset:20480
  ds_read_b64_tr_b16 v[94:95], v3 offset:20736
  buffer_load_dwordx4 v[140:143], v1, s[32:35], s54 offen offset:1536 sc1
  s_waitcnt lgkmcnt(4)
  v_mfma_f32_32x32x16_bf16 v[32:47], v[100:103], v[144:147], v[32:47]
  ds_read_b64_tr_b16 v[96:97], v3 offset:53248
  ds_read_b64_tr_b16 v[98:99], v3 offset:53504
  buffer_load_dwordx4 v[176:179], v6, s[32:35], s56 offen offset:0 sc1
  s_waitcnt lgkmcnt(4)
  v_mfma_f32_32x32x16_bf16 v[48:63], v[104:107], v[144:147], v[48:63]
  ds_read_b64_tr_b16 v[100:101], v4 offset:20480
  ds_read_b64_tr_b16 v[102:103], v4 offset:20736
  buffer_load_dwordx4 v[180:183], v6, s[32:35], s56 offen offset:1024 sc1
  s_waitcnt lgkmcnt(4)
  v_mfma_f32_32x32x16_bf16 v[16:31], v[92:95], v[148:151], v[16:31]
  ds_read_b64_tr_b16 v[104:105], v3 offset:21504
  ds_read_b64_tr_b16 v[106:107], v3 offset:21760
  buffer_load_dwordx4 v[144:147], v1, s[32:35], s54 offen offset:2048 sc1
  s_waitcnt lgkmcnt(4)
  v_mfma_f32_32x32x16_bf16 v[32:47], v[96:99], v[148:151], v[32:47]
  ds_read_b64_tr_b16 v[92:93], v3 offset:54272
  ds_read_b64_tr_b16 v[94:95], v3 offset:54528
  buffer_load_dwordx4 v[184:187], v6, s[32:35], s56 offen offset:2048 sc1
  s_waitcnt lgkmcnt(4)
  v_mfma_f32_32x32x16_bf16 v[48:63], v[100:103], v[148:151], v[48:63]
  ds_read_b64_tr_b16 v[96:97], v4 offset:21504
  ds_read_b64_tr_b16 v[98:99], v4 offset:21760
  buffer_load_dwordx4 v[188:191], v6, s[32:35], s56 offen offset:3072 sc1
  s_waitcnt lgkmcnt(4)
  v_mfma_f32_32x32x16_bf16 v[16:31], v[104:107], v[152:155], v[16:31]
  ds_read_b64_tr_b16 v[100:101], v3 offset:22528
  ds_read_b64_tr_b16 v[102:103], v3 offset:22784
  buffer_load_dwordx4 v[148:151], v1, s[32:35], s54 offen offset:2560 sc1
  v_mfma_f32_32x32x16_bf16 v[16:31], v[76:79], v[84:87], v[16:31]
  s_waitcnt lgkmcnt(4)
  v_mfma_f32_32x32x16_bf16 v[32:47], v[92:95], v[152:155], v[32:47]
  ds_read_b64_tr_b16 v[104:105], v3 offset:55296
  ds_read_b64_tr_b16 v[106:107], v3 offset:55552
  s_add_u32 s56, s56, 4096
  buffer_load_dwordx4 v[192:195], v6, s[32:35], s56 offen offset:0 sc1
  v_mfma_f32_32x32x16_bf16 v[32:47], v[78:81], v[82:85], v[32:47]
  s_waitcnt lgkmcnt(4)
  v_mfma_f32_32x32x16_bf16 v[48:63], v[96:99], v[152:155], v[48:63]
  ds_read_b64_tr_b16 v[92:93], v4 offset:22528
  ds_read_b64_tr_b16 v[94:95], v4 offset:22784
  buffer_load_dwordx4 v[196:199], v6, s[32:35], s56 offen offset:1024 sc1
  v_mfma_f32_32x32x16_bf16 v[48:63], v[76:79], v[82:85], v[48:63]
  s_waitcnt vmcnt(14) lgkmcnt(4)
  v_mfma_f32_32x32x16_bf16 v[16:31], v[100:103], v[156:159], v[16:31]
  ds_read_b64_tr_b16 v[96:97], v3 offset:23552
  ds_read_b64_tr_b16 v[98:99], v3 offset:23808
  buffer_load_dwordx4 v[152:155], v1, s[32:35], s54 offen offset:3072 sc1
  s_waitcnt vmcnt(10)
  v_add_f32 v90, v208, v210
  s_waitcnt lgkmcnt(4)
  v_mfma_f32_32x32x16_bf16 v[32:47], v[104:107], v[156:159], v[32:47]
  ds_read_b64_tr_b16 v[100:101], v3 offset:56320
  ds_read_b64_tr_b16 v[102:103], v3 offset:56576
  buffer_load_dwordx4 v[200:203], v6, s[32:35], s56 offen offset:2048 sc1
  v_add_f32 v91, v209, v211
  s_waitcnt lgkmcnt(4)
  v_mfma_f32_32x32x16_bf16 v[48:63], v[92:95], v[156:159], v[48:63]
  ds_read_b64_tr_b16 v[104:105], v4 offset:23552
  ds_read_b64_tr_b16 v[106:107], v4 offset:23808
  buffer_load_dwordx4 v[204:207], v6, s[32:35], s56 offen offset:3072 sc1
  v_mov_b32 v13, v90
  s_waitcnt lgkmcnt(4)
  v_mfma_f32_32x32x16_bf16 v[16:31], v[96:99], v[160:163], v[16:31]
  ds_read_b64_tr_b16 v[92:93], v3 offset:24576
  ds_read_b64_tr_b16 v[94:95], v3 offset:24832
  buffer_load_dwordx4 v[156:159], v1, s[32:35], s54 offen offset:3584 sc1
  v_mov_b32 v14, v91
  s_waitcnt lgkmcnt(4)
  v_mfma_f32_32x32x16_bf16 v[32:47], v[100:103], v[160:163], v[32:47]
  ds_read_b64_tr_b16 v[96:97], v3 offset:57344
  ds_read_b64_tr_b16 v[98:99], v3 offset:57600
  v_permlane32_swap_b32 v90, v13
  v_permlane32_swap_b32 v91, v14
  v_add_f32 v90, v90, v13
  s_waitcnt lgkmcnt(4)
  v_mfma_f32_32x32x16_bf16 v[48:63], v[104:107], v[160:163], v[48:63]
  ds_read_b64_tr_b16 v[100:101], v4 offset:24576
  ds_read_b64_tr_b16 v[102:103], v4 offset:24832
  v_add_f32 v91, v91, v14
  v_mov_b32 v13, v90
  v_mov_b32 v14, v91
  s_waitcnt lgkmcnt(4)
  v_mfma_f32_32x32x16_bf16 v[16:31], v[92:95], v[164:167], v[16:31]
  ds_read_b64_tr_b16 v[104:105], v3 offset:25600
  ds_read_b64_tr_b16 v[106:107], v3 offset:25856
  v_permlane16_swap_b32 v90, v13
  v_permlane16_swap_b32 v91, v14
  v_add_f32 v90, v90, v13
  s_mul_i32 s59, s41, 262144
  s_mul_i32 s67, s39, 1024
  s_waitcnt lgkmcnt(4)
  v_mfma_f32_32x32x16_bf16 v[32:47], v[96:99], v[164:167], v[32:47]
  ds_read_b64_tr_b16 v[92:93], v3 offset:58368
  ds_read_b64_tr_b16 v[94:95], v3 offset:58624
  ds_read_b64_tr_b16 v[108:109], v5 offset:0
  ds_read_b64_tr_b16 v[110:111], v5 offset:256
  v_add_f32 v91, v91, v14
  s_add_u32 s59, s59, s67
  s_add_u32 s59, s59, 16777216
  s_waitcnt lgkmcnt(6)
  v_mfma_f32_32x32x16_bf16 v[48:63], v[100:103], v[164:167], v[48:63]
  ds_read_b64_tr_b16 v[96:97], v4 offset:25600
  ds_read_b64_tr_b16 v[98:99], v4 offset:25856
  ds_read_b64_tr_b16 v[112:113], v5 offset:2048
  ds_read_b64_tr_b16 v[114:115], v5 offset:2304
  v_mul_f32 v90, 0xbb000000, v90
  s_mul_i32 s60, s39, 1024
  s_add_u32 m0, s60, 98304
  s_waitcnt lgkmcnt(8)
  v_mfma_f32_32x32x16_bf16 v[16:31], v[104:107], v[168:171], v[16:31]
  ds_read_b64_tr_b16 v[100:101], v3 offset:26624
  ds_read_b64_tr_b16 v[102:103], v3 offset:26880
  ds_read_b64_tr_b16 v[208:209], v5 offset:4096
  ds_read_b64_tr_b16 v[210:211], v5 offset:4352
  s_waitcnt vmcnt(11) lgkmcnt(8)
  v_mfma_f32_16x16x32_bf16 v[64:67], v[108:111], v[176:179], 0
  v_mul_f32 v91, 0x3b000000, v91
  v_fma_f32 v13, -v90, v90, v91
  v_max_f32 v13, 0, v13
  s_add_u32 s61, s59, 196608
  v_mfma_f32_32x32x16_bf16 v[32:47], v[92:95], v[168:171], v[32:47]
  ds_read_b64_tr_b16 v[104:105], v3 offset:59392
  ds_read_b64_tr_b16 v[106:107], v3 offset:59648
  ds_read_b64_tr_b16 v[212:213], v5 offset:6144
  ds_read_b64_tr_b16 v[214:215], v5 offset:6400
  s_waitcnt lgkmcnt(8)
  v_mfma_f32_16x16x32_bf16 v[68:71], v[112:115], v[176:179], 0
  v_add_f32 v13, 0x3727c5ac, v13
  v_rsq_f32 v91, v13
  buffer_load_dwordx4 v8, s[32:35], s61 offen lds
  v_mfma_f32_32x32x16_bf16 v[48:63], v[96:99], v[168:171], v[48:63]
  ds_read_b64_tr_b16 v[92:93], v4 offset:26624
  ds_read_b64_tr_b16 v[94:95], v4 offset:26880
  ds_read_b64_tr_b16 v[108:109], v5 offset:8192
  ds_read_b64_tr_b16 v[110:111], v5 offset:8448
  s_waitcnt vmcnt(11) lgkmcnt(8)
  v_mfma_f32_16x16x32_bf16 v[64:67], v[208:211], v[180:183], v[64:67]
  s_add_u32 m0, s60, 102400
  s_add_u32 s61, s59, 163840
  v_mfma_f32_32x32x16_bf16 v[16:31], v[100:103], v[172:175], v[16:31]
  ds_read_b64_tr_b16 v[96:97], v3 offset:27648
  ds_read_b64_tr_b16 v[98:99], v3 offset:27904
  ds_read_b64_tr_b16 v[112:113], v5 offset:10240
  ds_read_b64_tr_b16 v[114:115], v5 offset:10496
  s_waitcnt lgkmcnt(8)
  v_mfma_f32_16x16x32_bf16 v[68:71], v[212:215], v[180:183], v[68:71]
  buffer_load_dwordx4 v8, s[32:35], s61 offen lds
  s_add_u32 m0, s60, 106496
  v_mfma_f32_32x32x16_bf16 v[32:47], v[104:107], v[172:175], v[32:47]
  ds_read_b64_tr_b16 v[100:101], v3 offset:60416
  ds_read_b64_tr_b16 v[102:103], v3 offset:60672
  ds_read_b64_tr_b16 v[208:209], v5 offset:12288
  ds_read_b64_tr_b16 v[210:211], v5 offset:12544
  s_waitcnt vmcnt(10) lgkmcnt(8)
  v_mfma_f32_16x16x32_bf16 v[64:67], v[108:111], v[184:187], v[64:67]
  s_add_u32 s61, s59, 200704
  buffer_load_dwordx4 v8, s[32:35], s61 offen lds
  v_mfma_f32_32x32x16_bf16 v[48:63], v[92:95], v[172:175], v[48:63]
  ds_read_b64_tr_b16 v[104:105], v4 offset:27648
  ds_read_b64_tr_b16 v[106:107], v4 offset:27904
  ds_read_b64_tr_b16 v[212:213], v5 offset:14336
  ds_read_b64_tr_b16 v[214:215], v5 offset:14592
  s_waitcnt lgkmcnt(8)
  v_mfma_f32_16x16x32_bf16 v[68:71], v[112:115], v[184:187], v[68:71]
  s_add_u32 m0, s60, 110592
  s_add_u32 s61, s59, 167936
  v_mfma_f32_32x32x16_bf16 v[16:31], v[96:99], v[140:143], v[16:31]
  ds_read_b64_tr_b16 v[92:93], v3 offset:28672
  ds_read_b64_tr_b16 v[94:95], v3 offset:28928
  ds_read_b64_tr_b16 v[108:109], v5 offset:16384
  ds_read_b64_tr_b16 v[110:111], v5 offset:16640
  s_waitcnt vmcnt(10) lgkmcnt(8)
  v_mfma_f32_16x16x32_bf16 v[64:67], v[208:211], v[188:191], v[64:67]
  buffer_load_dwordx4 v8, s[32:35], s61 offen lds
  s_add_u32 m0, s60, 114688
  v_mfma_f32_32x32x16_bf16 v[32:47], v[100:103], v[140:143], v[32:47]
  ds_read_b64_tr_b16 v[96:97], v3 offset:61440
  ds_read_b64_tr_b16 v[98:99], v3 offset:61696
  ds_read_b64_tr_b16 v[112:113], v5 offset:18432
  ds_read_b64_tr_b16 v[114:115], v5 offset:18688
  s_waitcnt lgkmcnt(8)
  v_mfma_f32_16x16x32_bf16 v[68:71], v[212:215], v[188:191], v[68:71]
  s_add_u32 s61, s59, 204800
  buffer_load_dwordx4 v8, s[32:35], s61 offen lds
  v_mfma_f32_32x32x16_bf16 v[48:63], v[104:107], v[140:143], v[48:63]
  ds_read_b64_tr_b16 v[100:101], v4 offset:28672
  ds_read_b64_tr_b16 v[102:103], v4 offset:28928
  ds_read_b64_tr_b16 v[208:209], v5 offset:20480
  ds_read_b64_tr_b16 v[210:211], v5 offset:20736
  s_waitcnt vmcnt(10) lgkmcnt(8)
  v_mfma_f32_16x16x32_bf16 v[64:67], v[108:111], v[192:195], v[64:67]
  s_add_u32 m0, s60, 118784
  s_add_u32 s61, s59, 172032
  v_mfma_f32_32x32x16_bf16 v[16:31], v[92:95], v[144:147], v[16:31]
  ds_read_b64_tr_b16 v[104:105], v3 offset:29696
  ds_read_b64_tr_b16 v[106:107], v3 offset:29952
  ds_read_b64_tr_b16 v[212:213], v5 offset:22528
  ds_read_b64_tr_b16 v[214:215], v5 offset:22784
  s_waitcnt lgkmcnt(8)
  v_mfma_f32_16x16x32_bf16 v[68:71], v[112:115], v[192:195], v[68:71]
  buffer_load_dwordx4 v8, s[32:35], s61 offen lds
  s_add_u32 m0, s60, 122880
  v_mfma_f32_32x32x16_bf16 v[32:47], v[96:99], v[144:147], v[32:47]
  ds_read_b64_tr_b16 v[92:93], v3 offset:62464
  ds_read_b64_tr_b16 v[94:95], v3 offset:62720
  ds_read_b64_tr_b16 v[108:109], v5 offset:24576
  ds_read_b64_tr_b16 v[110:111], v5 offset:24832
  s_waitcnt vmcnt(10) lgkmcnt(8)
  v_mfma_f32_16x16x32_bf16 v[64:67], v[208:211], v[196:199], v[64:67]
  s_add_u32 s61, s59, 208896
  buffer_load_dwordx4 v8, s[32:35], s61 offen lds
  v_mfma_f32_32x32x16_bf16 v[48:63], v[100:103], v[144:147], v[48:63]
  ds_read_b64_tr_b16 v[96:97], v4 offset:29696
  ds_read_b64_tr_b16 v[98:99], v4 offset:29952
  ds_read_b64_tr_b16 v[112:113], v5 offset:26624
  ds_read_b64_tr_b16 v[114:115], v5 offset:26880
  s_waitcnt lgkmcnt(8)
  v_mfma_f32_16x16x32_bf16 v[68:71], v[212:215], v[196:199], v[68:71]
  s_add_u32 m0, s60, 126976
  s_add_u32 s61, s59, 176128
  v_mfma_f32_32x32x16_bf16 v[16:31], v[104:107], v[148:151], v[16:31]
  ds_read_b64_tr_b16 v[100:101], v3 offset:30720
  ds_read_b64_tr_b16 v[102:103], v3 offset:30976
  ds_read_b64_tr_b16 v[208:209], v5 offset:28672
  ds_read_b64_tr_b16 v[210:211], v5 offset:28928
  s_waitcnt vmcnt(9) lgkmcnt(8)
  v_mfma_f32_16x16x32_bf16 v[64:67], v[108:111], v[200:203], v[64:67]
  buffer_load_dwordx4 v8, s[32:35], s61 offen lds
  s_add_u32 m0, s60, 131072
  v_mfma_f32_32x32x16_bf16 v[32:47], v[92:95], v[148:151], v[32:47]
  ds_read_b64_tr_b16 v[104:105], v3 offset:63488
  ds_read_b64_tr_b16 v[106:107], v3 offset:63744
  ds_read_b64_tr_b16 v[212:213], v5 offset:30720
  ds_read_b64_tr_b16 v[214:215], v5 offset:30976
  s_waitcnt lgkmcnt(8)
  v_mfma_f32_16x16x32_bf16 v[68:71], v[112:115], v[200:203], v[68:71]
  s_add_u32 s61, s59, 212992
  buffer_load_dwordx4 v8, s[32:35], s61 offen lds
  v_mfma_f32_32x32x16_bf16 v[48:63], v[96:99], v[148:151], v[48:63]
  ds_read_b64_tr_b16 v[92:93], v4 offset:30720
  ds_read_b64_tr_b16 v[94:95], v4 offset:30976
  s_waitcnt vmcnt(10) lgkmcnt(6)
  v_mfma_f32_16x16x32_bf16 v[64:67], v[208:211], v[204:207], v[64:67]
  v_mfma_f32_32x32x16_bf16 v[16:31], v[100:103], v[152:155], v[16:31]
  ds_read_b64_tr_b16 v[96:97], v3 offset:31744
  ds_read_b64_tr_b16 v[98:99], v3 offset:32000
  s_waitcnt lgkmcnt(4)
  v_mfma_f32_16x16x32_bf16 v[68:71], v[212:215], v[204:207], v[68:71]
  v_mfma_f32_32x32x16_bf16 v[32:47], v[104:107], v[152:155], v[32:47]
  ds_read_b64_tr_b16 v[100:101], v3 offset:64512
  ds_read_b64_tr_b16 v[102:103], v3 offset:64768
  s_waitcnt lgkmcnt(4)
  v_mfma_f32_32x32x16_bf16 v[48:63], v[92:95], v[152:155], v[48:63]
  ds_read_b64_tr_b16 v[104:105], v4 offset:31744
  ds_read_b64_tr_b16 v[106:107], v4 offset:32000
  s_waitcnt vmcnt(9) lgkmcnt(4)
  v_mfma_f32_32x32x16_bf16 v[16:31], v[96:99], v[156:159], v[16:31]
  v_add_f32_dpp v64, v68, v64 row_ror:8 row_mask:0xf bank_mask:0xf
  v_add_f32_dpp v65, v69, v65 row_ror:8 row_mask:0xf bank_mask:0xf
  v_add_f32_dpp v66, v70, v66 row_ror:8 row_mask:0xf bank_mask:0xf
  s_waitcnt lgkmcnt(2)
  v_mfma_f32_32x32x16_bf16 v[32:47], v[100:103], v[156:159], v[32:47]
  v_add_f32_dpp v67, v71, v67 row_ror:8 row_mask:0xf bank_mask:0xf
  v_fma_f32 v64, v90, v72, v64
  v_fma_f32 v65, v90, v73, v65
  s_waitcnt lgkmcnt(0)
  v_mfma_f32_32x32x16_bf16 v[48:63], v[104:107], v[156:159], v[48:63]
  v_fma_f32 v66, v90, v74, v66
  v_fma_f32 v67, v90, v75, v67
  v_mul_f32 v64, v91, v64
  v_mul_f32 v65, v91, v65
  v_mul_f32 v66, v91, v66
  v_mul_f32 v67, v91, v67
  v_cvt_pk_bf16_f32 v64, v64, v65
  v_cvt_pk_bf16_f32 v65, v66, v67
  ds_write_b64 v10, v[64:65]
  v_pk_mul_f32 v[16:17], v[16:17], v[88:89]
  v_pk_mul_f32 v[18:19], v[18:19], v[88:89]
  v_pk_mul_f32 v[20:21], v[20:21], v[88:89]
  v_pk_mul_f32 v[22:23], v[22:23], v[88:89]
  v_pk_mul_f32 v[24:25], v[24:25], v[88:89]
  v_pk_mul_f32 v[26:27], v[26:27], v[88:89]
  v_pk_mul_f32 v[28:29], v[28:29], v[88:89]
  v_pk_mul_f32 v[30:31], v[30:31], v[88:89]
  v_cvt_pk_bf16_f32 v16, v16, v17
  v_cvt_pk_bf16_f32 v17, v18, v19
  v_cvt_pk_bf16_f32 v18, v20, v21
  v_cvt_pk_bf16_f32 v19, v22, v23
  v_cvt_pk_bf16_f32 v20, v24, v25
  v_cvt_pk_bf16_f32 v21, v26, v27
  v_cvt_pk_bf16_f32 v22, v28, v29
  v_cvt_pk_bf16_f32 v23, v30, v31
  ds_write_b128 v9, v[16:19] offset:0
  ds_write_b128 v9, v[20:23] offset:4608
  v_pk_mul_f32 v[32:33], v[32:33], v[88:89]
  v_pk_mul_f32 v[34:35], v[34:35], v[88:89]
  v_pk_mul_f32 v[36:37], v[36:37], v[88:89]
  v_pk_mul_f32 v[38:39], v[38:39], v[88:89]
  v_pk_mul_f32 v[40:41], v[40:41], v[88:89]
  v_pk_mul_f32 v[42:43], v[42:43], v[88:89]
  v_pk_mul_f32 v[44:45], v[44:45], v[88:89]
  v_pk_mul_f32 v[46:47], v[46:47], v[88:89]
  v_cvt_pk_bf16_f32 v32, v32, v33
  v_cvt_pk_bf16_f32 v33, v34, v35
  v_cvt_pk_bf16_f32 v34, v36, v37
  v_cvt_pk_bf16_f32 v35, v38, v39
  v_cvt_pk_bf16_f32 v36, v40, v41
  v_cvt_pk_bf16_f32 v37, v42, v43
  v_cvt_pk_bf16_f32 v38, v44, v45
  v_cvt_pk_bf16_f32 v39, v46, v47
  ds_write_b128 v9, v[32:35] offset:9216
  ds_write_b128 v9, v[36:39] offset:13824
  v_cvt_pk_bf16_f32 v48, v48, v49
  v_cvt_pk_bf16_f32 v49, v50, v51
  v_cvt_pk_bf16_f32 v50, v52, v53
  v_cvt_pk_bf16_f32 v51, v54, v55
  v_cvt_pk_bf16_f32 v52, v56, v57
  v_cvt_pk_bf16_f32 v53, v58, v59
  v_cvt_pk_bf16_f32 v54, v60, v61
  v_cvt_pk_bf16_f32 v55, v62, v63
  v_permlane16_swap_b32 v48, v50
  v_permlane16_swap_b32 v49, v51
  v_permlane16_swap_b32 v52, v54
  v_permlane16_swap_b32 v53, v55
  s_waitcnt lgkmcnt(0)
  s_barrier
  ds_read_b64 v[140:141], v11 offset:0
  ds_read_b64 v[142:143], v11 offset:512
  ds_read_b64 v[144:145], v11 offset:1024
  ds_read_b64 v[146:147], v11 offset:4608
  ds_read_b64 v[148:149], v11 offset:5120
  ds_read_b64 v[150:151], v11 offset:5632
  ds_read_b64_tr_b16 v[152:153], v12 offset:0
  ds_read_b64_tr_b16 v[154:155], v12 offset:512
  ds_read_b64_tr_b16 v[156:157], v12 offset:1024
  ds_read_b64_tr_b16 v[158:159], v12 offset:4608
  ds_read_b64_tr_b16 v[160:161], v12 offset:5120
  ds_read_b64_tr_b16 v[162:163], v12 offset:5632
  s_mul_i32 s59, s41, 262144
  s_mul_i32 s67, s39, 1024
  s_add_u32 s59, s59, s67
  s_add_u32 s59, s59, 16777216
  s_mul_i32 s60, s39, 1024
  s_waitcnt lgkmcnt(10)
  v_mfma_f32_16x16x16_bf16 v[164:167], v[142:143], v[48:49], v[116:119]
  v_mfma_f32_16x16x16_bf16 v[180:183], v[140:141], v[48:49], v[124:127]
  s_waitcnt lgkmcnt(7)
  v_mfma_f32_16x16x16_bf16 v[168:171], v[148:149], v[52:53], v[116:119]
  v_mfma_f32_16x16x16_bf16 v[184:187], v[146:147], v[52:53], v[124:127]
  v_mfma_f32_16x16x16_bf16 v[172:175], v[144:145], v[50:51], v[116:119]
  v_mfma_f32_16x16x16_bf16 v[188:191], v[142:143], v[50:51], v[120:123]
  s_waitcnt lgkmcnt(6)
  v_mfma_f32_16x16x16_bf16 v[176:179], v[150:151], v[54:55], v[116:119]
  v_mfma_f32_16x16x16_bf16 v[192:195], v[148:149], v[54:55], v[120:123]
  v_max_f32 v164, v164, v180
  v_max_f32 v165, v165, v181
  v_max_f32 v166, v166, v182
  v_max_f32 v167, v167, v183
  v_max_f32 v168, v168, v184
  v_max_f32 v169, v169, v185
  v_max_f32 v170, v170, v186
  v_max_f32 v171, v171, v187
  s_add_u32 m0, s60, 0
  s_add_u32 s61, s59, 180224
  buffer_load_dwordx4 v8, s[32:35], s61 offen lds
  v_max_f32 v172, v172, v188
  v_max_f32 v173, v173, v189
  v_max_f32 v174, v174, v190
  v_max_f32 v175, v175, v191
  v_max_f32 v176, v176, v192
  v_max_f32 v177, v177, v193
  v_max_f32 v178, v178, v194
  v_max_f32 v179, v179, v195
  s_add_u32 m0, s60, 4096
  s_add_u32 s61, s59, 217088
  buffer_load_dwordx4 v8, s[32:35], s61 offen lds
  v_max3_f32 v196, v164, v165, v166
  v_max3_f32 v197, v168, v169, v170
  v_max3_f32 v198, v172, v173, v174
  v_max3_f32 v199, v176, v177, v178
  v_max_f32 v196, v196, v167
  v_max_f32 v197, v197, v171
  v_max_f32 v198, v198, v175
  v_max_f32 v199, v199, v179
  v_permlane32_swap_b32 v196, v197
  s_nop 0
  v_permlane32_swap_b32 v198, v199
  v_max_f32 v196, v196, v197
  v_max_f32 v198, v198, v199
  s_nop 1
  v_permlane16_swap_b32 v196, v198
  v_max_f32 v196, v196, v198
  v_mul_f32 v196, v196, v134
  v_mov_b32 v198, v196
  s_nop 1
  v_permlane16_swap_b32 v196, v198
  v_mov_b32 v197, v196
  v_mov_b32 v199, v198
  s_nop 0
  v_permlane32_swap_b32 v196, v197
  v_permlane32_swap_b32 v198, v199
  v_pk_fma_f32 v[164:165], v[164:165], v[132:133], v[196:197] op_sel:[0,0,0] op_sel_hi:[1,0,0]
  v_pk_fma_f32 v[166:167], v[166:167], v[132:133], v[196:197] op_sel:[0,0,0] op_sel_hi:[1,0,0]
  v_pk_fma_f32 v[168:169], v[168:169], v[132:133], v[196:197] op_sel:[0,0,1] op_sel_hi:[1,0,1]
  v_pk_fma_f32 v[170:171], v[170:171], v[132:133], v[196:197] op_sel:[0,0,1] op_sel_hi:[1,0,1]
  v_pk_fma_f32 v[172:173], v[172:173], v[132:133], v[198:199] op_sel:[0,1,0] op_sel_hi:[1,1,0]
  v_pk_fma_f32 v[174:175], v[174:175], v[132:133], v[198:199] op_sel:[0,1,0] op_sel_hi:[1,1,0]
  v_pk_fma_f32 v[176:177], v[176:177], v[132:133], v[198:199] op_sel:[0,1,1] op_sel_hi:[1,1,1]
  v_pk_fma_f32 v[178:179], v[178:179], v[132:133], v[198:199] op_sel:[0,1,1] op_sel_hi:[1,1,1]
  v_exp_f32 v164, v164
  v_exp_f32 v165, v165
  v_exp_f32 v166, v166
  v_exp_f32 v167, v167
  s_add_u32 m0, s60, 8192
  s_add_u32 s61, s59, 184320
  buffer_load_dwordx4 v8, s[32:35], s61 offen lds
  v_exp_f32 v168, v168
  v_exp_f32 v169, v169
  v_cvt_pk_bf16_f32 v164, v164, v165
  v_cvt_pk_bf16_f32 v165, v166, v167
  v_exp_f32 v170, v170
  v_exp_f32 v171, v171
  v_and_b32 v180, v164, v128
  v_and_b32 v181, v165, v129
  v_and_b32 v182, v164, v130
  v_and_b32 v183, v165, v131
  s_add_u32 m0, s60, 12288
  s_add_u32 s61, s59, 221184
  buffer_load_dwordx4 v8, s[32:35], s61 offen lds
  v_exp_f32 v172, v172
  v_exp_f32 v173, v173
  v_mfma_f32_16x16x16_bf16 v[32:35], v[136:137], v[164:165], 0
  v_cvt_pk_bf16_f32 v168, v168, v169
  v_cvt_pk_bf16_f32 v169, v170, v171
  v_exp_f32 v174, v174
  v_exp_f32 v175, v175
  s_waitcnt lgkmcnt(4)
  v_mfma_f32_16x16x16_bf16 v[16:19], v[154:155], v[180:181], 0
  v_and_b32 v184, v168, v128
  v_and_b32 v185, v169, v129
  v_and_b32 v186, v168, v130
  v_and_b32 v187, v169, v131
  v_mfma_f32_16x16x16_bf16 v[16:19], v[152:153], v[182:183], v[16:19]
  s_add_u32 m0, s60, 16384
  s_add_u32 s61, s59, 188416
  buffer_load_dwordx4 v8, s[32:35], s61 offen lds
  v_exp_f32 v176, v176
  v_exp_f32 v177, v177
  v_mfma_f32_16x16x16_bf16 v[36:39], v[136:137], v[168:169], 0
  v_cvt_pk_bf16_f32 v172, v172, v173
  v_cvt_pk_bf16_f32 v173, v174, v175
  v_exp_f32 v178, v178
  v_exp_f32 v179, v179
  s_waitcnt lgkmcnt(1)
  v_mfma_f32_16x16x16_bf16 v[20:23], v[160:161], v[184:185], 0
  v_and_b32 v188, v172, v128
  v_and_b32 v189, v173, v129
  v_and_b32 v190, v172, v130
  v_and_b32 v191, v173, v131
  v_mfma_f32_16x16x16_bf16 v[20:23], v[158:159], v[186:187], v[20:23]
  s_add_u32 m0, s60, 20480
  s_add_u32 s61, s59, 225280
  buffer_load_dwordx4 v8, s[32:35], s61 offen lds
  v_mfma_f32_16x16x16_bf16 v[40:43], v[136:137], v[172:173], 0
  v_cvt_pk_bf16_f32 v176, v176, v177
  v_cvt_pk_bf16_f32 v177, v178, v179
  v_mfma_f32_16x16x16_bf16 v[24:27], v[156:157], v[188:189], 0
  v_and_b32 v192, v176, v128
  v_and_b32 v193, v177, v129
  v_and_b32 v194, v176, v130
  v_and_b32 v195, v177, v131
  v_mfma_f32_16x16x16_bf16 v[24:27], v[154:155], v[190:191], v[24:27]
  v_mfma_f32_16x16x16_bf16 v[44:47], v[136:137], v[176:177], 0
  s_waitcnt lgkmcnt(0)
  v_mfma_f32_16x16x16_bf16 v[28:31], v[162:163], v[192:193], 0
  v_mfma_f32_16x16x16_bf16 v[28:31], v[160:161], v[194:195], v[28:31]
  v_rcp_f32 v32, v32
  v_rcp_f32 v36, v36
  v_rcp_f32 v40, v40
  s_nop 1
  v_rcp_f32 v44, v44
  v_pk_mul_f32 v[16:17], v[16:17], v[32:33] op_sel_hi:[1,0]
  v_pk_mul_f32 v[18:19], v[18:19], v[32:33] op_sel_hi:[1,0]
  v_pk_mul_f32 v[20:21], v[20:21], v[36:37] op_sel_hi:[1,0]
  v_pk_mul_f32 v[22:23], v[22:23], v[36:37] op_sel_hi:[1,0]
  v_pk_mul_f32 v[24:25], v[24:25], v[40:41] op_sel_hi:[1,0]
  v_pk_mul_f32 v[26:27], v[26:27], v[40:41] op_sel_hi:[1,0]
  v_pk_mul_f32 v[28:29], v[28:29], v[44:45] op_sel_hi:[1,0]
  v_pk_mul_f32 v[30:31], v[30:31], v[44:45] op_sel_hi:[1,0]
  v_cvt_pk_bf16_f32 v200, v16, v17
  v_cvt_pk_bf16_f32 v201, v18, v19
  v_cvt_pk_bf16_f32 v202, v20, v21
  v_cvt_pk_bf16_f32 v203, v22, v23
  buffer_store_dwordx4 v[200:203], v8, s[32:35], s62 offen
  v_cvt_pk_bf16_f32 v204, v24, v25
  v_cvt_pk_bf16_f32 v205, v26, v27
  v_cvt_pk_bf16_f32 v206, v28, v29
  v_cvt_pk_bf16_f32 v207, v30, v31
  buffer_store_dwordx4 v[204:207], v8, s[32:35], s63 offen
  s_add_u32 s69, s36, 7
  v_mov_b32 v220, s69
  v_mov_b32 v221, s37
  v_mbcnt_lo_u32_b32 v0, -1, 0
  v_mbcnt_hi_u32_b32 v0, -1, v0
  v_lshlrev_b32 v222, 3, v0
  v_bfe_u32 v2, v0, 4, 1
  v_lshlrev_b32 v2, 14, v2
  v_lshrrev_b32 v15, 5, v0
  v_lshl_add_u32 v2, v15, 8, v2
  v_bfe_u32 v15, v0, 0, 4
  v_lshl_add_u32 v2, v15, 4, v2
  s_mul_i32 s56, s40, 131072
  s_mul_i32 s67, s42, 65536
  s_add_u32 s56, s56, s67
  s_mul_i32 s67, s43, 2048
  s_add_u32 s56, s56, s67
  s_mul_i32 s67, s39, 512
  s_add_u32 s56, s56, s67
  s_add_u32 s56, s56, 4194304
  s_add_u32 s57, s56, 32768
  v_lshlrev_b32 v8, 4, v0
  v_bfe_u32 v1, v0, 4, 1
  v_mul_u32_u24 v1, 57344, v1
  v_lshrrev_b32 v15, 5, v0
  v_lshl_add_u32 v1, v15, 8, v1
  v_bfe_u32 v15, v0, 0, 4
  v_lshl_add_u32 v1, v15, 4, v1
  s_mul_i32 s54, s40, 458752
  s_mul_i32 s67, s42, 229376
  s_add_u32 s54, s54, s67
  s_mul_i32 s67, s39, 4096
  s_add_u32 s54, s54, s67
  s_add_u32 s54, s54, 20971520
  s_add_u32 s55, s54, 114688
  s_add_u32 s64, s39, 1
  s_and_b32 s64, s64, 3
  s_mul_i32 s65, s64, 6144
  s_add_u32 s65, s65, 135168
  v_add_u32 v4, s65, v8
  s_add_u32 s64, s39, 2
  s_and_b32 s64, s64, 3
  s_mul_i32 s65, s64, 6144
  s_add_u32 s65, s65, 137216
  v_add_u32 v5, s65, v8
  s_add_u32 s64, s39, 3
  s_and_b32 s64, s64, 3
  s_mul_i32 s65, s64, 6144
  s_add_u32 s65, s65, 139264
  v_add_u32 v6, s65, v8
  s_mul_i32 s65, s39, 6144
  s_add_u32 s65, s65, 135168
  v_add_u32 v7, s65, v8
  s_mov_b64 exec, 1
  s_cmp_lg_u32 s38, 0
  s_waitcnt vmcnt(0)
  s_cbranch_scc1 L_slow_58
  buffer_store_dwordx2 v[220:221], off, s[32:35], s51
L_sigd_59:
  s_mov_b64 exec, -1
  s_barrier
  buffer_load_dwordx4 v[104:107], v2, s[32:35], s56 offen sc1
  buffer_load_dwordx4 v[108:111], v2, s[32:35], s57 offen sc1
  buffer_load_dwordx2 v[220:221], v222, s[32:35], s50 offen offset:0 sc1
  v_mov_b32 v11, 1065369472
  v_mov_b32 v112, 0
  v_mov_b32 v113, 0
  v_mov_b32 v114, 0
  v_mov_b32 v115, 0
  v_mov_b32 v24, 0
  v_mov_b32 v25, 0
  v_mov_b32 v26, 0
  v_mov_b32 v27, 0
  v_mov_b32 v28, 0
  v_mov_b32 v29, 0
  v_mov_b32 v30, 0
  v_mov_b32 v31, 0
  s_waitcnt vmcnt(2)
  v_lshlrev_b32 v16, 16, v104
  v_and_b32 v17, 4294901760, v104
  v_lshlrev_b32 v18, 16, v105
  v_and_b32 v19, 4294901760, v105
  v_lshlrev_b32 v20, 16, v106
  v_and_b32 v21, 4294901760, v106
  v_lshlrev_b32 v22, 16, v107
  v_and_b32 v23, 4294901760, v107
  v_mov_b32 v56, 0
  v_mov_b32 v57, 0
  v_mov_b32 v58, 0
  v_mov_b32 v59, 0
  v_mov_b32 v60, 0
  v_mov_b32 v61, 0
  v_mov_b32 v62, 0
  v_mov_b32 v63, 0
  s_waitcnt vmcnt(1)
  v_lshlrev_b32 v48, 16, v108
  v_and_b32 v49, 4294901760, v108
  v_lshlrev_b32 v50, 16, v109
  v_and_b32 v51, 4294901760, v109
  v_lshlrev_b32 v52, 16, v110
  v_and_b32 v53, 4294901760, v110
  v_lshlrev_b32 v54, 16, v111
  v_and_b32 v55, 4294901760, v111
  s_mov_b32 s69, 0
  s_waitcnt vmcnt(0)
L_chk_61:
  v_subrev_u32 v220, s36, v220
  v_xor_b32 v221, s37, v221
  v_subrev_u32 v220, 7, v220
  v_cmp_lt_u64 vcc, 31, v[220:221]
  s_nop 0
  s_and_b64 vcc, vcc, s[48:49]
  s_cbranch_scc1 L_poll_60
  s_cmp_lg_u32 s38, 0
  s_cbranch_scc1 L_inv_63
L_polld_62:
  buffer_load_dwordx4 v[128:131], v1, s[32:35], s54 offen offset:0 sc1
  buffer_load_dwordx4 v[132:135], v1, s[32:35], s54 offen offset:512 sc1
  buffer_load_dwordx4 v[136:139], v1, s[32:35], s54 offen offset:1024 sc1
  buffer_load_dwordx4 v[140:143], v1, s[32:35], s54 offen offset:1536 sc1
  buffer_load_dwordx4 v[144:147], v1, s[32:35], s54 offen offset:2048 sc1
  buffer_load_dwordx4 v[148:151], v1, s[32:35], s54 offen offset:2560 sc1
  buffer_load_dwordx4 v[152:155], v1, s[32:35], s54 offen offset:3072 sc1
  buffer_load_dwordx4 v[156:159], v1, s[32:35], s54 offen offset:3584 sc1
  s_add_u32 s69, s36, 8
  v_mov_b32 v220, s69
  v_mov_b32 v221, s37
  s_waitcnt vmcnt(7)
  v_mfma_f32_32x32x16_bf16 v[16:31], a[224:227], v[128:131], v[16:31]
  buffer_load_dwordx4 v[160:163], v1, s[32:35], s55 offen offset:0 sc1
  v_mfma_f32_32x32x16_bf16 v[32:47], a[228:231], v[128:131], 0
  s_waitcnt vmcnt(7)
  v_mfma_f32_32x32x16_bf16 v[16:31], a[232:235], v[132:135], v[16:31]
  buffer_load_dwordx4 v[164:167], v1, s[32:35], s55 offen offset:512 sc1
  v_mfma_f32_32x32x16_bf16 v[32:47], a[236:239], v[132:135], v[32:47]
  s_waitcnt vmcnt(7)
  v_mfma_f32_32x32x16_bf16 v[16:31], a[240:243], v[136:139], v[16:31]
  buffer_load_dwordx4 v[168:171], v1, s[32:35], s55 offen offset:1024 sc1
  v_mfma_f32_32x32x16_bf16 v[32:47], a[244:247], v[136:139], v[32:47]
  s_waitcnt vmcnt(7)
  v_mfma_f32_32x32x16_bf16 v[16:31], a[248:251], v[140:143], v[16:31]
  buffer_load_dwordx4 v[172:175], v1, s[32:35], s55 offen offset:1536 sc1
  v_mfma_f32_32x32x16_bf16 v[32:47], a[252:255], v[140:143], v[32:47]
  s_waitcnt vmcnt(7)
  v_mfma_f32_32x32x16_bf16 v[16:31], v[224:227], v[144:147], v[16:31]
  buffer_load_dwordx4 v[128:131], v1, s[32:35], s55 offen offset:2048 sc1
  v_mfma_f32_32x32x16_bf16 v[32:47], v[228:231], v[144:147], v[32:47]
  s_waitcnt vmcnt(7)
  v_mfma_f32_32x32x16_bf16 v[16:31], v[232:235], v[148:151], v[16:31]
  buffer_load_dwordx4 v[132:135], v1, s[32:35], s55 offen offset:2560 sc1
  v_mfma_f32_32x32x16_bf16 v[32:47], v[236:239], v[148:151], v[32:47]
  s_waitcnt vmcnt(7)
  v_mfma_f32_32x32x16_bf16 v[16:31], v[240:243], v[152:155], v[16:31]
  buffer_load_dwordx4 v[136:139], v1, s[32:35], s55 offen offset:3072 sc1
  s_mul_i32 s63, s41, 262144
  s_mul_i32 s67, s39, 1024
  s_add_u32 s63, s63, s67
  s_add_u32 s63, s63, 16777216
  v_mfma_f32_32x32x16_bf16 v[32:47], v[244:247], v[152:155], v[32:47]
  s_mul_i32 s62, s39, 1024
  s_add_u32 m0, s62, 24576
  s_add_u32 s61, s63, 192512
  buffer_load_dwordx4 v8, s[32:35], s61 offen lds
  s_waitcnt vmcnt(8)
  v_mfma_f32_32x32x16_bf16 v[16:31], v[248:251], v[156:159], v[16:31]
  buffer_load_dwordx4 v[140:143], v1, s[32:35], s55 offen offset:3584 sc1
  s_add_u32 m0, s62, 28672
  s_add_u32 s61, s63, 131072
  buffer_load_dwordx4 v8, s[32:35], s61 offen lds
  v_mfma_f32_32x32x16_bf16 v[32:47], v[252:255], v[156:159], v[32:47]
  s_add_u32 m0, s62, 32768
  s_add_u32 s61, s63, 135168
  buffer_load_dwordx4 v8, s[32:35], s61 offen lds
  s_add_u32 m0, s62, 36864
  s_waitcnt vmcnt(10)
  v_mfma_f32_32x32x16_bf16 v[48:63], a[224:227], v[160:163], v[48:63]
  s_add_u32 s61, s63, 139264
  buffer_load_dwordx4 v8, s[32:35], s61 offen lds
  s_add_u32 m0, s62, 40960
  s_add_u32 s61, s63, 143360
  v_mfma_f32_32x32x16_bf16 v[64:79], a[228:231], v[160:163], 0
  buffer_load_dwordx4 v8, s[32:35], s61 offen lds
  s_add_u32 m0, s62, 45056
  s_add_u32 s61, s63, 147456
  s_waitcnt vmcnt(11)
  v_mfma_f32_32x32x16_bf16 v[48:63], a[232:235], v[164:167], v[48:63]
  buffer_load_dwordx4 v8, s[32:35], s61 offen lds
  s_add_u32 m0, s62, 49152
  s_add_u32 s61, s63, 151552
  v_mfma_f32_32x32x16_bf16 v[64:79], a[236:239], v[164:167], v[64:79]
  buffer_load_dwordx4 v8, s[32:35], s61 offen lds
  s_add_u32 m0, s62, 53248
  s_add_u32 s61, s63, 155648
  s_waitcnt vmcnt(12)
  v_mfma_f32_32x32x16_bf16 v[48:63], a[240:243], v[168:171], v[48:63]
  ds_write_b128 v4, v[24:27] offset:0
  ds_write_b128 v4, v[28:31] offset:1024
  buffer_load_dwordx4 v8, s[32:35], s61 offen lds
  v_mfma_f32_32x32x16_bf16 v[64:79], a[244:247], v[168:171], v[64:79]
  ds_write_b128 v5, v[32:35] offset:0
  ds_write_b128 v5, v[36:39] offset:1024
  s_waitcnt vmcnt(12)
  v_mfma_f32_32x32x16_bf16 v[48:63], a[248:251], v[172:175], v[48:63]
  ds_write_b128 v6, v[40:43] offset:0
  ds_write_b128 v6, v[44:47] offset:1024
  v_mfma_f32_32x32x16_bf16 v[64:79], a[252:255], v[172:175], v[64:79]
  s_waitcnt vmcnt(11)
  v_mfma_f32_32x32x16_bf16 v[48:63], v[224:227], v[128:131], v[48:63]
  s_waitcnt lgkmcnt(0)
  s_barrier
  ds_read_b128 v[80:83], v7 offset:0
  ds_read_b128 v[84:87], v7 offset:1024
  ds_read_b128 v[88:91], v7 offset:2048
  v_mfma_f32_32x32x16_bf16 v[64:79], v[228:231], v[128:131], v[64:79]
  ds_read_b128 v[92:95], v7 offset:3072
  ds_read_b128 v[96:99], v7 offset:4096
  ds_read_b128 v[100:103], v7 offset:5120
  s_waitcnt vmcnt(10)
  v_mfma_f32_32x32x16_bf16 v[48:63], v[232:235], v[132:135], v[48:63]
  v_mfma_f32_32x32x16_bf16 v[64:79], v[236:239], v[132:135], v[64:79]
  s_waitcnt lgkmcnt(5)
  v_add_f32 v16, v16, v80
  v_add_f32 v17, v17, v81
  v_add_f32 v18, v18, v82
  v_add_f32 v19, v19, v83
  s_waitcnt lgkmcnt(4)
  v_add_f32 v20, v20, v84
  s_waitcnt vmcnt(9)
  v_mfma_f32_32x32x16_bf16 v[48:63], v[240:243], v[136:139], v[48:63]
  v_add_f32 v21, v21, v85
  v_add_f32 v22, v22, v86
  v_add_f32 v23, v23, v87
  s_waitcnt lgkmcnt(3)
  v_add_f32 v16, v16, v88
  v_add_f32 v17, v17, v89
  v_mfma_f32_32x32x16_bf16 v[64:79], v[244:247], v[136:139], v[64:79]
  v_add_f32 v18, v18, v90
  v_add_f32 v19, v19, v91
  s_waitcnt lgkmcnt(2)
  v_add_f32 v20, v20, v92
  v_add_f32 v21, v21, v93
  v_add_f32 v22, v22, v94
  s_waitcnt vmcnt(7)
  v_mfma_f32_32x32x16_bf16 v[48:63], v[248:251], v[140:143], v[48:63]
  v_add_f32 v23, v23, v95
  s_waitcnt lgkmcnt(1)
  v_add_f32 v16, v16, v96
  v_add_f32 v17, v17, v97
  v_add_f32 v18, v18, v98
  v_add_f32 v19, v19, v99
  v_mfma_f32_32x32x16_bf16 v[64:79], v[252:255], v[140:143], v[64:79]
  s_waitcnt lgkmcnt(0)
  v_add_f32 v20, v20, v100
  v_add_f32 v21, v21, v101
  v_add_f32 v22, v22, v102
  v_add_f32 v23, v23, v103
  v_cvt_pk_bf16_f32 v104, v16, v17
  v_cvt_pk_bf16_f32 v105, v18, v19
  v_cvt_pk_bf16_f32 v106, v20, v21
  v_cvt_pk_bf16_f32 v107, v22, v23
  buffer_store_dwordx4 v[104:107], v2, s[32:35], s56 offen
  s_barrier
  ds_write_b128 v4, v[56:59] offset:0
  ds_write_b128 v4, v[60:63] offset:1024
  ds_write_b128 v5, v[64:67] offset:0
  ds_write_b128 v5, v[68:71] offset:1024
  ds_write_b128 v6, v[72:75] offset:0
  ds_write_b128 v6, v[76:79] offset:1024
  s_waitcnt lgkmcnt(0)
  s_barrier
  ds_read_b128 v[80:83], v7 offset:0
  ds_read_b128 v[84:87], v7 offset:1024
  ds_read_b128 v[88:91], v7 offset:2048
  ds_read_b128 v[92:95], v7 offset:3072
  ds_read_b128 v[96:99], v7 offset:4096
  ds_read_b128 v[100:103], v7 offset:5120
  s_waitcnt lgkmcnt(5)
  v_pk_add_f32 v[48:49], v[48:49], v[80:81]
  v_pk_add_f32 v[50:51], v[50:51], v[82:83]
  s_waitcnt lgkmcnt(4)
  v_pk_add_f32 v[52:53], v[52:53], v[84:85]
  v_pk_add_f32 v[54:55], v[54:55], v[86:87]
  s_waitcnt lgkmcnt(3)
  v_pk_add_f32 v[48:49], v[48:49], v[88:89]
  v_pk_add_f32 v[50:51], v[50:51], v[90:91]
  s_waitcnt lgkmcnt(2)
  v_pk_add_f32 v[52:53], v[52:53], v[92:93]
  v_pk_add_f32 v[54:55], v[54:55], v[94:95]
  s_waitcnt lgkmcnt(1)
  v_pk_add_f32 v[48:49], v[48:49], v[96:97]
  v_pk_add_f32 v[50:51], v[50:51], v[98:99]
  s_waitcnt lgkmcnt(0)
  v_pk_add_f32 v[52:53], v[52:53], v[100:101]
  v_pk_add_f32 v[54:55], v[54:55], v[102:103]
  v_cvt_pk_bf16_f32 v108, v48, v49
  v_cvt_pk_bf16_f32 v109, v50, v51
  v_cvt_pk_bf16_f32 v110, v52, v53
  v_cvt_pk_bf16_f32 v111, v54, v55
  buffer_store_dwordx4 v[108:111], v2, s[32:35], s57 offen
  v_mov_b32 v88, v104
  v_mov_b32 v89, v105
  v_mov_b32 v90, v106
  v_mov_b32 v91, v107
  v_mov_b32 v92, v108
  v_mov_b32 v93, v109
  v_mov_b32 v94, v110
  v_mov_b32 v95, v111
  v_dot2c_f32_bf16 v112, v104, v11
  v_dot2c_f32_bf16 v113, v104, v104
  v_dot2c_f32_bf16 v114, v108, v11
  v_dot2c_f32_bf16 v115, v108, v108
  v_dot2c_f32_bf16 v112, v105, v11
  v_dot2c_f32_bf16 v113, v105, v105
  v_dot2c_f32_bf16 v114, v109, v11
  v_dot2c_f32_bf16 v115, v109, v109
  v_dot2c_f32_bf16 v112, v106, v11
  v_dot2c_f32_bf16 v113, v106, v106
  v_dot2c_f32_bf16 v114, v110, v11
  v_dot2c_f32_bf16 v115, v110, v110
  v_dot2c_f32_bf16 v112, v107, v11
  v_dot2c_f32_bf16 v113, v107, v107
  v_dot2c_f32_bf16 v114, v111, v11
  v_dot2c_f32_bf16 v115, v111, v111
  v_lshrrev_b32 v12, 1, v8
  s_mul_i32 s65, s39, 512
  s_add_u32 s65, s65, 160000
  v_add_u32 v13, s65, v12
  v_permlane32_swap_b32 v112, v114
  v_permlane32_swap_b32 v113, v115
  v_add_u32 v12, 160000, v12
  v_pk_add_f32 v[112:113], v[112:113], v[114:115]
  ds_write_b64 v13, v[112:113]
  s_lshr_b32 s64, s43, 1
  s_and_b32 s65, s43, 1
  s_mul_i32 s66, s40, 8192
  s_mul_i32 s67, s64, 2048
  s_add_u32 s66, s66, s67
  s_mul_i32 s67, s42, 1024
  s_add_u32 s66, s66, s67
  s_mul_i32 s67, s65, 8
  s_add_u32 s66, s66, s67
  s_add_u32 s66, s66, 1048576
  s_cmp_eq_u32 s39, 0
  s_cselect_b32 s66, s66, 2147483648
  s_mov_b64 exec, 1
  s_cmp_lg_u32 s38, 0
  s_waitcnt vmcnt(0)
  s_cbranch_scc1 L_slow_64
  buffer_store_dwordx2 v[220:221], off, s[32:35], s51
L_sigd_65:
  s_mov_b64 exec, -1
  s_waitcnt lgkmcnt(0)
  s_barrier
  ds_read_b64 v[16:17], v12 offset:0
  ds_read_b64 v[18:19], v12 offset:512
  ds_read_b64 v[20:21], v12 offset:1024
  ds_read_b64 v[22:23], v12 offset:1536
  s_waitcnt lgkmcnt(2)
  v_pk_add_f32 v[16:17], v[16:17], v[18:19]
  s_waitcnt lgkmcnt(0)
  v_pk_add_f32 v[20:21], v[20:21], v[22:23]
  v_pk_add_f32 v[16:17], v[16:17], v[20:21]
  buffer_store_dwordx2 v[16:17], v8, s[32:35], s66 offen
  v_mbcnt_lo_u32_b32 v0, -1, 0
  v_mbcnt_hi_u32_b32 v0, -1, v0
  v_lshlrev_b32 v222, 3, v0
  buffer_load_dwordx2 v[220:221], v222, s[32:35], s50 offen offset:0 sc1
  v_bfe_u32 v1, v0, 4, 1
  v_lshlrev_b32 v1, 14, v1
  v_lshrrev_b32 v15, 5, v0
  v_lshl_add_u32 v1, v15, 8, v1
  v_bfe_u32 v15, v0, 0, 4
  v_lshl_add_u32 v1, v15, 4, v1
  s_mul_i32 s54, s40, 131072
  s_mul_i32 s67, s39, 32768
  s_add_u32 s54, s54, s67
  s_add_u32 s54, s54, 4194304
  v_lshrrev_b32 v2, 5, v0
  v_lshlrev_b32 v2, 12, v2
  v_bfe_u32 v15, v0, 0, 5
  v_lshl_add_u32 v2, v15, 4, v2
  s_mul_i32 s55, s40, 8192
  s_mul_i32 s67, s39, 512
  s_add_u32 s55, s55, s67
  s_add_u32 s55, s55, 1048576
  v_mov_b32 v81, v222
  s_mul_i32 s56, s40, 458752
  s_mul_i32 s67, s39, 114688
  s_add_u32 s56, s56, s67
  s_mul_i32 s67, s41, 3584
  s_add_u32 s56, s56, s67
  s_add_u32 s56, s56, 20971520
  s_mul_i32 s59, s41, 262144
  s_mul_i32 s67, s39, 1024
  s_add_u32 s59, s59, s67
  s_add_u32 s59, s59, 16678912
  s_mul_i32 s60, s39, 1024
  v_lshlrev_b32 v6, 4, v0
  v_add_u32 v6, 98304, v6
  v_lshlrev_b32 v0, 4, v0
  v_add_u32 v7, 65536, v0
  s_and_b32 s64, s46, 286331153
  s_and_b32 s65, s47, 286331153
  s_add_u32 s69, s36, 9
  v_mov_b32 v82, s69
  v_mov_b32 v83, s37
  s_mov_b64 exec, 1
  s_cmp_lg_u32 s38, 0
  s_waitcnt vmcnt(1)
  s_cbranch_scc1 L_slow_66
  buffer_store_dwordx2 v[82:83], off, s[32:35], s51
L_sigd_67:
  s_mov_b64 exec, -1
  s_mov_b32 s69, 0
  s_waitcnt vmcnt(1)
L_chk_69:
  v_subrev_u32 v220, s36, v220
  v_xor_b32 v221, s37, v221
  v_subrev_u32 v220, 8, v220
  v_cmp_lt_u64 vcc, 31, v[220:221]
  s_nop 0
  s_and_b64 vcc, vcc, s[46:47]
  s_cbranch_scc1 L_poll_68
  s_cmp_lg_u32 s38, 0
  s_cbranch_scc1 L_inv_71
L_polld_70:
  buffer_load_dwordx4 v[96:99], v1, s[32:35], s54 offen offset:0 sc1
  buffer_load_dwordx4 v[100:103], v1, s[32:35], s54 offen offset:512 sc1
  buffer_load_dwordx4 v[104:107], v1, s[32:35], s54 offen offset:1024 sc1
  buffer_load_dwordx4 v[108:111], v1, s[32:35], s54 offen offset:1536 sc1
  buffer_load_dwordx4 v[112:115], v1, s[32:35], s54 offen offset:2048 sc1
  buffer_load_dwordx4 v[116:119], v1, s[32:35], s54 offen offset:2560 sc1
  buffer_load_dwordx4 v[120:123], v1, s[32:35], s54 offen offset:3072 sc1
  buffer_load_dwordx4 v[124:127], v1, s[32:35], s54 offen offset:3584 sc1
  ds_read_b128 v[16:19], v6 offset:0
  ds_read_b128 v[20:23], v6 offset:4096
  ds_read_b128 v[24:27], v6 offset:1024
  ds_read_b128 v[28:31], v6 offset:5120
  s_waitcnt vmcnt(7) lgkmcnt(2)
  v_mfma_f32_32x32x16_bf16 v[32:47], v[16:19], v[96:99], 0
  ds_read_b128 v[84:87], v6 offset:2048
  s_add_u32 s54, s54, 4096
  buffer_load_dwordx4 v[128:131], v1, s[32:35], s54 offen offset:0 sc1
  v_mfma_f32_32x32x16_bf16 v[48:63], v[20:23], v[96:99], 0
  ds_read_b128 v[16:19], v6 offset:6144
  s_waitcnt vmcnt(7) lgkmcnt(2)
  v_mfma_f32_32x32x16_bf16 v[32:47], v[24:27], v[100:103], v[32:47]
  ds_read_b128 v[20:23], v6 offset:3072
  buffer_load_dwordx4 v[132:135], v1, s[32:35], s54 offen offset:512 sc1
  v_mfma_f32_32x32x16_bf16 v[48:63], v[28:31], v[100:103], v[48:63]
  ds_read_b128 v[24:27], v6 offset:7168
  s_waitcnt vmcnt(7) lgkmcnt(2)
  v_mfma_f32_32x32x16_bf16 v[32:47], v[84:87], v[104:107], v[32:47]
  ds_read_b128 v[28:31], v6 offset:8192
  buffer_load_dwordx4 v[136:139], v1, s[32:35], s54 offen offset:1024 sc1
  v_mfma_f32_32x32x16_bf16 v[48:63], v[16:19], v[104:107], v[48:63]
  ds_read_b128 v[84:87], v6 offset:12288
  s_waitcnt vmcnt(7) lgkmcnt(2)
  v_mfma_f32_32x32x16_bf16 v[32:47], v[20:23], v[108:111], v[32:47]
  ds_read_b128 v[16:19], v6 offset:9216
  buffer_load_dwordx4 v[140:143], v1, s[32:35], s54 offen offset:1536 sc1
  v_mfma_f32_32x32x16_bf16 v[48:63], v[24:27], v[108:111], v[48:63]
  ds_read_b128 v[20:23], v6 offset:13312
  s_waitcnt vmcnt(7) lgkmcnt(2)
  v_mfma_f32_32x32x16_bf16 v[32:47], v[28:31], v[112:115], v[32:47]
  ds_read_b128 v[24:27], v6 offset:10240
  buffer_load_dwordx4 v[144:147], v1, s[32:35], s54 offen offset:2048 sc1
  v_mfma_f32_32x32x16_bf16 v[48:63], v[84:87], v[112:115], v[48:63]
  ds_read_b128 v[28:31], v6 offset:14336
  s_waitcnt vmcnt(7) lgkmcnt(2)
  v_mfma_f32_32x32x16_bf16 v[32:47], v[16:19], v[116:119], v[32:47]
  ds_read_b128 v[84:87], v6 offset:11264
  buffer_load_dwordx4 v[148:151], v1, s[32:35], s54 offen offset:2560 sc1
  v_mfma_f32_32x32x16_bf16 v[48:63], v[20:23], v[116:119], v[48:63]
  ds_read_b128 v[16:19], v6 offset:15360
  s_waitcnt vmcnt(7) lgkmcnt(2)
  v_mfma_f32_32x32x16_bf16 v[32:47], v[24:27], v[120:123], v[32:47]
  ds_read_b128 v[20:23], v6 offset:16384
  buffer_load_dwordx4 v[152:155], v1, s[32:35], s54 offen offset:3072 sc1
  v_mfma_f32_32x32x16_bf16 v[48:63], v[28:31], v[120:123], v[48:63]
  ds_read_b128 v[24:27], v6 offset:20480
  s_waitcnt vmcnt(7) lgkmcnt(2)
  v_mfma_f32_32x32x16_bf16 v[32:47], v[84:87], v[124:127], v[32:47]
  ds_read_b128 v[28:31], v6 offset:17408
  buffer_load_dwordx4 v[156:159], v1, s[32:35], s54 offen offset:3584 sc1
  v_mfma_f32_32x32x16_bf16 v[48:63], v[16:19], v[124:127], v[48:63]
  ds_read_b128 v[84:87], v6 offset:21504
  s_waitcnt vmcnt(7) lgkmcnt(2)
  v_mfma_f32_32x32x16_bf16 v[32:47], v[20:23], v[128:131], v[32:47]
  ds_read_b128 v[16:19], v6 offset:18432
  s_add_u32 s54, s54, 4096
  buffer_load_dwordx4 v[160:163], v1, s[32:35], s54 offen offset:0 sc1
  buffer_load_dwordx2 v[82:83], v81, s[32:35], s50 offen offset:0 sc1
  v_mfma_f32_32x32x16_bf16 v[48:63], v[24:27], v[128:131], v[48:63]
  ds_read_b128 v[20:23], v6 offset:22528
  s_waitcnt vmcnt(8) lgkmcnt(2)
  v_mfma_f32_32x32x16_bf16 v[32:47], v[28:31], v[132:135], v[32:47]
  ds_read_b128 v[24:27], v6 offset:19456
  buffer_load_dwordx4 v[164:167], v1, s[32:35], s54 offen offset:512 sc1
  v_mfma_f32_32x32x16_bf16 v[48:63], v[84:87], v[132:135], v[48:63]
  ds_read_b128 v[28:31], v6 offset:23552
  s_waitcnt vmcnt(8) lgkmcnt(2)
  v_mfma_f32_32x32x16_bf16 v[32:47], v[16:19], v[136:139], v[32:47]
  ds_read_b128 v[84:87], v6 offset:24576
  buffer_load_dwordx4 v[168:171], v1, s[32:35], s54 offen offset:1024 sc1
  v_mfma_f32_32x32x16_bf16 v[48:63], v[20:23], v[136:139], v[48:63]
  ds_read_b128 v[16:19], v6 offset:28672
  s_waitcnt vmcnt(8) lgkmcnt(2)
  v_mfma_f32_32x32x16_bf16 v[32:47], v[24:27], v[140:143], v[32:47]
  ds_read_b128 v[20:23], v6 offset:25600
  buffer_load_dwordx4 v[172:175], v1, s[32:35], s54 offen offset:1536 sc1
  v_mfma_f32_32x32x16_bf16 v[48:63], v[28:31], v[140:143], v[48:63]
  ds_read_b128 v[24:27], v6 offset:29696
  s_waitcnt vmcnt(8) lgkmcnt(2)
  v_mfma_f32_32x32x16_bf16 v[32:47], v[84:87], v[144:147], v[32:47]
  ds_read_b128 v[28:31], v6 offset:26624
  buffer_load_dwordx4 v[176:179], v1, s[32:35], s54 offen offset:2048 sc1
  v_mfma_f32_32x32x16_bf16 v[48:63], v[16:19], v[144:147], v[48:63]
  ds_read_b128 v[84:87], v6 offset:30720
  s_waitcnt vmcnt(8) lgkmcnt(2)
  v_mfma_f32_32x32x16_bf16 v[32:47], v[20:23], v[148:151], v[32:47]
  ds_read_b128 v[16:19], v6 offset:27648
  buffer_load_dwordx4 v[180:183], v1, s[32:35], s54 offen offset:2560 sc1
  s_mov_b32 s69, 0
  s_waitcnt vmcnt(5)
L_chk_73:
  v_subrev_u32 v82, s36, v82
  v_xor_b32 v83, s37, v83
  v_subrev_u32 v82, 9, v82
  v_cmp_lt_u64 vcc, 31, v[82:83]
  s_nop 0
  s_and_b64 vcc, vcc, s[64:65]
  s_cbranch_scc1 L_poll_72
  s_cmp_lg_u32 s38, 0
  s_cbranch_scc1 L_inv_75
L_polld_74:
  buffer_load_dwordx4 v[64:67], v2, s[32:35], s55 offen offset:0 sc1
  v_mfma_f32_32x32x16_bf16 v[48:63], v[24:27], v[148:151], v[48:63]
  ds_read_b128 v[20:23], v6 offset:31744
  s_waitcnt lgkmcnt(2)
  v_mfma_f32_32x32x16_bf16 v[32:47], v[28:31], v[152:155], v[32:47]
  ds_read_b128 v[24:27], v6 offset:32768
  buffer_load_dwordx4 v[184:187], v1, s[32:35], s54 offen offset:3072 sc1
  buffer_load_dwordx4 v[68:71], v2, s[32:35], s55 offen offset:2048 sc1
  v_mfma_f32_32x32x16_bf16 v[48:63], v[84:87], v[152:155], v[48:63]
  ds_read_b128 v[28:31], v0 offset:0
  s_waitcnt lgkmcnt(2)
  v_mfma_f32_32x32x16_bf16 v[32:47], v[16:19], v[156:159], v[32:47]
  ds_read_b128 v[84:87], v6 offset:33792
  buffer_load_dwordx4 v[188:191], v1, s[32:35], s54 offen offset:3584 sc1
  v_mfma_f32_32x32x16_bf16 v[48:63], v[20:23], v[156:159], v[48:63]
  ds_read_b128 v[16:19], v0 offset:1024
  s_waitcnt lgkmcnt(2)
  v_mfma_f32_32x32x16_bf16 v[32:47], v[24:27], v[160:163], v[32:47]
  ds_read_b128 v[20:23], v6 offset:34816
  s_add_u32 s54, s54, 4096
  buffer_load_dwordx4 v[192:195], v1, s[32:35], s54 offen offset:0 sc1
  v_mfma_f32_32x32x16_bf16 v[48:63], v[28:31], v[160:163], v[48:63]
  ds_read_b128 v[24:27], v0 offset:2048
  s_waitcnt vmcnt(9) lgkmcnt(2)
  v_mfma_f32_32x32x16_bf16 v[32:47], v[84:87], v[164:167], v[32:47]
  ds_read_b128 v[28:31], v6 offset:35840
  buffer_load_dwordx4 v[196:199], v1, s[32:35], s54 offen offset:512 sc1
  v_mfma_f32_32x32x16_bf16 v[48:63], v[16:19], v[164:167], v[48:63]
  ds_read_b128 v[84:87], v0 offset:3072
  s_waitcnt vmcnt(9) lgkmcnt(2)
  v_mfma_f32_32x32x16_bf16 v[32:47], v[20:23], v[168:171], v[32:47]
  ds_read_b128 v[16:19], v0 offset:4096
  buffer_load_dwordx4 v[200:203], v1, s[32:35], s54 offen offset:1024 sc1
  v_mfma_f32_32x32x16_bf16 v[48:63], v[24:27], v[168:171], v[48:63]
  ds_read_b128 v[20:23], v0 offset:8192
  s_waitcnt vmcnt(9) lgkmcnt(2)
  v_mfma_f32_32x32x16_bf16 v[32:47], v[28:31], v[172:175], v[32:47]
  ds_read_b128 v[24:27], v0 offset:5120
  buffer_load_dwordx4 v[204:207], v1, s[32:35], s54 offen offset:1536 sc1
  v_mfma_f32_32x32x16_bf16 v[48:63], v[84:87], v[172:175], v[48:63]
  ds_read_b128 v[28:31], v0 offset:9216
  s_waitcnt vmcnt(9) lgkmcnt(2)
  v_mfma_f32_32x32x16_bf16 v[32:47], v[16:19], v[176:179], v[32:47]
  ds_read_b128 v[84:87], v0 offset:6144
  buffer_load_dwordx4 v[208:211], v1, s[32:35], s54 offen offset:2048 sc1
  v_mfma_f32_32x32x16_bf16 v[48:63], v[20:23], v[176:179], v[48:63]
  ds_read_b128 v[16:19], v0 offset:10240
  s_add_u32 m0, s60, 57344
  s_add_u32 s61, s59, 159744
  buffer_load_dwordx4 v6, s[32:35], s61 offen lds
  s_waitcnt vmcnt(9)
  v_add_f32 v3, v64, v66
  s_waitcnt lgkmcnt(2)
  v_mfma_f32_32x32x16_bf16 v[32:47], v[24:27], v[180:183], v[32:47]
  ds_read_b128 v[20:23], v0 offset:7168
  buffer_load_dwordx4 v[212:215], v1, s[32:35], s54 offen offset:2560 sc1
  v_add_f32 v4, v65, v67
  s_waitcnt vmcnt(8)
  v_add_f32 v3, v3, v68
  v_mfma_f32_32x32x16_bf16 v[48:63], v[28:31], v[180:183], v[48:63]
  ds_read_b128 v[24:27], v0 offset:11264
  v_add_f32 v4, v4, v69
  v_add_f32 v3, v3, v70
  v_add_f32 v4, v4, v71
  v_mov_b32 v8, v3
  s_waitcnt lgkmcnt(2)
  v_mfma_f32_32x32x16_bf16 v[32:47], v[84:87], v[184:187], v[32:47]
  ds_read_b128 v[28:31], v0 offset:12288
  buffer_load_dwordx4 v[216:219], v1, s[32:35], s54 offen offset:3072 sc1
  v_mov_b32 v9, v4
  v_permlane32_swap_b32 v3, v8
  v_mfma_f32_32x32x16_bf16 v[48:63], v[16:19], v[184:187], v[48:63]
  ds_read_b128 v[84:87], v0 offset:16384
  s_add_u32 m0, s60, 61440
  s_add_u32 s61, s59, 98304
  buffer_load_dwordx4 v6, s[32:35], s61 offen lds
  v_permlane32_swap_b32 v4, v9
  s_waitcnt vmcnt(9) lgkmcnt(2)
  v_mfma_f32_32x32x16_bf16 v[32:47], v[20:23], v[188:191], v[32:47]
  ds_read_b128 v[16:19], v0 offset:13312
  buffer_load_dwordx4 v[220:223], v1, s[32:35], s54 offen offset:3584 sc1
  v_add_f32 v3, v3, v8
  v_add_f32 v4, v4, v9
  v_mfma_f32_32x32x16_bf16 v[48:63], v[24:27], v[188:191], v[48:63]
  ds_read_b128 v[20:23], v0 offset:17408
  v_mul_f32 v3, 0xbb000000, v3
  v_mul_f32 v4, 0x3b000000, v4
  v_fma_f32 v8, -v3, v3, v4
  v_max_f32 v8, 0, v8
  s_waitcnt vmcnt(9) lgkmcnt(2)
  v_mfma_f32_32x32x16_bf16 v[32:47], v[28:31], v[192:195], v[32:47]
  ds_read_b128 v[24:27], v0 offset:14336
  v_add_f32 v8, 0x3727c5ac, v8
  v_rsq_f32 v4, v8
  s_nop 0
  v_mfma_f32_32x32x16_bf16 v[48:63], v[84:87], v[192:195], v[48:63]
  ds_read_b128 v[28:31], v0 offset:18432
  s_add_u32 m0, s60, 65536
  s_add_u32 s61, s59, 102400
  buffer_load_dwordx4 v6, s[32:35], s61 offen lds
  v_mul_f32 v5, v8, v4
  s_waitcnt vmcnt(9) lgkmcnt(2)
  v_mfma_f32_32x32x16_bf16 v[32:47], v[16:19], v[196:199], v[32:47]
  ds_read_b128 v[84:87], v0 offset:15360
  v_mul_f32 v4, 0xbfb8aa3b, v4
  v_bfe_u32 v2, v2, 2, 7
  v_add_u32 v2, 162048, v2
  v_cvt_pk_bf16_f32 v12, v3, v3
  v_mfma_f32_32x32x16_bf16 v[48:63], v[20:23], v[196:199], v[48:63]
  ds_read_b128 v[16:19], v0 offset:19456
  v_lshlrev_b32 v8, 16, v12
  v_sub_f32 v8, v3, v8
  v_cvt_pk_bf16_f32 v8, v8, v8
  v_cndmask_b32 v12, v12, v8, s[52:53]
  s_waitcnt vmcnt(8) lgkmcnt(2)
  v_mfma_f32_32x32x16_bf16 v[32:47], v[24:27], v[200:203], v[32:47]
  ds_read_b128 v[20:23], v0 offset:20480
  ds_read_b32 v8, v2 offset:768
  v_mov_b32 v9, 0
  v_mov_b32 v10, 0
  v_mov_b32 v11, 0
  v_mfma_f32_32x32x16_bf16 v[48:63], v[28:31], v[200:203], v[48:63]
  ds_read_b128 v[24:27], v0 offset:24576
  s_add_u32 m0, s60, 69632
  s_add_u32 s61, s59, 106496
  buffer_load_dwordx4 v6, s[32:35], s61 offen lds
  v_mov_b32 v13, 0
  s_waitcnt vmcnt(8) lgkmcnt(3)
  v_mfma_f32_32x32x16_bf16 v[32:47], v[84:87], v[204:207], v[32:47]
  ds_read_b128 v[28:31], v0 offset:21504
  v_mov_b32 v14, 0
  v_mov_b32 v15, 0
  v_bfe_u32 v3, v1, 14, 1
  v_mul_u32_u24 v3, 40960, v3
  v_mfma_f32_32x32x16_bf16 v[48:63], v[16:19], v[204:207], v[48:63]
  ds_read_b128 v[84:87], v0 offset:25600
  v_add_u32 v1, v1, v3
  s_waitcnt vmcnt(7) lgkmcnt(2)
  v_mfma_f32_32x32x16_bf16 v[32:47], v[20:23], v[208:211], v[32:47]
  ds_read_b128 v[16:19], v0 offset:22528
  v_mfma_f32_32x32x16_bf16 v[48:63], v[24:27], v[208:211], v[48:63]
  ds_read_b128 v[20:23], v0 offset:26624
  s_add_u32 m0, s60, 73728
  s_add_u32 s61, s59, 110592
  buffer_load_dwordx4 v6, s[32:35], s61 offen lds
  s_waitcnt vmcnt(6) lgkmcnt(2)
  v_mfma_f32_32x32x16_bf16 v[32:47], v[28:31], v[212:215], v[32:47]
  ds_read_b128 v[24:27], v0 offset:23552
  v_mfma_f32_32x32x16_bf16 v[48:63], v[84:87], v[212:215], v[48:63]
  ds_read_b128 v[28:31], v0 offset:27648
  s_waitcnt vmcnt(5) lgkmcnt(2)
  v_mfma_f32_32x32x16_bf16 v[32:47], v[16:19], v[216:219], v[32:47]
  ds_read_b128 v[84:87], v0 offset:28672
  v_mfma_f32_32x32x16_bf16 v[48:63], v[20:23], v[216:219], v[48:63]
  ds_read_b128 v[16:19], v0 offset:29696
  s_add_u32 m0, s60, 77824
  s_add_u32 s61, s59, 114688
  buffer_load_dwordx4 v6, s[32:35], s61 offen lds
  s_waitcnt vmcnt(4) lgkmcnt(2)
  v_mfma_f32_32x32x16_bf16 v[32:47], v[24:27], v[220:223], v[32:47]
  v_mfma_f32_32x32x16_bf16 v[32:47], v[8:11], v[12:15], v[32:47]
  ds_read_b32 v8, v2 offset:640
  ds_read_b128 v[20:23], v0 offset:30720
  v_mfma_f32_32x32x16_bf16 v[48:63], v[28:31], v[220:223], v[48:63]
  s_waitcnt lgkmcnt(1)
  v_mfma_f32_32x32x16_bf16 v[48:63], v[8:11], v[12:15], v[48:63]
  ds_read_b32 v8, v2 offset:512
  ds_read_b128 v[24:27], v0 offset:31744
  v_mfma_f32_32x32x16_bf16 v[64:79], v[84:87], v[96:99], 0
  ds_read_b128 v[28:31], v0 offset:32768
  v_mfma_f32_32x32x16_bf16 v[64:79], v[16:19], v[100:103], v[64:79]
  ds_read_b128 v[84:87], v0 offset:33792
  s_add_u32 m0, s60, 81920
  s_add_u32 s61, s59, 118784
  buffer_load_dwordx4 v6, s[32:35], s61 offen lds
  s_waitcnt lgkmcnt(2)
  v_mfma_f32_32x32x16_bf16 v[64:79], v[20:23], v[104:107], v[64:79]
  ds_read_b128 v[16:19], v0 offset:34816
  v_mul_f32 v32, v4, v32
  v_mul_f32 v33, v4, v33
  v_mul_f32 v34, v4, v34
  v_mul_f32 v35, v4, v35
  v_mfma_f32_32x32x16_bf16 v[64:79], v[24:27], v[108:111], v[64:79]
  ds_read_b128 v[20:23], v0 offset:35840
  v_exp_f32 v32, v32
  v_exp_f32 v33, v33
  s_waitcnt lgkmcnt(2)
  v_mfma_f32_32x32x16_bf16 v[64:79], v[28:31], v[112:115], v[64:79]
  ds_read_b128 v[24:27], v0 offset:36864
  v_exp_f32 v34, v34
  v_exp_f32 v35, v35
  v_mfma_f32_32x32x16_bf16 v[64:79], v[84:87], v[116:119], v[64:79]
  ds_read_b128 v[28:31], v0 offset:37888
  s_add_u32 m0, s60, 86016
  s_add_u32 s61, s59, 122880
  buffer_load_dwordx4 v6, s[32:35], s61 offen lds
  v_fma_f32 v32, v32, v5, v5
  s_waitcnt lgkmcnt(2)
  v_mfma_f32_32x32x16_bf16 v[64:79], v[16:19], v[120:123], v[64:79]
  ds_read_b128 v[84:87], v0 offset:38912
  v_fma_f32 v33, v33, v5, v5
  v_fma_f32 v34, v34, v5, v5
  v_fma_f32 v35, v35, v5, v5
  v_mfma_f32_32x32x16_bf16 v[64:79], v[20:23], v[124:127], v[64:79]
  ds_read_b128 v[16:19], v0 offset:39936
  v_rcp_f32 v32, v32
  v_rcp_f32 v33, v33
  s_waitcnt lgkmcnt(2)
  v_mfma_f32_32x32x16_bf16 v[64:79], v[24:27], v[128:131], v[64:79]
  ds_read_b128 v[20:23], v0 offset:40960
  v_rcp_f32 v34, v34
  v_rcp_f32 v35, v35
  v_mfma_f32_32x32x16_bf16 v[64:79], v[28:31], v[132:135], v[64:79]
  ds_read_b128 v[24:27], v0 offset:41984
  s_add_u32 m0, s60, 90112
  s_add_u32 s61, s59, 126976
  buffer_load_dwordx4 v6, s[32:35], s61 offen lds
  v_mul_f32 v40, v40, v32
  s_waitcnt lgkmcnt(2)
  v_mfma_f32_32x32x16_bf16 v[64:79], v[84:87], v[136:139], v[64:79]
  ds_read_b128 v[28:31], v0 offset:43008
  v_mul_f32 v41, v41, v33
  v_mul_f32 v42, v42, v34
  v_mul_f32 v43, v43, v35
  v_mul_f32 v36, v4, v36
  v_mfma_f32_32x32x16_bf16 v[64:79], v[16:19], v[140:143], v[64:79]
  ds_read_b128 v[84:87], v0 offset:44032
  v_mul_f32 v37, v4, v37
  v_mul_f32 v38, v4, v38
  v_mul_f32 v39, v4, v39
  s_waitcnt lgkmcnt(2)
  v_mfma_f32_32x32x16_bf16 v[64:79], v[20:23], v[144:147], v[64:79]
  v_mfma_f32_32x32x16_bf16 v[64:79], v[8:11], v[12:15], v[64:79]
  ds_read_b32 v8, v2 offset:384
  ds_read_b128 v[16:19], v0 offset:45056
  v_exp_f32 v36, v36
  v_exp_f32 v37, v37
  v_mfma_f32_32x32x16_bf16 v[64:79], v[24:27], v[148:151], v[64:79]
  ds_read_b128 v[20:23], v0 offset:46080
  s_add_u32 m0, s60, 94208
  s_add_u32 s61, s59, 65536
  buffer_load_dwordx4 v6, s[32:35], s61 offen lds
  s_waitcnt lgkmcnt(3)
  v_mfma_f32_32x32x16_bf16 v[64:79], v[28:31], v[152:155], v[64:79]
  ds_read_b128 v[24:27], v0 offset:47104
  v_exp_f32 v38, v38
  v_exp_f32 v39, v39
  v_mfma_f32_32x32x16_bf16 v[64:79], v[84:87], v[156:159], v[64:79]
  ds_read_b128 v[28:31], v0 offset:48128
  v_fma_f32 v36, v36, v5, v5
  v_fma_f32 v37, v37, v5, v5
  v_fma_f32 v38, v38, v5, v5
  v_fma_f32 v39, v39, v5, v5
  s_waitcnt lgkmcnt(2)
  v_mfma_f32_32x32x16_bf16 v[64:79], v[16:19], v[160:163], v[64:79]
  ds_read_b128 v[84:87], v0 offset:49152
  v_rcp_f32 v36, v36
  v_rcp_f32 v37, v37
  v_mfma_f32_32x32x16_bf16 v[64:79], v[20:23], v[164:167], v[64:79]
  ds_read_b128 v[16:19], v0 offset:50176
  s_add_u32 m0, s60, 135168
  s_add_u32 s61, s59, 69632
  buffer_load_dwordx4 v6, s[32:35], s61 offen lds
  s_waitcnt lgkmcnt(2)
  v_mfma_f32_32x32x16_bf16 v[64:79], v[24:27], v[168:171], v[64:79]
  ds_read_b128 v[20:23], v0 offset:51200
  v_rcp_f32 v38, v38
  v_rcp_f32 v39, v39
  v_mfma_f32_32x32x16_bf16 v[64:79], v[28:31], v[172:175], v[64:79]
  ds_read_b128 v[24:27], v0 offset:52224
  v_mul_f32 v44, v44, v36
  v_mul_f32 v45, v45, v37
  v_mul_f32 v46, v46, v38
  v_mul_f32 v47, v47, v39
  s_waitcnt lgkmcnt(2)
  v_mfma_f32_32x32x16_bf16 v[64:79], v[84:87], v[176:179], v[64:79]
  ds_read_b128 v[28:31], v0 offset:53248
  v_cvt_pk_bf16_f32 v32, v40, v41
  v_cvt_pk_bf16_f32 v33, v42, v43
  v_cvt_pk_bf16_f32 v34, v44, v45
  v_cvt_pk_bf16_f32 v35, v46, v47
  v_mfma_f32_32x32x16_bf16 v[64:79], v[16:19], v[180:183], v[64:79]
  ds_read_b128 v[84:87], v0 offset:54272
  s_add_u32 m0, s60, 139264
  s_add_u32 s61, s59, 73728
  buffer_load_dwordx4 v6, s[32:35], s61 offen lds
  s_waitcnt lgkmcnt(2)
  v_mfma_f32_32x32x16_bf16 v[64:79], v[20:23], v[184:187], v[64:79]
  ds_read_b128 v[16:19], v0 offset:55296
  buffer_store_dwordx4 v[32:35], v1, s[32:35], s56 offen offset:3072
  v_mfma_f32_32x32x16_bf16 v[64:79], v[24:27], v[188:191], v[64:79]
  ds_read_b128 v[20:23], v0 offset:56320
  s_waitcnt lgkmcnt(2)
  v_mfma_f32_32x32x16_bf16 v[64:79], v[28:31], v[192:195], v[64:79]
  s_waitcnt vmcnt(9)
  s_barrier
  ds_read_b128 v[24:27], v0 offset:57344
  v_mfma_f32_32x32x16_bf16 v[64:79], v[84:87], v[196:199], v[64:79]
  ds_read_b128 v[28:31], v0 offset:58368
  s_add_u32 m0, s60, 143360
  s_add_u32 s61, s59, 77824
  buffer_load_dwordx4 v6, s[32:35], s61 offen lds
  v_mul_f32 v48, v4, v48
  s_waitcnt lgkmcnt(2)
  v_mfma_f32_32x32x16_bf16 v[64:79], v[16:19], v[200:203], v[64:79]
  ds_read_b128 v[84:87], v0 offset:59392
  v_mul_f32 v49, v4, v49
  v_mul_f32 v50, v4, v50
  v_mul_f32 v51, v4, v51
  v_mfma_f32_32x32x16_bf16 v[64:79], v[20:23], v[204:207], v[64:79]
  ds_read_b128 v[16:19], v0 offset:60416
  v_exp_f32 v48, v48
  v_exp_f32 v49, v49
  s_waitcnt lgkmcnt(2)
  v_mfma_f32_32x32x16_bf16 v[64:79], v[24:27], v[208:211], v[64:79]
  ds_read_b128 v[20:23], v0 offset:61440
  v_exp_f32 v50, v50
  v_exp_f32 v51, v51
  v_mfma_f32_32x32x16_bf16 v[64:79], v[28:31], v[212:215], v[64:79]
  ds_read_b128 v[24:27], v0 offset:62464
  s_add_u32 m0, s60, 147456
  s_add_u32 s61, s59, 81920
  buffer_load_dwordx4 v6, s[32:35], s61 offen lds
  v_fma_f32 v48, v48, v5, v5
  s_waitcnt lgkmcnt(2)
  v_mfma_f32_32x32x16_bf16 v[64:79], v[84:87], v[216:219], v[64:79]
  ds_read_b128 v[28:31], v0 offset:63488
  v_fma_f32 v49, v49, v5, v5
  v_fma_f32 v50, v50, v5, v5
  v_fma_f32 v51, v51, v5, v5
  v_mfma_f32_32x32x16_bf16 v[64:79], v[16:19], v[220:223], v[64:79]
  ds_read_b128 v[84:87], v0 offset:64512
  v_rcp_f32 v48, v48
  v_rcp_f32 v49, v49
  s_waitcnt lgkmcnt(2)
  v_mfma_f32_32x32x16_bf16 v[32:47], v[20:23], v[96:99], 0
  ds_read_b128 v[16:19], v7 offset:0
  v_rcp_f32 v50, v50
  v_rcp_f32 v51, v51
  v_mfma_f32_32x32x16_bf16 v[32:47], v[24:27], v[100:103], v[32:47]
  ds_read_b128 v[20:23], v7 offset:1024
  s_add_u32 m0, s60, 151552
  s_add_u32 s61, s59, 86016
  buffer_load_dwordx4 v6, s[32:35], s61 offen lds
  v_mul_f32 v56, v56, v48
  s_waitcnt lgkmcnt(2)
  v_mfma_f32_32x32x16_bf16 v[32:47], v[28:31], v[104:107], v[32:47]
  ds_read_b128 v[24:27], v7 offset:2048
  v_mul_f32 v57, v57, v49
  v_mul_f32 v58, v58, v50
  v_mul_f32 v59, v59, v51
  v_mul_f32 v52, v4, v52
  v_mfma_f32_32x32x16_bf16 v[32:47], v[84:87], v[108:111], v[32:47]
  ds_read_b128 v[28:31], v7 offset:3072
  v_mul_f32 v53, v4, v53
  v_mul_f32 v54, v4, v54
  v_mul_f32 v55, v4, v55
  s_waitcnt lgkmcnt(2)
  v_mfma_f32_32x32x16_bf16 v[32:47], v[16:19], v[112:115], v[32:47]
  ds_read_b128 v[84:87], v7 offset:4096
  v_exp_f32 v52, v52
  v_exp_f32 v53, v53
  v_mfma_f32_32x32x16_bf16 v[32:47], v[20:23], v[116:119], v[32:47]
  ds_read_b128 v[16:19], v7 offset:5120
  s_add_u32 m0, s60, 155648
  s_add_u32 s61, s59, 90112
  buffer_load_dwordx4 v6, s[32:35], s61 offen lds
  s_waitcnt lgkmcnt(2)
  v_mfma_f32_32x32x16_bf16 v[32:47], v[24:27], v[120:123], v[32:47]
  ds_read_b128 v[20:23], v7 offset:6144
  v_exp_f32 v54, v54
  v_exp_f32 v55, v55
  v_mfma_f32_32x32x16_bf16 v[32:47], v[28:31], v[124:127], v[32:47]
  ds_read_b128 v[24:27], v7 offset:7168
  v_fma_f32 v52, v52, v5, v5
  v_fma_f32 v53, v53, v5, v5
  v_fma_f32 v54, v54, v5, v5
  v_fma_f32 v55, v55, v5, v5
  s_waitcnt lgkmcnt(2)
  v_mfma_f32_32x32x16_bf16 v[32:47], v[84:87], v[128:131], v[32:47]
  s_waitcnt vmcnt(9)
  s_barrier
  ds_read_b128 v[28:31], v7 offset:8192
  v_rcp_f32 v52, v52
  v_rcp_f32 v53, v53
  v_mfma_f32_32x32x16_bf16 v[32:47], v[16:19], v[132:135], v[32:47]
  ds_read_b128 v[84:87], v7 offset:9216
  s_add_u32 m0, s60, 98304
  s_add_u32 s61, s59, 94208
  buffer_load_dwordx4 v6, s[32:35], s61 offen lds
  s_waitcnt lgkmcnt(2)
  v_mfma_f32_32x32x16_bf16 v[32:47], v[20:23], v[136:139], v[32:47]
  ds_read_b128 v[16:19], v7 offset:10240
  v_rcp_f32 v54, v54
  v_rcp_f32 v55, v55
  v_mfma_f32_32x32x16_bf16 v[32:47], v[24:27], v[140:143], v[32:47]
  ds_read_b128 v[20:23], v7 offset:11264
  v_mul_f32 v60, v60, v52
  v_mul_f32 v61, v61, v53
  v_mul_f32 v62, v62, v54
  v_mul_f32 v63, v63, v55
  s_waitcnt lgkmcnt(2)
  v_mfma_f32_32x32x16_bf16 v[32:47], v[28:31], v[144:147], v[32:47]
  v_mfma_f32_32x32x16_bf16 v[32:47], v[8:11], v[12:15], v[32:47]
  ds_read_b32 v8, v2 offset:256
  ds_read_b128 v[24:27], v7 offset:12288
  v_cvt_pk_bf16_f32 v48, v56, v57
  v_cvt_pk_bf16_f32 v49, v58, v59
  v_cvt_pk_bf16_f32 v50, v60, v61
  v_cvt_pk_bf16_f32 v51, v62, v63
  v_mfma_f32_32x32x16_bf16 v[32:47], v[84:87], v[148:151], v[32:47]
  ds_read_b128 v[28:31], v7 offset:13312
  s_add_u32 m0, s60, 102400
  s_add_u32 s61, s59, 32768
  buffer_load_dwordx4 v6, s[32:35], s61 offen lds
  s_waitcnt lgkmcnt(3)
  v_mfma_f32_32x32x16_bf16 v[32:47], v[16:19], v[152:155], v[32:47]
  ds_read_b128 v[84:87], v7 offset:14336
  buffer_store_dwordx4 v[48:51], v1, s[32:35], s56 offen offset:2560
  v_mfma_f32_32x32x16_bf16 v[32:47], v[20:23], v[156:159], v[32:47]
  ds_read_b128 v[16:19], v7 offset:15360
  s_waitcnt lgkmcnt(2)
  v_mfma_f32_32x32x16_bf16 v[32:47], v[24:27], v[160:163], v[32:47]
  ds_read_b128 v[20:23], v7 offset:16384
  v_mfma_f32_32x32x16_bf16 v[32:47], v[28:31], v[164:167], v[32:47]
  ds_read_b128 v[24:27], v7 offset:17408
  s_add_u32 m0, s60, 106496
  s_add_u32 s61, s59, 36864
  buffer_load_dwordx4 v6, s[32:35], s61 offen lds
  v_mul_f32 v64, v4, v64
  s_waitcnt lgkmcnt(2)
  v_mfma_f32_32x32x16_bf16 v[32:47], v[84:87], v[168:171], v[32:47]
  ds_read_b128 v[28:31], v7 offset:18432
  v_mul_f32 v65, v4, v65
  v_mul_f32 v66, v4, v66
  v_mul_f32 v67, v4, v67
  v_mfma_f32_32x32x16_bf16 v[32:47], v[16:19], v[172:175], v[32:47]
  ds_read_b128 v[84:87], v7 offset:19456
  v_exp_f32 v64, v64
  v_exp_f32 v65, v65
  s_waitcnt lgkmcnt(2)
  v_mfma_f32_32x32x16_bf16 v[32:47], v[20:23], v[176:179], v[32:47]
  ds_read_b128 v[16:19], v7 offset:20480
  v_exp_f32 v66, v66
  v_exp_f32 v67, v67
  v_mfma_f32_32x32x16_bf16 v[32:47], v[24:27], v[180:183], v[32:47]
  ds_read_b128 v[20:23], v7 offset:21504
  s_add_u32 m0, s60, 110592
  s_add_u32 s61, s59, 40960
  buffer_load_dwordx4 v6, s[32:35], s61 offen lds
  v_fma_f32 v64, v64, v5, v5
  s_waitcnt lgkmcnt(2)
  v_mfma_f32_32x32x16_bf16 v[32:47], v[28:31], v[184:187], v[32:47]
  ds_read_b128 v[24:27], v7 offset:22528
  v_fma_f32 v65, v65, v5, v5
  v_fma_f32 v66, v66, v5, v5
  v_fma_f32 v67, v67, v5, v5
  v_mfma_f32_32x32x16_bf16 v[32:47], v[84:87], v[188:191], v[32:47]
  ds_read_b128 v[28:31], v7 offset:23552
  v_rcp_f32 v64, v64
  v_rcp_f32 v65, v65
  s_waitcnt lgkmcnt(2)
  v_mfma_f32_32x32x16_bf16 v[32:47], v[16:19], v[192:195], v[32:47]
  s_waitcnt vmcnt(10)
  s_barrier
  ds_read_b128 v[84:87], v7 offset:24576
  v_rcp_f32 v66, v66
  v_rcp_f32 v67, v67
  v_mfma_f32_32x32x16_bf16 v[32:47], v[20:23], v[196:199], v[32:47]
  ds_read_b128 v[16:19], v7 offset:25600
  s_add_u32 m0, s60, 114688
  s_add_u32 s61, s59, 45056
  buffer_load_dwordx4 v6, s[32:35], s61 offen lds
  v_mul_f32 v72, v72, v64
  s_waitcnt lgkmcnt(2)
  v_mfma_f32_32x32x16_bf16 v[32:47], v[24:27], v[200:203], v[32:47]
  ds_read_b128 v[20:23], v7 offset:26624
  v_mul_f32 v73, v73, v65
  v_mul_f32 v74, v74, v66
  v_mul_f32 v75, v75, v67
  v_mul_f32 v68, v4, v68
  v_mfma_f32_32x32x16_bf16 v[32:47], v[28:31], v[204:207], v[32:47]
  ds_read_b128 v[24:27], v7 offset:27648
  v_mul_f32 v69, v4, v69
  v_mul_f32 v70, v4, v70
  v_mul_f32 v71, v4, v71
  s_waitcnt lgkmcnt(2)
  v_mfma_f32_32x32x16_bf16 v[32:47], v[84:87], v[208:211], v[32:47]
  ds_read_b128 v[28:31], v7 offset:28672
  v_exp_f32 v68, v68
  v_exp_f32 v69, v69
  v_mfma_f32_32x32x16_bf16 v[32:47], v[16:19], v[212:215], v[32:47]
  ds_read_b128 v[84:87], v7 offset:29696
  s_add_u32 m0, s60, 118784
  s_add_u32 s61, s59, 49152
  buffer_load_dwordx4 v6, s[32:35], s61 offen lds
  s_waitcnt lgkmcnt(2)
  v_mfma_f32_32x32x16_bf16 v[32:47], v[20:23], v[216:219], v[32:47]
  ds_read_b128 v[16:19], v7 offset:30720
  v_exp_f32 v70, v70
  v_exp_f32 v71, v71
  v_mfma_f32_32x32x16_bf16 v[32:47], v[24:27], v[220:223], v[32:47]
  ds_read_b128 v[20:23], v7 offset:31744
  v_fma_f32 v68, v68, v5, v5
  v_fma_f32 v69, v69, v5, v5
  v_fma_f32 v70, v70, v5, v5
  v_fma_f32 v71, v71, v5, v5
  s_waitcnt lgkmcnt(2)
  v_mfma_f32_32x32x16_bf16 v[48:63], v[28:31], v[96:99], 0
  ds_read_b128 v[24:27], v6 offset:36864
  v_rcp_f32 v68, v68
  v_rcp_f32 v69, v69
  v_mfma_f32_32x32x16_bf16 v[48:63], v[84:87], v[100:103], v[48:63]
  ds_read_b128 v[28:31], v6 offset:37888
  s_add_u32 m0, s60, 122880
  s_add_u32 s61, s59, 53248
  buffer_load_dwordx4 v6, s[32:35], s61 offen lds
  s_waitcnt lgkmcnt(2)
  v_mfma_f32_32x32x16_bf16 v[48:63], v[16:19], v[104:107], v[48:63]
  ds_read_b128 v[84:87], v6 offset:38912
  v_rcp_f32 v70, v70
  v_rcp_f32 v71, v71
  v_mfma_f32_32x32x16_bf16 v[48:63], v[20:23], v[108:111], v[48:63]
  ds_read_b128 v[16:19], v6 offset:39936
  v_mul_f32 v76, v76, v68
  v_mul_f32 v77, v77, v69
  v_mul_f32 v78, v78, v70
  v_mul_f32 v79, v79, v71
  s_waitcnt lgkmcnt(2)
  v_mfma_f32_32x32x16_bf16 v[48:63], v[24:27], v[112:115], v[48:63]
  ds_read_b128 v[20:23], v6 offset:40960
  v_cvt_pk_bf16_f32 v64, v72, v73
  v_cvt_pk_bf16_f32 v65, v74, v75
  v_cvt_pk_bf16_f32 v66, v76, v77
  v_cvt_pk_bf16_f32 v67, v78, v79
  v_mfma_f32_32x32x16_bf16 v[48:63], v[28:31], v[116:119], v[48:63]
  ds_read_b128 v[24:27], v6 offset:41984
  s_add_u32 m0, s60, 126976
  s_add_u32 s61, s59, 57344
  buffer_load_dwordx4 v6, s[32:35], s61 offen lds
  s_waitcnt lgkmcnt(2)
  v_mfma_f32_32x32x16_bf16 v[48:63], v[84:87], v[120:123], v[48:63]
  ds_read_b128 v[28:31], v6 offset:43008
  buffer_store_dwordx4 v[64:67], v1, s[32:35], s56 offen offset:2048
  v_mfma_f32_32x32x16_bf16 v[48:63], v[16:19], v[124:127], v[48:63]
  ds_read_b128 v[84:87], v6 offset:44032
  s_waitcnt lgkmcnt(2)
  v_mfma_f32_32x32x16_bf16 v[48:63], v[20:23], v[128:131], v[48:63]
  s_waitcnt vmcnt(10)
  s_barrier
  ds_read_b128 v[16:19], v6 offset:45056
  v_mfma_f32_32x32x16_bf16 v[48:63], v[24:27], v[132:135], v[48:63]
  ds_read_b128 v[20:23], v6 offset:46080
  s_add_u32 m0, s60, 131072
  s_add_u32 s61, s59, 61440
  buffer_load_dwordx4 v6, s[32:35], s61 offen lds
  v_mul_f32 v32, v4, v32
  s_waitcnt lgkmcnt(2)
  v_mfma_f32_32x32x16_bf16 v[48:63], v[28:31], v[136:139], v[48:63]
  ds_read_b128 v[24:27], v6 offset:47104
  v_mul_f32 v33, v4, v33
  v_mul_f32 v34, v4, v34
  v_mul_f32 v35, v4, v35
  v_mfma_f32_32x32x16_bf16 v[48:63], v[84:87], v[140:143], v[48:63]
  ds_read_b128 v[28:31], v6 offset:48128
  v_exp_f32 v32, v32
  v_exp_f32 v33, v33
  s_waitcnt lgkmcnt(2)
  v_mfma_f32_32x32x16_bf16 v[48:63], v[16:19], v[144:147], v[48:63]
  v_mfma_f32_32x32x16_bf16 v[48:63], v[8:11], v[12:15], v[48:63]
  ds_read_b32 v8, v2 offset:128
  ds_read_b128 v[84:87], v6 offset:49152
  v_exp_f32 v34, v34
  v_exp_f32 v35, v35
  v_mfma_f32_32x32x16_bf16 v[48:63], v[20:23], v[148:151], v[48:63]
  ds_read_b128 v[16:19], v6 offset:50176
  s_add_u32 m0, s60, 0
  s_add_u32 s61, s59, 0
  buffer_load_dwordx4 v6, s[32:35], s61 offen lds
  v_fma_f32 v32, v32, v5, v5
  s_waitcnt lgkmcnt(3)
  v_mfma_f32_32x32x16_bf16 v[48:63], v[24:27], v[152:155], v[48:63]
  ds_read_b128 v[20:23], v6 offset:51200
  v_fma_f32 v33, v33, v5, v5
  v_fma_f32 v34, v34, v5, v5
  v_fma_f32 v35, v35, v5, v5
  v_mfma_f32_32x32x16_bf16 v[48:63], v[28:31], v[156:159], v[48:63]
  ds_read_b128 v[24:27], v6 offset:52224
  v_rcp_f32 v32, v32
  v_rcp_f32 v33, v33
  s_waitcnt lgkmcnt(2)
  v_mfma_f32_32x32x16_bf16 v[48:63], v[84:87], v[160:163], v[48:63]
  ds_read_b128 v[28:31], v6 offset:53248
  v_rcp_f32 v34, v34
  v_rcp_f32 v35, v35
  v_mfma_f32_32x32x16_bf16 v[48:63], v[16:19], v[164:167], v[48:63]
  ds_read_b128 v[84:87], v6 offset:54272
  s_add_u32 m0, s60, 4096
  s_add_u32 s61, s59, 4096
  buffer_load_dwordx4 v6, s[32:35], s61 offen lds
  v_mul_f32 v40, v40, v32
  s_waitcnt lgkmcnt(2)
  v_mfma_f32_32x32x16_bf16 v[48:63], v[20:23], v[168:171], v[48:63]
  ds_read_b128 v[16:19], v6 offset:55296
  v_mul_f32 v41, v41, v33
  v_mul_f32 v42, v42, v34
  v_mul_f32 v43, v43, v35
  v_mul_f32 v36, v4, v36
  v_mfma_f32_32x32x16_bf16 v[48:63], v[24:27], v[172:175], v[48:63]
  ds_read_b128 v[20:23], v6 offset:56320
  v_mul_f32 v37, v4, v37
  v_mul_f32 v38, v4, v38
  v_mul_f32 v39, v4, v39
  s_waitcnt lgkmcnt(2)
  v_mfma_f32_32x32x16_bf16 v[48:63], v[28:31], v[176:179], v[48:63]
  ds_read_b128 v[24:27], v6 offset:57344
  v_exp_f32 v36, v36
  v_exp_f32 v37, v37
  v_mfma_f32_32x32x16_bf16 v[48:63], v[84:87], v[180:183], v[48:63]
  ds_read_b128 v[28:31], v6 offset:58368
  s_add_u32 m0, s60, 8192
  s_add_u32 s61, s59, 8192
  buffer_load_dwordx4 v6, s[32:35], s61 offen lds
  s_waitcnt lgkmcnt(2)
  v_mfma_f32_32x32x16_bf16 v[48:63], v[16:19], v[184:187], v[48:63]
  ds_read_b128 v[84:87], v6 offset:59392
  v_exp_f32 v38, v38
  v_exp_f32 v39, v39
  v_mfma_f32_32x32x16_bf16 v[48:63], v[20:23], v[188:191], v[48:63]
  ds_read_b128 v[16:19], v6 offset:60416
  v_fma_f32 v36, v36, v5, v5
  v_fma_f32 v37, v37, v5, v5
  v_fma_f32 v38, v38, v5, v5
  v_fma_f32 v39, v39, v5, v5
  s_waitcnt lgkmcnt(2)
  v_mfma_f32_32x32x16_bf16 v[48:63], v[24:27], v[192:195], v[48:63]
  s_waitcnt vmcnt(9)
  s_barrier
  ds_read_b128 v[20:23], v6 offset:0
  v_rcp_f32 v36, v36
  v_rcp_f32 v37, v37
  v_mfma_f32_32x32x16_bf16 v[48:63], v[28:31], v[196:199], v[48:63]
  ds_read_b128 v[24:27], v6 offset:1024
  s_add_u32 m0, s60, 12288
  s_add_u32 s61, s59, 12288
  buffer_load_dwordx4 v6, s[32:35], s61 offen lds
  s_waitcnt lgkmcnt(2)
  v_mfma_f32_32x32x16_bf16 v[48:63], v[84:87], v[200:203], v[48:63]
  ds_read_b128 v[28:31], v6 offset:2048
  v_rcp_f32 v38, v38
  v_rcp_f32 v39, v39
  v_mfma_f32_32x32x16_bf16 v[48:63], v[16:19], v[204:207], v[48:63]
  ds_read_b128 v[84:87], v6 offset:3072
  v_mul_f32 v44, v44, v36
  v_mul_f32 v45, v45, v37
  v_mul_f32 v46, v46, v38
  v_mul_f32 v47, v47, v39
  s_waitcnt lgkmcnt(2)
  v_mfma_f32_32x32x16_bf16 v[48:63], v[20:23], v[208:211], v[48:63]
  ds_read_b128 v[16:19], v6 offset:4096
  v_cvt_pk_bf16_f32 v32, v40, v41
  v_cvt_pk_bf16_f32 v33, v42, v43
  v_cvt_pk_bf16_f32 v34, v44, v45
  v_cvt_pk_bf16_f32 v35, v46, v47
  v_mfma_f32_32x32x16_bf16 v[48:63], v[24:27], v[212:215], v[48:63]
  ds_read_b128 v[20:23], v6 offset:5120
  s_add_u32 m0, s60, 16384
  s_add_u32 s61, s59, 16384
  buffer_load_dwordx4 v6, s[32:35], s61 offen lds
  s_waitcnt lgkmcnt(2)
  v_mfma_f32_32x32x16_bf16 v[48:63], v[28:31], v[216:219], v[48:63]
  ds_read_b128 v[24:27], v6 offset:6144
  buffer_store_dwordx4 v[32:35], v1, s[32:35], s56 offen offset:1536
  v_mfma_f32_32x32x16_bf16 v[48:63], v[84:87], v[220:223], v[48:63]
  ds_read_b128 v[28:31], v6 offset:7168
  s_waitcnt lgkmcnt(2)
  v_mfma_f32_32x32x16_bf16 v[64:79], v[16:19], v[96:99], 0
  ds_read_b128 v[84:87], v6 offset:8192
  v_mfma_f32_32x32x16_bf16 v[64:79], v[20:23], v[100:103], v[64:79]
  ds_read_b128 v[16:19], v6 offset:9216
  s_add_u32 m0, s60, 20480
  s_add_u32 s61, s59, 20480
  buffer_load_dwordx4 v6, s[32:35], s61 offen lds
  s_waitcnt lgkmcnt(2)
  v_mfma_f32_32x32x16_bf16 v[64:79], v[24:27], v[104:107], v[64:79]
  ds_read_b128 v[20:23], v6 offset:10240
  v_mfma_f32_32x32x16_bf16 v[64:79], v[28:31], v[108:111], v[64:79]
  ds_read_b128 v[24:27], v6 offset:11264
  v_mul_f32 v48, v4, v48
  v_mul_f32 v49, v4, v49
  v_mul_f32 v50, v4, v50
  v_mul_f32 v51, v4, v51
  s_waitcnt lgkmcnt(2)
  v_mfma_f32_32x32x16_bf16 v[64:79], v[84:87], v[112:115], v[64:79]
  ds_read_b128 v[28:31], v6 offset:12288
  v_exp_f32 v48, v48
  v_exp_f32 v49, v49
  v_mfma_f32_32x32x16_bf16 v[64:79], v[16:19], v[116:119], v[64:79]
  ds_read_b128 v[84:87], v6 offset:13312
  s_add_u32 m0, s60, 24576
  s_add_u32 s61, s59, 24576
  buffer_load_dwordx4 v6, s[32:35], s61 offen lds
  s_waitcnt lgkmcnt(2)
  v_mfma_f32_32x32x16_bf16 v[64:79], v[20:23], v[120:123], v[64:79]
  ds_read_b128 v[16:19], v6 offset:14336
  v_exp_f32 v50, v50
  v_exp_f32 v51, v51
  v_mfma_f32_32x32x16_bf16 v[64:79], v[24:27], v[124:127], v[64:79]
  ds_read_b128 v[20:23], v6 offset:15360
  v_fma_f32 v48, v48, v5, v5
  v_fma_f32 v49, v49, v5, v5
  v_fma_f32 v50, v50, v5, v5
  v_fma_f32 v51, v51, v5, v5
  s_waitcnt lgkmcnt(2)
  v_mfma_f32_32x32x16_bf16 v[64:79], v[28:31], v[128:131], v[64:79]
  s_waitcnt vmcnt(10)
  s_barrier
  ds_read_b128 v[24:27], v6 offset:16384
  v_rcp_f32 v48, v48
  v_rcp_f32 v49, v49
  v_mfma_f32_32x32x16_bf16 v[64:79], v[84:87], v[132:135], v[64:79]
  ds_read_b128 v[28:31], v6 offset:17408
  s_add_u32 m0, s60, 28672
  s_add_u32 s61, s59, 28672
  buffer_load_dwordx4 v6, s[32:35], s61 offen lds
  s_waitcnt lgkmcnt(2)
  v_mfma_f32_32x32x16_bf16 v[64:79], v[16:19], v[136:139], v[64:79]
  ds_read_b128 v[84:87], v6 offset:18432
  v_rcp_f32 v50, v50
  v_rcp_f32 v51, v51
  v_mfma_f32_32x32x16_bf16 v[64:79], v[20:23], v[140:143], v[64:79]
  ds_read_b128 v[16:19], v6 offset:19456
  v_mul_f32 v56, v56, v48
  v_mul_f32 v57, v57, v49
  v_mul_f32 v58, v58, v50
  v_mul_f32 v59, v59, v51
  s_waitcnt lgkmcnt(2)
  v_mfma_f32_32x32x16_bf16 v[64:79], v[24:27], v[144:147], v[64:79]
  v_mfma_f32_32x32x16_bf16 v[64:79], v[8:11], v[12:15], v[64:79]
  ds_read_b32 v8, v2 offset:0
  ds_read_b128 v[20:23], v6 offset:20480
  v_mul_f32 v52, v4, v52
  v_mul_f32 v53, v4, v53
  v_mul_f32 v54, v4, v54
  v_mul_f32 v55, v4, v55
  s_add_u32 s69, s36, 10
  v_mov_b32 v82, s69
  v_mov_b32 v83, s37
  s_mov_b64 exec, 1
  s_cmp_lg_u32 s38, 0
  s_waitcnt vmcnt(3)
  s_cbranch_scc1 L_slow_76
  buffer_store_dwordx2 v[82:83], off, s[32:35], s51
L_sigd_77:
  s_mov_b64 exec, -1
  v_mfma_f32_32x32x16_bf16 v[64:79], v[28:31], v[148:151], v[64:79]
  ds_read_b128 v[24:27], v6 offset:21504
  v_exp_f32 v52, v52
  v_exp_f32 v53, v53
  s_waitcnt lgkmcnt(3)
  v_mfma_f32_32x32x16_bf16 v[64:79], v[84:87], v[152:155], v[64:79]
  ds_read_b128 v[28:31], v6 offset:22528
  v_exp_f32 v54, v54
  v_exp_f32 v55, v55
  v_mfma_f32_32x32x16_bf16 v[64:79], v[16:19], v[156:159], v[64:79]
  ds_read_b128 v[84:87], v6 offset:23552
  v_fma_f32 v52, v52, v5, v5
  v_fma_f32 v53, v53, v5, v5
  v_fma_f32 v54, v54, v5, v5
  v_fma_f32 v55, v55, v5, v5
  s_waitcnt lgkmcnt(2)
  v_mfma_f32_32x32x16_bf16 v[64:79], v[20:23], v[160:163], v[64:79]
  ds_read_b128 v[16:19], v6 offset:24576
  v_rcp_f32 v52, v52
  v_rcp_f32 v53, v53
  v_mfma_f32_32x32x16_bf16 v[64:79], v[24:27], v[164:167], v[64:79]
  ds_read_b128 v[20:23], v6 offset:25600
  v_rcp_f32 v54, v54
  v_rcp_f32 v55, v55
  s_waitcnt lgkmcnt(2)
  v_mfma_f32_32x32x16_bf16 v[64:79], v[28:31], v[168:171], v[64:79]
  ds_read_b128 v[24:27], v6 offset:26624
  v_mul_f32 v60, v60, v52
  v_mul_f32 v61, v61, v53
  v_mul_f32 v62, v62, v54
  v_mul_f32 v63, v63, v55
  v_mfma_f32_32x32x16_bf16 v[64:79], v[84:87], v[172:175], v[64:79]
  ds_read_b128 v[28:31], v6 offset:27648
  v_cvt_pk_bf16_f32 v48, v56, v57
  v_cvt_pk_bf16_f32 v49, v58, v59
  v_cvt_pk_bf16_f32 v50, v60, v61
  v_cvt_pk_bf16_f32 v51, v62, v63
  s_waitcnt lgkmcnt(2)
  v_mfma_f32_32x32x16_bf16 v[64:79], v[16:19], v[176:179], v[64:79]
  ds_read_b128 v[84:87], v6 offset:28672
  buffer_store_dwordx4 v[48:51], v1, s[32:35], s56 offen offset:1024
  v_mfma_f32_32x32x16_bf16 v[64:79], v[20:23], v[180:183], v[64:79]
  ds_read_b128 v[16:19], v6 offset:29696
  s_waitcnt lgkmcnt(2)
  v_mfma_f32_32x32x16_bf16 v[64:79], v[24:27], v[184:187], v[64:79]
  ds_read_b128 v[20:23], v6 offset:30720
  v_mfma_f32_32x32x16_bf16 v[64:79], v[28:31], v[188:191], v[64:79]
  ds_read_b128 v[24:27], v6 offset:31744
  s_waitcnt lgkmcnt(2)
  v_mfma_f32_32x32x16_bf16 v[64:79], v[84:87], v[192:195], v[64:79]
  s_barrier
  ds_read_b128 v[28:31], v6 offset:32768
  v_subrev_u32 v81, 98304, v6
  v_lshrrev_b32 v81, 1, v81
  buffer_load_dwordx2 v[82:83], v81, s[32:35], s50 offen offset:0 sc1
  s_mul_i32 s63, s40, 458752
  s_mul_i32 s67, s42, 229376
  s_add_u32 s63, s63, s67
  s_mul_i32 s67, s39, 14336
  s_add_u32 s63, s63, s67
  s_add_u32 s63, s63, 20971520
  v_mfma_f32_32x32x16_bf16 v[64:79], v[16:19], v[196:199], v[64:79]
  ds_read_b128 v[84:87], v6 offset:33792
  s_waitcnt lgkmcnt(2)
  v_mfma_f32_32x32x16_bf16 v[64:79], v[20:23], v[200:203], v[64:79]
  ds_read_b128 v[16:19], v6 offset:34816
  v_mfma_f32_32x32x16_bf16 v[64:79], v[24:27], v[204:207], v[64:79]
  ds_read_b128 v[20:23], v6 offset:35840
  s_waitcnt lgkmcnt(2)
  v_mfma_f32_32x32x16_bf16 v[64:79], v[28:31], v[208:211], v[64:79]
  ds_read_b128 v[24:27], v0 offset:0
  v_mfma_f32_32x32x16_bf16 v[64:79], v[84:87], v[212:215], v[64:79]
  ds_read_b128 v[28:31], v0 offset:1024
  s_waitcnt lgkmcnt(2)
  v_mfma_f32_32x32x16_bf16 v[64:79], v[16:19], v[216:219], v[64:79]
  ds_read_b128 v[84:87], v0 offset:2048
  v_mfma_f32_32x32x16_bf16 v[64:79], v[20:23], v[220:223], v[64:79]
  ds_read_b128 v[16:19], v0 offset:3072
  s_waitcnt lgkmcnt(2)
  v_mfma_f32_32x32x16_bf16 v[32:47], v[24:27], v[96:99], 0
  ds_read_b128 v[20:23], v0 offset:4096
  v_mfma_f32_32x32x16_bf16 v[32:47], v[28:31], v[100:103], v[32:47]
  ds_read_b128 v[24:27], v0 offset:5120
  s_waitcnt lgkmcnt(2)
  v_mfma_f32_32x32x16_bf16 v[32:47], v[84:87], v[104:107], v[32:47]
  ds_read_b128 v[28:31], v0 offset:6144
  v_mfma_f32_32x32x16_bf16 v[32:47], v[16:19], v[108:111], v[32:47]
  ds_read_b128 v[84:87], v0 offset:7168
  s_nop 0
  v_mul_f32 v64, v4, v64
  v_mul_f32 v65, v4, v65
  v_mul_f32 v66, v4, v66
  v_mul_f32 v67, v4, v67
  s_waitcnt lgkmcnt(2)
  v_mfma_f32_32x32x16_bf16 v[32:47], v[20:23], v[112:115], v[32:47]
  ds_read_b128 v[16:19], v0 offset:8192
  v_exp_f32 v64, v64
  v_exp_f32 v65, v65
  s_mov_b32 s69, 0
  s_waitcnt vmcnt(0)
L_chk_79:
  v_subrev_u32 v82, s36, v82
  v_xor_b32 v83, s37, v83
  v_subrev_u32 v82, 10, v82
  v_cmp_lt_u64 vcc, 31, v[82:83]
  s_nop 0
  s_and_b64 vcc, vcc, s[48:49]
  s_cbranch_scc1 L_poll_78
  s_cmp_lg_u32 s38, 0
  s_cbranch_scc1 L_inv_81
L_polld_80:
  v_mfma_f32_32x32x16_bf16 v[32:47], v[24:27], v[116:119], v[32:47]
  ds_read_b128 v[20:23], v0 offset:9216
  v_exp_f32 v66, v66
  v_exp_f32 v67, v67
  s_add_u32 s64, s63, 0
  buffer_load_dwordx4 v[96:99], v1, s[32:35], s64 offen offset:1536 sc1
  s_waitcnt lgkmcnt(2)
  v_mfma_f32_32x32x16_bf16 v[32:47], v[28:31], v[120:123], v[32:47]
  ds_read_b128 v[24:27], v0 offset:10240
  v_fma_f32 v64, v64, v5, v5
  v_fma_f32 v65, v65, v5, v5
  v_fma_f32 v66, v66, v5, v5
  v_fma_f32 v67, v67, v5, v5
  v_mfma_f32_32x32x16_bf16 v[32:47], v[84:87], v[124:127], v[32:47]
  ds_read_b128 v[28:31], v0 offset:11264
  v_rcp_f32 v64, v64
  v_rcp_f32 v65, v65
  buffer_load_dwordx4 v[100:103], v1, s[32:35], s64 offen offset:2048 sc1
  s_waitcnt lgkmcnt(2)
  v_mfma_f32_32x32x16_bf16 v[32:47], v[16:19], v[128:131], v[32:47]
  s_barrier
  ds_read_b128 v[84:87], v0 offset:12288
  v_rcp_f32 v66, v66
  v_rcp_f32 v67, v67
  v_mfma_f32_32x32x16_bf16 v[32:47], v[20:23], v[132:135], v[32:47]
  ds_read_b128 v[16:19], v0 offset:13312
  v_mul_f32 v72, v72, v64
  v_mul_f32 v73, v73, v65
  v_mul_f32 v74, v74, v66
  v_mul_f32 v75, v75, v67
  buffer_load_dwordx4 v[104:107], v1, s[32:35], s64 offen offset:2560 sc1
  s_waitcnt lgkmcnt(2)
  v_mfma_f32_32x32x16_bf16 v[32:47], v[24:27], v[136:139], v[32:47]
  ds_read_b128 v[20:23], v0 offset:14336
  v_mul_f32 v68, v4, v68
  v_mul_f32 v69, v4, v69
  v_mul_f32 v70, v4, v70
  v_mul_f32 v71, v4, v71
  v_mfma_f32_32x32x16_bf16 v[32:47], v[28:31], v[140:143], v[32:47]
  ds_read_b128 v[24:27], v0 offset:15360
  v_exp_f32 v68, v68
  v_exp_f32 v69, v69
  buffer_load_dwordx4 v[108:111], v1, s[32:35], s64 offen offset:3072 sc1
  s_waitcnt lgkmcnt(2)
  v_mfma_f32_32x32x16_bf16 v[32:47], v[84:87], v[144:147], v[32:47]
  v_mfma_f32_32x32x16_bf16 v[32:47], v[8:11], v[12:15], v[32:47]
  ds_read_b128 v[28:31], v0 offset:16384
  v_exp_f32 v70, v70
  v_exp_f32 v71, v71
  v_mfma_f32_32x32x16_bf16 v[32:47], v[16:19], v[148:151], v[32:47]
  ds_read_b128 v[84:87], v0 offset:17408
  v_fma_f32 v68, v68, v5, v5
  v_fma_f32 v69, v69, v5, v5
  v_fma_f32 v70, v70, v5, v5
  v_fma_f32 v71, v71, v5, v5
  s_add_u32 s64, s63, 4096
  buffer_load_dwordx4 v[112:115], v1, s[32:35], s64 offen offset:1024 sc1
  s_waitcnt lgkmcnt(2)
  v_mfma_f32_32x32x16_bf16 v[32:47], v[20:23], v[152:155], v[32:47]
  ds_read_b128 v[16:19], v0 offset:18432
  v_rcp_f32 v68, v68
  v_rcp_f32 v69, v69
  v_mfma_f32_32x32x16_bf16 v[32:47], v[24:27], v[156:159], v[32:47]
  ds_read_b128 v[20:23], v0 offset:19456
  v_rcp_f32 v70, v70
  v_rcp_f32 v71, v71
  buffer_load_dwordx4 v[116:119], v1, s[32:35], s64 offen offset:1536 sc1
  s_waitcnt lgkmcnt(2)
  v_mfma_f32_32x32x16_bf16 v[32:47], v[28:31], v[160:163], v[32:47]
  ds_read_b128 v[24:27], v0 offset:20480
  v_mul_f32 v76, v76, v68
  v_mul_f32 v77, v77, v69
  v_mul_f32 v78, v78, v70
  v_mul_f32 v79, v79, v71
  v_mfma_f32_32x32x16_bf16 v[32:47], v[84:87], v[164:167], v[32:47]
  ds_read_b128 v[28:31], v0 offset:21504
  v_cvt_pk_bf16_f32 v64, v72, v73
  v_cvt_pk_bf16_f32 v65, v74, v75
  v_cvt_pk_bf16_f32 v66, v76, v77
  v_cvt_pk_bf16_f32 v67, v78, v79
  buffer_load_dwordx4 v[120:123], v1, s[32:35], s64 offen offset:2048 sc1
  s_waitcnt lgkmcnt(2)
  v_mfma_f32_32x32x16_bf16 v[32:47], v[16:19], v[168:171], v[32:47]
  ds_read_b128 v[84:87], v0 offset:22528
  buffer_store_dwordx4 v[64:67], v1, s[32:35], s56 offen offset:512
  v_mfma_f32_32x32x16_bf16 v[32:47], v[20:23], v[172:175], v[32:47]
  ds_read_b128 v[16:19], v0 offset:23552
  buffer_load_dwordx4 v[124:127], v1, s[32:35], s64 offen offset:2560 sc1
  s_waitcnt lgkmcnt(2)
  v_mfma_f32_32x32x16_bf16 v[32:47], v[24:27], v[176:179], v[32:47]
  ds_read_b128 v[20:23], v0 offset:24576
  v_mfma_f32_32x32x16_bf16 v[32:47], v[28:31], v[180:183], v[32:47]
  ds_read_b128 v[24:27], v0 offset:25600
  s_add_u32 s64, s63, 8192
  buffer_load_dwordx4 v[128:131], v1, s[32:35], s64 offen offset:512 sc1
  s_waitcnt lgkmcnt(2)
  v_mfma_f32_32x32x16_bf16 v[32:47], v[84:87], v[184:187], v[32:47]
  ds_read_b128 v[28:31], v0 offset:26624
  v_mfma_f32_32x32x16_bf16 v[32:47], v[16:19], v[188:191], v[32:47]
  ds_read_b128 v[84:87], v0 offset:27648
  buffer_load_dwordx4 v[132:135], v1, s[32:35], s64 offen offset:1024 sc1
  s_waitcnt lgkmcnt(2)
  v_mfma_f32_32x32x16_bf16 v[32:47], v[20:23], v[192:195], v[32:47]
  s_barrier
  ds_read_b128 v[16:19], v0 offset:28672
  v_mfma_f32_32x32x16_bf16 v[32:47], v[24:27], v[196:199], v[32:47]
  ds_read_b128 v[20:23], v0 offset:29696
  buffer_load_dwordx4 v[136:139], v1, s[32:35], s64 offen offset:1536 sc1
  s_waitcnt lgkmcnt(2)
  v_mfma_f32_32x32x16_bf16 v[32:47], v[28:31], v[200:203], v[32:47]
  ds_read_b128 v[24:27], v0 offset:30720
  v_mfma_f32_32x32x16_bf16 v[32:47], v[84:87], v[204:207], v[32:47]
  ds_read_b128 v[28:31], v0 offset:31744
  buffer_load_dwordx4 v[140:143], v1, s[32:35], s64 offen offset:2048 sc1
  s_waitcnt lgkmcnt(2)
  v_mfma_f32_32x32x16_bf16 v[32:47], v[16:19], v[208:211], v[32:47]
  v_mfma_f32_32x32x16_bf16 v[32:47], v[20:23], v[212:215], v[32:47]
  s_waitcnt lgkmcnt(0)
  v_mfma_f32_32x32x16_bf16 v[32:47], v[24:27], v[216:219], v[32:47]
  v_mfma_f32_32x32x16_bf16 v[32:47], v[28:31], v[220:223], v[32:47]
  s_waitcnt vmcnt(12)
  v_mfma_f32_32x32x16_bf16 v[48:63], a[24:27], v[96:99], 0
  v_mfma_f32_32x32x16_bf16 v[64:79], a[28:31], v[96:99], 0
  s_waitcnt vmcnt(11)
  v_mfma_f32_32x32x16_bf16 v[48:63], a[32:35], v[100:103], v[48:63]
  v_mfma_f32_32x32x16_bf16 v[64:79], a[36:39], v[100:103], v[64:79]
  s_nop 5
  v_mul_f32 v32, v4, v32
  v_mul_f32 v33, v4, v33
  v_mul_f32 v34, v4, v34
  v_mul_f32 v35, v4, v35
  v_exp_f32 v32, v32
  v_exp_f32 v33, v33
  v_exp_f32 v34, v34
  v_exp_f32 v35, v35
  v_fma_f32 v32, v32, v5, v5
  v_fma_f32 v33, v33, v5, v5
  s_waitcnt vmcnt(10)
  v_mfma_f32_32x32x16_bf16 v[48:63], a[40:43], v[104:107], v[48:63]
  v_fma_f32 v34, v34, v5, v5
  v_fma_f32 v35, v35, v5, v5
  v_rcp_f32 v32, v32
  v_rcp_f32 v33, v33
  v_rcp_f32 v34, v34
  v_rcp_f32 v35, v35
  v_mul_f32 v40, v40, v32
  v_mul_f32 v41, v41, v33
  v_mul_f32 v42, v42, v34
  v_mul_f32 v43, v43, v35
  v_mfma_f32_32x32x16_bf16 v[64:79], a[44:47], v[104:107], v[64:79]
  v_mul_f32 v36, v4, v36
  v_mul_f32 v37, v4, v37
  v_mul_f32 v38, v4, v38
  v_mul_f32 v39, v4, v39
  v_exp_f32 v36, v36
  v_exp_f32 v37, v37
  v_exp_f32 v38, v38
  v_exp_f32 v39, v39
  v_fma_f32 v36, v36, v5, v5
  v_fma_f32 v37, v37, v5, v5
  s_waitcnt vmcnt(9)
  v_mfma_f32_32x32x16_bf16 v[48:63], a[48:51], v[108:111], v[48:63]
  v_fma_f32 v38, v38, v5, v5
  v_fma_f32 v39, v39, v5, v5
  v_rcp_f32 v36, v36
  v_rcp_f32 v37, v37
  v_rcp_f32 v38, v38
  v_rcp_f32 v39, v39
  v_mul_f32 v44, v44, v36
  v_mul_f32 v45, v45, v37
  v_mul_f32 v46, v46, v38
  v_mul_f32 v47, v47, v39
  v_mfma_f32_32x32x16_bf16 v[64:79], a[52:55], v[108:111], v[64:79]
  v_cvt_pk_bf16_f32 v32, v40, v41
  v_cvt_pk_bf16_f32 v33, v42, v43
  v_cvt_pk_bf16_f32 v34, v44, v45
  v_cvt_pk_bf16_f32 v35, v46, v47
  buffer_store_dwordx4 v[32:35], v1, s[32:35], s56 offen offset:0
  v_mbcnt_lo_u32_b32 v0, -1, 0
  v_mbcnt_hi_u32_b32 v0, -1, v0
  v_lshlrev_b32 v218, 3, v0
  v_bfe_u32 v2, v0, 4, 1
  v_lshlrev_b32 v2, 14, v2
  v_lshrrev_b32 v15, 5, v0
  v_lshl_add_u32 v2, v15, 8, v2
  s_waitcnt vmcnt(9)
  v_mfma_f32_32x32x16_bf16 v[48:63], a[80:83], v[112:115], v[48:63]
  s_add_u32 s64, s63, 12288
  buffer_load_dwordx4 v[144:147], v1, s[32:35], s64 offen offset:0 sc1
  v_bfe_u32 v15, v0, 0, 4
  v_lshl_add_u32 v2, v15, 4, v2
  v_mfma_f32_32x32x16_bf16 v[64:79], a[84:87], v[112:115], v[64:79]
  s_mul_i32 s54, s40, 131072
  s_mul_i32 s67, s42, 65536
  s_add_u32 s54, s54, s67
  s_mul_i32 s67, s43, 2048
  s_add_u32 s54, s54, s67
  s_waitcnt vmcnt(9)
  v_mfma_f32_32x32x16_bf16 v[48:63], a[88:91], v[116:119], v[48:63]
  buffer_load_dwordx4 v[148:151], v1, s[32:35], s64 offen offset:512 sc1
  s_mul_i32 s67, s39, 512
  s_add_u32 s54, s54, s67
  v_mfma_f32_32x32x16_bf16 v[64:79], a[92:95], v[116:119], v[64:79]
  s_add_u32 s54, s54, 4194304
  s_add_u32 s55, s54, 32768
  v_lshlrev_b32 v8, 4, v0
  v_bfe_u32 v3, v0, 0, 5
  v_lshlrev_b32 v3, 11, v3
  s_waitcnt vmcnt(9)
  v_mfma_f32_32x32x16_bf16 v[48:63], a[96:99], v[120:123], v[48:63]
  buffer_load_dwordx4 v[152:155], v1, s[32:35], s64 offen offset:1024 sc1
  v_lshrrev_b32 v15, 5, v0
  v_lshl_add_u32 v3, v15, 4, v3
  v_mfma_f32_32x32x16_bf16 v[64:79], a[100:103], v[120:123], v[64:79]
  s_mul_i32 s56, s44, 262144
  s_mul_i32 s67, s42, 131072
  s_add_u32 s56, s56, s67
  s_mul_i32 s67, s45, 1024
  s_add_u32 s56, s56, s67
  s_waitcnt vmcnt(8)
  v_mfma_f32_32x32x16_bf16 v[48:63], a[104:107], v[124:127], v[48:63]
  buffer_load_dwordx4 v[156:159], v1, s[32:35], s64 offen offset:1536 sc1
  s_mul_i32 s67, s43, 128
  s_add_u32 s56, s56, s67
  v_mfma_f32_32x32x16_bf16 v[64:79], a[108:111], v[124:127], v[64:79]
  s_mul_i32 s67, s39, 32
  s_add_u32 s56, s56, s67
  s_add_u32 s57, s56, 65536
  s_add_u32 s66, s39, 1
  s_and_b32 s66, s66, 3
  s_waitcnt vmcnt(8)
  v_mfma_f32_32x32x16_bf16 v[48:63], a[136:139], v[128:131], v[48:63]
  s_add_u32 s64, s63, 114688
  buffer_load_dwordx4 v[160:163], v1, s[32:35], s64 offen offset:1536 sc1
  s_mul_i32 s65, s66, 6144
  s_add_u32 s65, s65, 98304
  v_mfma_f32_32x32x16_bf16 v[64:79], a[140:143], v[128:131], v[64:79]
  v_add_u32 v4, s65, v8
  s_add_u32 s66, s39, 2
  s_and_b32 s66, s66, 3
  s_mul_i32 s65, s66, 6144
  s_add_u32 s65, s65, 100352
  s_add_u32 s69, s36, 11
  v_mov_b32 v212, s69
  v_mov_b32 v213, s37
  s_mov_b64 exec, 1
  s_cmp_lg_u32 s38, 0
  s_waitcnt vmcnt(5)
  s_cbranch_scc1 L_slow_82
  buffer_store_dwordx2 v[212:213], off, s[32:35], s51
L_sigd_83:
  s_mov_b64 exec, -1
  v_mfma_f32_32x32x16_bf16 v[48:63], a[144:147], v[132:135], v[48:63]
  buffer_load_dwordx4 v[164:167], v1, s[32:35], s64 offen offset:2048 sc1
  v_add_u32 v5, s65, v8
  s_add_u32 s66, s39, 3
  v_mfma_f32_32x32x16_bf16 v[64:79], a[148:151], v[132:135], v[64:79]
  s_and_b32 s66, s66, 3
  s_mul_i32 s65, s66, 6144
  s_add_u32 s65, s65, 102400
  v_add_u32 v6, s65, v8
  s_mul_i32 s65, s39, 6144
  v_mfma_f32_32x32x16_bf16 v[48:63], a[152:155], v[136:139], v[48:63]
  buffer_load_dwordx4 v[168:171], v1, s[32:35], s64 offen offset:2560 sc1
  s_add_u32 s65, s65, 98304
  v_add_u32 v7, s65, v8
  v_mfma_f32_32x32x16_bf16 v[64:79], a[156:159], v[136:139], v[64:79]
  v_mov_b32 v200, v88
  v_mov_b32 v201, v89
  v_mov_b32 v202, v90
  v_mov_b32 v203, v91
  v_mov_b32 v204, v92
  v_mfma_f32_32x32x16_bf16 v[48:63], a[160:163], v[140:143], v[48:63]
  buffer_load_dwordx4 v[172:175], v1, s[32:35], s64 offen offset:3072 sc1
  v_mov_b32 v205, v93
  v_mov_b32 v206, v94
  v_mfma_f32_32x32x16_bf16 v[64:79], a[164:167], v[140:143], v[64:79]
  v_mov_b32 v207, v95
  v_lshlrev_b32 v80, 16, v200
  v_and_b32 v81, 4294901760, v200
  v_lshlrev_b32 v82, 16, v201
  v_and_b32 v83, 4294901760, v201
  s_waitcnt vmcnt(8)
  v_mfma_f32_32x32x16_bf16 v[48:63], a[192:195], v[144:147], v[48:63]
  s_add_u32 s64, s63, 118784
  buffer_load_dwordx4 v[96:99], v1, s[32:35], s64 offen offset:1024 sc1
  v_lshlrev_b32 v84, 16, v202
  v_and_b32 v85, 4294901760, v202
  v_mfma_f32_32x32x16_bf16 v[64:79], a[196:199], v[144:147], v[64:79]
  v_lshlrev_b32 v86, 16, v203
  v_and_b32 v87, 4294901760, v203
  v_lshlrev_b32 v88, 16, v204
  v_and_b32 v89, 4294901760, v204
  v_lshlrev_b32 v90, 16, v205
  s_waitcnt vmcnt(8)
  v_mfma_f32_32x32x16_bf16 v[48:63], a[200:203], v[148:151], v[48:63]
  buffer_load_dwordx4 v[100:103], v1, s[32:35], s64 offen offset:1536 sc1
  v_and_b32 v91, 4294901760, v205
  v_lshlrev_b32 v92, 16, v206
  v_mfma_f32_32x32x16_bf16 v[64:79], a[204:207], v[148:151], v[64:79]
  v_and_b32 v93, 4294901760, v206
  v_lshlrev_b32 v94, 16, v207
  v_and_b32 v95, 4294901760, v207
  s_waitcnt vmcnt(8)
  v_mfma_f32_32x32x16_bf16 v[48:63], a[208:211], v[152:155], v[48:63]
  buffer_load_dwordx4 v[104:107], v1, s[32:35], s64 offen offset:2048 sc1
  v_mfma_f32_32x32x16_bf16 v[64:79], a[212:215], v[152:155], v[64:79]
  s_waitcnt vmcnt(8)
  v_mfma_f32_32x32x16_bf16 v[48:63], a[216:219], v[156:159], v[48:63]
  buffer_load_dwordx4 v[108:111], v1, s[32:35], s64 offen offset:2560 sc1
  v_mfma_f32_32x32x16_bf16 v[64:79], a[220:223], v[156:159], v[64:79]
  s_waitcnt vmcnt(8)
  v_mfma_f32_32x32x16_bf16 v[16:31], a[24:27], v[160:163], 0
  s_add_u32 s64, s63, 122880
  buffer_load_dwordx4 v[112:115], v1, s[32:35], s64 offen offset:512 sc1
  v_mfma_f32_32x32x16_bf16 v[32:47], a[28:31], v[160:163], 0
  s_waitcnt vmcnt(7)
  v_mfma_f32_32x32x16_bf16 v[16:31], a[32:35], v[164:167], v[16:31]
  buffer_load_dwordx4 v[116:119], v1, s[32:35], s64 offen offset:1024 sc1
  v_mfma_f32_32x32x16_bf16 v[32:47], a[36:39], v[164:167], v[32:47]
  s_waitcnt vmcnt(7)
  v_mfma_f32_32x32x16_bf16 v[16:31], a[40:43], v[168:171], v[16:31]
  buffer_load_dwordx4 v[120:123], v1, s[32:35], s64 offen offset:1536 sc1
  v_mfma_f32_32x32x16_bf16 v[32:47], a[44:47], v[168:171], v[32:47]
  buffer_load_dwordx2 v[216:217], v218, s[32:35], s50 offen offset:0 sc1
  s_waitcnt vmcnt(8)
  v_mfma_f32_32x32x16_bf16 v[16:31], a[48:51], v[172:175], v[16:31]
  buffer_load_dwordx4 v[124:127], v1, s[32:35], s64 offen offset:2048 sc1
  v_mfma_f32_32x32x16_bf16 v[32:47], a[52:55], v[172:175], v[32:47]
  s_waitcnt vmcnt(8)
  v_mfma_f32_32x32x16_bf16 v[16:31], a[80:83], v[96:99], v[16:31]
  s_add_u32 s64, s63, 126976
  buffer_load_dwordx4 v[128:131], v1, s[32:35], s64 offen offset:0 sc1
  v_mfma_f32_32x32x16_bf16 v[32:47], a[84:87], v[96:99], v[32:47]
  s_waitcnt vmcnt(8)
  v_mfma_f32_32x32x16_bf16 v[16:31], a[88:91], v[100:103], v[16:31]
  buffer_load_dwordx4 v[132:135], v1, s[32:35], s64 offen offset:512 sc1
  v_mfma_f32_32x32x16_bf16 v[32:47], a[92:95], v[100:103], v[32:47]
  s_waitcnt vmcnt(8)
  v_mfma_f32_32x32x16_bf16 v[16:31], a[96:99], v[104:107], v[16:31]
  buffer_load_dwordx4 v[136:139], v1, s[32:35], s64 offen offset:1024 sc1
  v_mfma_f32_32x32x16_bf16 v[32:47], a[100:103], v[104:107], v[32:47]
  s_waitcnt vmcnt(8)
  v_mfma_f32_32x32x16_bf16 v[16:31], a[104:107], v[108:111], v[16:31]
  buffer_load_dwordx4 v[140:143], v1, s[32:35], s64 offen offset:1536 sc1
  v_mfma_f32_32x32x16_bf16 v[32:47], a[108:111], v[108:111], v[32:47]
  s_mov_b32 s69, 0
  s_waitcnt vmcnt(5)
L_chk_85:
  v_subrev_u32 v216, s36, v216
  v_xor_b32 v217, s37, v217
  v_subrev_u32 v216, 11, v216
  v_cmp_lt_u64 vcc, 31, v[216:217]
  s_nop 0
  s_and_b64 vcc, vcc, s[48:49]
  s_cbranch_scc1 L_poll_84
  s_cmp_lg_u32 s38, 0
  s_cbranch_scc1 L_inv_87
L_polld_86:
  v_mfma_f32_32x32x16_bf16 v[16:31], a[136:139], v[112:115], v[16:31]
  s_add_u32 s64, s63, 0
  buffer_load_dwordx4 v[144:147], v1, s[32:35], s64 offen offset:0 sc1
  v_mfma_f32_32x32x16_bf16 v[32:47], a[140:143], v[112:115], v[32:47]
  v_mfma_f32_32x32x16_bf16 v[16:31], a[144:147], v[116:119], v[16:31]
  buffer_load_dwordx4 v[148:151], v1, s[32:35], s64 offen offset:512 sc1
  v_mfma_f32_32x32x16_bf16 v[32:47], a[148:151], v[116:119], v[32:47]
  v_mfma_f32_32x32x16_bf16 v[16:31], a[152:155], v[120:123], v[16:31]
  buffer_load_dwordx4 v[152:155], v1, s[32:35], s64 offen offset:1024 sc1
  v_mfma_f32_32x32x16_bf16 v[32:47], a[156:159], v[120:123], v[32:47]
  s_waitcnt vmcnt(7)
  v_mfma_f32_32x32x16_bf16 v[16:31], a[160:163], v[124:127], v[16:31]
  buffer_load_dwordx4 v[156:159], v1, s[32:35], s64 offen offset:3584 sc1
  v_mfma_f32_32x32x16_bf16 v[32:47], a[164:167], v[124:127], v[32:47]
  s_waitcnt vmcnt(7)
  v_mfma_f32_32x32x16_bf16 v[16:31], a[192:195], v[128:131], v[16:31]
  s_add_u32 s64, s63, 4096
  buffer_load_dwordx4 v[160:163], v1, s[32:35], s64 offen offset:0 sc1
  v_mfma_f32_32x32x16_bf16 v[32:47], a[196:199], v[128:131], v[32:47]
  s_waitcnt vmcnt(7)
  v_mfma_f32_32x32x16_bf16 v[16:31], a[200:203], v[132:135], v[16:31]
  buffer_load_dwordx4 v[164:167], v1, s[32:35], s64 offen offset:512 sc1
  v_mfma_f32_32x32x16_bf16 v[32:47], a[204:207], v[132:135], v[32:47]
  s_waitcnt vmcnt(7)
  v_mfma_f32_32x32x16_bf16 v[16:31], a[208:211], v[136:139], v[16:31]
  buffer_load_dwordx4 v[168:171], v1, s[32:35], s64 offen offset:3072 sc1
  v_mfma_f32_32x32x16_bf16 v[32:47], a[212:215], v[136:139], v[32:47]
  s_waitcnt vmcnt(7)
  v_mfma_f32_32x32x16_bf16 v[16:31], a[216:219], v[140:143], v[16:31]
  buffer_load_dwordx4 v[172:175], v1, s[32:35], s64 offen offset:3584 sc1
  v_mfma_f32_32x32x16_bf16 v[32:47], a[220:223], v[140:143], v[32:47]
  s_waitcnt vmcnt(7)
  v_mfma_f32_32x32x16_bf16 v[48:63], a[0:3], v[144:147], v[48:63]
  s_add_u32 s64, s63, 8192
  buffer_load_dwordx4 v[96:99], v1, s[32:35], s64 offen offset:0 sc1
  v_mfma_f32_32x32x16_bf16 v[64:79], a[4:7], v[144:147], v[64:79]
  s_waitcnt vmcnt(7)
  v_mfma_f32_32x32x16_bf16 v[48:63], a[8:11], v[148:151], v[48:63]
  buffer_load_dwordx4 v[100:103], v1, s[32:35], s64 offen offset:2560 sc1
  v_mfma_f32_32x32x16_bf16 v[64:79], a[12:15], v[148:151], v[64:79]
  s_waitcnt vmcnt(7)
  v_mfma_f32_32x32x16_bf16 v[48:63], a[16:19], v[152:155], v[48:63]
  buffer_load_dwordx4 v[104:107], v1, s[32:35], s64 offen offset:3072 sc1
  v_mfma_f32_32x32x16_bf16 v[64:79], a[20:23], v[152:155], v[64:79]
  s_waitcnt vmcnt(7)
  v_mfma_f32_32x32x16_bf16 v[48:63], a[56:59], v[156:159], v[48:63]
  buffer_load_dwordx4 v[108:111], v1, s[32:35], s64 offen offset:3584 sc1
  v_mfma_f32_32x32x16_bf16 v[64:79], a[60:63], v[156:159], v[64:79]
  s_waitcnt vmcnt(7)
  v_mfma_f32_32x32x16_bf16 v[48:63], a[64:67], v[160:163], v[48:63]
  s_add_u32 s64, s63, 114688
  buffer_load_dwordx4 v[112:115], v1, s[32:35], s64 offen offset:0 sc1
  v_mfma_f32_32x32x16_bf16 v[64:79], a[68:71], v[160:163], v[64:79]
  s_waitcnt vmcnt(7)
  v_mfma_f32_32x32x16_bf16 v[48:63], a[72:75], v[164:167], v[48:63]
  buffer_load_dwordx4 v[116:119], v1, s[32:35], s64 offen offset:512 sc1
  v_mfma_f32_32x32x16_bf16 v[64:79], a[76:79], v[164:167], v[64:79]
  s_waitcnt vmcnt(7)
  v_mfma_f32_32x32x16_bf16 v[48:63], a[112:115], v[168:171], v[48:63]
  buffer_load_dwordx4 v[120:123], v1, s[32:35], s64 offen offset:1024 sc1
  v_mfma_f32_32x32x16_bf16 v[64:79], a[116:119], v[168:171], v[64:79]
  s_waitcnt vmcnt(7)
  v_mfma_f32_32x32x16_bf16 v[48:63], a[120:123], v[172:175], v[48:63]
  buffer_load_dwordx4 v[124:127], v1, s[32:35], s64 offen offset:3584 sc1
  v_mfma_f32_32x32x16_bf16 v[64:79], a[124:127], v[172:175], v[64:79]
  s_waitcnt vmcnt(7)
  v_mfma_f32_32x32x16_bf16 v[48:63], a[128:131], v[96:99], v[48:63]
  s_add_u32 s64, s63, 118784
  buffer_load_dwordx4 v[128:131], v1, s[32:35], s64 offen offset:0 sc1
  v_mfma_f32_32x32x16_bf16 v[64:79], a[132:135], v[96:99], v[64:79]
  s_waitcnt vmcnt(7)
  v_mfma_f32_32x32x16_bf16 v[48:63], a[168:171], v[100:103], v[48:63]
  buffer_load_dwordx4 v[132:135], v1, s[32:35], s64 offen offset:512 sc1
  v_mfma_f32_32x32x16_bf16 v[64:79], a[172:175], v[100:103], v[64:79]
  s_waitcnt vmcnt(7)
  v_mfma_f32_32x32x16_bf16 v[48:63], a[176:179], v[104:107], v[48:63]
  buffer_load_dwordx4 v[136:139], v1, s[32:35], s64 offen offset:3072 sc1
  v_mfma_f32_32x32x16_bf16 v[64:79], a[180:183], v[104:107], v[64:79]
  s_waitcnt vmcnt(7)
  v_mfma_f32_32x32x16_bf16 v[48:63], a[184:187], v[108:111], v[48:63]
  buffer_load_dwordx4 v[140:143], v1, s[32:35], s64 offen offset:3584 sc1
  v_mfma_f32_32x32x16_bf16 v[64:79], a[188:191], v[108:111], v[64:79]
  s_waitcnt vmcnt(7)
  v_mfma_f32_32x32x16_bf16 v[16:31], a[0:3], v[112:115], v[16:31]
  s_add_u32 s64, s63, 122880
  buffer_load_dwordx4 v[144:147], v1, s[32:35], s64 offen offset:0 sc1
  v_mfma_f32_32x32x16_bf16 v[32:47], a[4:7], v[112:115], v[32:47]
  s_waitcnt vmcnt(7)
  v_mfma_f32_32x32x16_bf16 v[16:31], a[8:11], v[116:119], v[16:31]
  buffer_load_dwordx4 v[148:151], v1, s[32:35], s64 offen offset:2560 sc1
  s_nop 1
  v_add_f32 v48, v48, v80
  v_add_f32 v49, v49, v81
  v_mfma_f32_32x32x16_bf16 v[32:47], a[12:15], v[116:119], v[32:47]
  v_add_f32 v50, v50, v82
  v_add_f32 v51, v51, v83
  v_add_f32 v52, v52, v84
  v_add_f32 v53, v53, v85
  v_add_f32 v54, v54, v86
  s_waitcnt vmcnt(7)
  v_mfma_f32_32x32x16_bf16 v[16:31], a[16:19], v[120:123], v[16:31]
  buffer_load_dwordx4 v[152:155], v1, s[32:35], s64 offen offset:3072 sc1
  v_add_f32 v55, v55, v87
  ds_write_b128 v4, v[56:59] offset:0
  v_mfma_f32_32x32x16_bf16 v[32:47], a[20:23], v[120:123], v[32:47]
  ds_write_b128 v4, v[60:63] offset:1024
  s_waitcnt vmcnt(7)
  v_mfma_f32_32x32x16_bf16 v[16:31], a[56:59], v[124:127], v[16:31]
  buffer_load_dwordx4 v[156:159], v1, s[32:35], s64 offen offset:3584 sc1
  ds_write_b128 v5, v[64:67] offset:0
  v_mfma_f32_32x32x16_bf16 v[32:47], a[60:63], v[124:127], v[32:47]
  ds_write_b128 v5, v[68:71] offset:1024
  s_waitcnt vmcnt(7)
  v_mfma_f32_32x32x16_bf16 v[16:31], a[64:67], v[128:131], v[16:31]
  ds_write_b128 v6, v[72:75] offset:0
  v_mfma_f32_32x32x16_bf16 v[32:47], a[68:71], v[128:131], v[32:47]
  ds_write_b128 v6, v[76:79] offset:1024
  s_waitcnt vmcnt(6)
  v_mfma_f32_32x32x16_bf16 v[16:31], a[72:75], v[132:135], v[16:31]
  v_mfma_f32_32x32x16_bf16 v[32:47], a[76:79], v[132:135], v[32:47]
  s_waitcnt lgkmcnt(0)
  s_barrier
  ds_read_b128 v[176:179], v7 offset:0
  ds_read_b128 v[180:183], v7 offset:1024
  s_waitcnt vmcnt(5)
  v_mfma_f32_32x32x16_bf16 v[16:31], a[112:115], v[136:139], v[16:31]
  ds_read_b128 v[184:187], v7 offset:2048
  ds_read_b128 v[188:191], v7 offset:3072
  v_mfma_f32_32x32x16_bf16 v[32:47], a[116:119], v[136:139], v[32:47]
  ds_read_b128 v[192:195], v7 offset:4096
  ds_read_b128 v[196:199], v7 offset:5120
  s_waitcnt vmcnt(4)
  v_mfma_f32_32x32x16_bf16 v[16:31], a[120:123], v[140:143], v[16:31]
  v_mfma_f32_32x32x16_bf16 v[32:47], a[124:127], v[140:143], v[32:47]
  s_waitcnt lgkmcnt(5)
  v_add_f32 v48, v48, v176
  v_add_f32 v49, v49, v177
  v_add_f32 v50, v50, v178
  v_add_f32 v51, v51, v179
  s_waitcnt lgkmcnt(4)
  v_add_f32 v52, v52, v180
  s_waitcnt vmcnt(3)
  v_mfma_f32_32x32x16_bf16 v[16:31], a[128:131], v[144:147], v[16:31]
  v_add_f32 v53, v53, v181
  v_add_f32 v54, v54, v182
  v_add_f32 v55, v55, v183
  s_waitcnt lgkmcnt(3)
  v_add_f32 v48, v48, v184
  v_add_f32 v49, v49, v185
  v_mfma_f32_32x32x16_bf16 v[32:47], a[132:135], v[144:147], v[32:47]
  v_add_f32 v50, v50, v186
  v_add_f32 v51, v51, v187
  s_waitcnt lgkmcnt(2)
  v_add_f32 v52, v52, v188
  v_add_f32 v53, v53, v189
  v_add_f32 v54, v54, v190
  s_waitcnt vmcnt(2)
  v_mfma_f32_32x32x16_bf16 v[16:31], a[168:171], v[148:151], v[16:31]
  v_add_f32 v55, v55, v191
  s_waitcnt lgkmcnt(1)
  v_add_f32 v48, v48, v192
  v_add_f32 v49, v49, v193
  v_add_f32 v50, v50, v194
  v_add_f32 v51, v51, v195
  v_mfma_f32_32x32x16_bf16 v[32:47], a[172:175], v[148:151], v[32:47]
  s_waitcnt lgkmcnt(0)
  v_add_f32 v52, v52, v196
  v_add_f32 v53, v53, v197
  v_add_f32 v54, v54, v198
  v_add_f32 v55, v55, v199
  v_cvt_pk_bf16_f32 v200, v48, v49
  s_waitcnt vmcnt(1)
  v_mfma_f32_32x32x16_bf16 v[16:31], a[176:179], v[152:155], v[16:31]
  v_cvt_pk_bf16_f32 v201, v50, v51
  v_cvt_pk_bf16_f32 v202, v52, v53
  v_cvt_pk_bf16_f32 v203, v54, v55
  buffer_store_dwordx4 v[200:203], v3, s[28:31], s56 offen
  v_mfma_f32_32x32x16_bf16 v[32:47], a[180:183], v[152:155], v[32:47]
  s_waitcnt vmcnt(1)
  v_mfma_f32_32x32x16_bf16 v[16:31], a[184:187], v[156:159], v[16:31]
  v_mfma_f32_32x32x16_bf16 v[32:47], a[188:191], v[156:159], v[32:47]
  s_nop 10
  ds_write_b128 v4, v[24:27] offset:24576
  ds_write_b128 v4, v[28:31] offset:25600
  ds_write_b128 v5, v[32:35] offset:24576
  ds_write_b128 v5, v[36:39] offset:25600
  ds_write_b128 v6, v[40:43] offset:24576
  ds_write_b128 v6, v[44:47] offset:25600
  v_pk_add_f32 v[16:17], v[16:17], v[88:89]
  v_pk_add_f32 v[18:19], v[18:19], v[90:91]
  v_pk_add_f32 v[20:21], v[20:21], v[92:93]
  v_pk_add_f32 v[22:23], v[22:23], v[94:95]
  s_waitcnt lgkmcnt(0)
  s_barrier
  ds_read_b128 v[176:179], v7 offset:24576
  ds_read_b128 v[180:183], v7 offset:25600
  ds_read_b128 v[184:187], v7 offset:26624
  ds_read_b128 v[188:191], v7 offset:27648
  ds_read_b128 v[192:195], v7 offset:28672
  ds_read_b128 v[196:199], v7 offset:29696
  s_waitcnt lgkmcnt(5)
  v_pk_add_f32 v[16:17], v[16:17], v[176:177]
  v_pk_add_f32 v[18:19], v[18:19], v[178:179]
  s_waitcnt lgkmcnt(4)
  v_pk_add_f32 v[20:21], v[20:21], v[180:181]
  v_pk_add_f32 v[22:23], v[22:23], v[182:183]
  s_waitcnt lgkmcnt(3)
  v_pk_add_f32 v[16:17], v[16:17], v[184:185]
  v_pk_add_f32 v[18:19], v[18:19], v[186:187]
  s_waitcnt lgkmcnt(2)
  v_pk_add_f32 v[20:21], v[20:21], v[188:189]
  v_pk_add_f32 v[22:23], v[22:23], v[190:191]
  s_waitcnt lgkmcnt(1)
  v_pk_add_f32 v[16:17], v[16:17], v[192:193]
  v_pk_add_f32 v[18:19], v[18:19], v[194:195]
  s_waitcnt lgkmcnt(0)
  v_pk_add_f32 v[20:21], v[20:21], v[196:197]
  v_pk_add_f32 v[22:23], v[22:23], v[198:199]
  v_cvt_pk_bf16_f32 v204, v16, v17
  v_cvt_pk_bf16_f32 v205, v18, v19
  v_cvt_pk_bf16_f32 v206, v20, v21
  v_cvt_pk_bf16_f32 v207, v22, v23
  buffer_store_dwordx4 v[204:207], v3, s[28:31], s57 offen
L_end:
  s_endpgm
L_poll_6:
  buffer_load_dwordx2 v[220:221], v222, s[32:35], s66 offen offset:0 sc1
  s_add_u32 s69, s69, 1
  s_cmp_gt_u32 s69, 0x400000
  s_cbranch_scc1 L_end
  s_waitcnt vmcnt(0)
  s_branch L_chk_7
L_slow_9:
  buffer_wbl2 sc1
  s_waitcnt vmcnt(0)
  buffer_store_dwordx2 v[220:221], off, s[32:35], s51  sc1
  s_branch L_sigd_10
L_poll_11:
  buffer_load_dwordx2 v[220:221], v222, s[32:35], s50 offen offset:0 sc1
  s_add_u32 s69, s69, 1
  s_cmp_gt_u32 s69, 0x400000
  s_cbranch_scc1 L_end
  s_waitcnt vmcnt(0)
  s_branch L_chk_12
L_inv_14:
  buffer_inv sc1
  s_waitcnt vmcnt(0)
  s_branch L_polld_13
L_poll_15:
  buffer_load_dwordx2 v[216:217], v218, s[32:35], s66 offen offset:0 sc1
  s_add_u32 s69, s69, 1
  s_cmp_gt_u32 s69, 0x400000
  s_cbranch_scc1 L_end
  s_waitcnt vmcnt(0)
  s_branch L_chk_16
L_slow_18:
  buffer_wbl2 sc1
  s_waitcnt vmcnt(0)
  buffer_store_dwordx2 v[220:221], off, s[32:35], s51  sc1
  s_branch L_sigd_19
L_slow_20:
  buffer_wbl2 sc1
  s_waitcnt vmcnt(0)
  buffer_store_dwordx2 v[82:83], off, s[32:35], s51  sc1
  s_branch L_sigd_21
L_poll_22:
  buffer_load_dwordx2 v[220:221], v222, s[32:35], s50 offen offset:0 sc1
  s_add_u32 s69, s69, 1
  s_cmp_gt_u32 s69, 0x400000
  s_cbranch_scc1 L_end
  s_waitcnt vmcnt(0)
  s_branch L_chk_23
L_inv_25:
  buffer_inv sc1
  s_waitcnt vmcnt(0)
  s_branch L_polld_24
L_poll_26:
  buffer_load_dwordx2 v[82:83], v81, s[32:35], s50 offen offset:0 sc1
  s_add_u32 s69, s69, 1
  s_cmp_gt_u32 s69, 0x400000
  s_cbranch_scc1 L_end
  s_waitcnt vmcnt(0)
  s_branch L_chk_27
L_inv_29:
  buffer_inv sc1
  s_waitcnt vmcnt(0)
  s_branch L_polld_28
L_slow_30:
  buffer_wbl2 sc1
  s_waitcnt vmcnt(0)
  buffer_store_dwordx2 v[82:83], off, s[32:35], s51  sc1
  s_branch L_sigd_31
L_poll_32:
  buffer_load_dwordx2 v[82:83], v81, s[32:35], s50 offen offset:0 sc1
  s_add_u32 s69, s69, 1
  s_cmp_gt_u32 s69, 0x400000
  s_cbranch_scc1 L_end
  s_waitcnt vmcnt(0)
  s_branch L_chk_33
L_inv_35:
  buffer_inv sc1
  s_waitcnt vmcnt(0)
  s_branch L_polld_34
L_slow_36:
  buffer_wbl2 sc1
  s_waitcnt vmcnt(0)
  buffer_store_dwordx2 v[212:213], off, s[32:35], s51  sc1
  s_branch L_sigd_37
L_poll_38:
  buffer_load_dwordx2 v[216:217], v218, s[32:35], s50 offen offset:0 sc1
  s_add_u32 s69, s69, 1
  s_cmp_gt_u32 s69, 0x400000
  s_cbranch_scc1 L_end
  s_waitcnt vmcnt(0)
  s_branch L_chk_39
L_inv_41:
  buffer_inv sc1
  s_waitcnt vmcnt(0)
  s_branch L_polld_40
L_slow_43:
  buffer_wbl2 sc1
  s_waitcnt vmcnt(0)
  buffer_store_dwordx2 v[212:213], off, s[32:35], s51  sc1
  s_branch L_sigd_44
L_slow_45:
  buffer_wbl2 sc1
  s_waitcnt vmcnt(0)
  buffer_store_dwordx2 v[216:217], off, s[32:35], s51  sc1
  s_branch L_sigd_46
L_poll_47:
  buffer_load_dwordx2 v[220:221], v222, s[32:35], s50 offen offset:0 sc1
  s_add_u32 s69, s69, 1
  s_cmp_gt_u32 s69, 0x400000
  s_cbranch_scc1 L_end
  s_waitcnt vmcnt(0)
  s_branch L_chk_48
L_inv_50:
  buffer_inv sc1
  s_waitcnt vmcnt(0)
  s_branch L_polld_49
L_poll_51:
  buffer_load_dwordx2 v[220:221], v222, s[32:35], s50 offen offset:0 sc1
  s_add_u32 s69, s69, 1
  s_cmp_gt_u32 s69, 0x400000
  s_cbranch_scc1 L_end
  s_waitcnt vmcnt(0)
  s_branch L_chk_52
L_inv_54:
  buffer_inv sc1
  s_waitcnt vmcnt(0)
  s_branch L_polld_53
L_poll_55:
  buffer_load_dwordx2 v[220:221], v222, s[32:35], s57 offen offset:512 sc1
  s_add_u32 s69, s69, 1
  s_cmp_gt_u32 s69, 0x400000
  s_cbranch_scc1 L_end
  s_waitcnt vmcnt(0)
  s_branch L_chk_56
L_slow_58:
  buffer_wbl2 sc1
  s_waitcnt vmcnt(0)
  buffer_store_dwordx2 v[220:221], off, s[32:35], s51  sc1
  s_branch L_sigd_59
L_poll_60:
  buffer_load_dwordx2 v[220:221], v222, s[32:35], s50 offen offset:0 sc1
  s_add_u32 s69, s69, 1
  s_cmp_gt_u32 s69, 0x400000
  s_cbranch_scc1 L_end
  s_waitcnt vmcnt(0)
  s_branch L_chk_61
L_inv_63:
  buffer_inv sc1
  s_waitcnt vmcnt(0)
  s_branch L_polld_62
L_slow_64:
  buffer_wbl2 sc1
  s_waitcnt vmcnt(0)
  buffer_store_dwordx2 v[220:221], off, s[32:35], s51  sc1
  s_branch L_sigd_65
L_slow_66:
  buffer_wbl2 sc1
  s_waitcnt vmcnt(0)
  buffer_store_dwordx2 v[82:83], off, s[32:35], s51  sc1
  s_branch L_sigd_67
L_poll_68:
  buffer_load_dwordx2 v[220:221], v222, s[32:35], s50 offen offset:0 sc1
  s_add_u32 s69, s69, 1
  s_cmp_gt_u32 s69, 0x400000
  s_cbranch_scc1 L_end
  s_waitcnt vmcnt(0)
  s_branch L_chk_69
L_inv_71:
  buffer_inv sc1
  s_waitcnt vmcnt(0)
  s_branch L_polld_70
L_poll_72:
  buffer_load_dwordx2 v[82:83], v81, s[32:35], s50 offen offset:0 sc1
  s_add_u32 s69, s69, 1
  s_cmp_gt_u32 s69, 0x400000
  s_cbranch_scc1 L_end
  s_waitcnt vmcnt(0)
  s_branch L_chk_73
L_inv_75:
  buffer_inv sc1
  s_waitcnt vmcnt(0)
  s_branch L_polld_74
L_slow_76:
  buffer_wbl2 sc1
  s_waitcnt vmcnt(0)
  buffer_store_dwordx2 v[82:83], off, s[32:35], s51  sc1
  s_branch L_sigd_77
L_poll_78:
  buffer_load_dwordx2 v[82:83], v81, s[32:35], s50 offen offset:0 sc1
  s_add_u32 s69, s69, 1
  s_cmp_gt_u32 s69, 0x400000
  s_cbranch_scc1 L_end
  s_waitcnt vmcnt(0)
  s_branch L_chk_79
L_inv_81:
  buffer_inv sc1
  s_waitcnt vmcnt(0)
  s_branch L_polld_80
L_slow_82:
  buffer_wbl2 sc1
  s_waitcnt vmcnt(0)
  buffer_store_dwordx2 v[212:213], off, s[32:35], s51  sc1
  s_branch L_sigd_83
L_poll_84:
  buffer_load_dwordx2 v[216:217], v218, s[32:35], s50 offen offset:0 sc1
  s_add_u32 s69, s69, 1
  s_cmp_gt_u32 s69, 0x400000
  s_cbranch_scc1 L_end
  s_waitcnt vmcnt(0)
  s_branch L_chk_85
L_inv_87:
  buffer_inv sc1
  s_waitcnt vmcnt(0)
  s_branch L_polld_86
L_codeend:
.section .rodata,"a"
.p2align 6
.amdhsa_kernel interleave_layers__sliding_local_dilated__glu_gated_glu__prompt_kernel
  .amdhsa_next_free_vgpr 512
  .amdhsa_next_free_sgpr 102
  .amdhsa_accum_offset 256
  .amdhsa_group_segment_fixed_size 0
  .amdhsa_kernarg_size 80
  .amdhsa_user_sgpr_count 2
  .amdhsa_user_sgpr_kernarg_segment_ptr 1
  .amdhsa_system_sgpr_workgroup_id_x 1
  .amdhsa_float_denorm_mode_32 3
.end_amdhsa_kernel
```
